```python
import torch

def _softmax(x, axis=-1):
    return torch.softmax(x, dim=axis)
def _gelu(x):
    return torch.nn.functional.gelu(x, approximate="tanh")
def _silu(x):
    return torch.nn.functional.silu(x)
def _sigmoid(x):
    return torch.sigmoid(x)
def _layernorm(x, axis=-1, eps=1e-5):
    m = x.mean(dim=axis, keepdim=True)
    v = x.var(dim=axis, keepdim=True, unbiased=False)
    return (x - m) / torch.sqrt(v + eps)
def _scatter_add(tgt, idx, src, axis=0):
    return tgt.clone().index_add_(axis, idx, src)
def _segment_sum(src, seg, n):
    out = torch.zeros((n,) + src.shape[1:], dtype=src.dtype)
    return out.index_add_(0, seg, src)
def _pad(x, pw):
    flat = tuple(v for pair in reversed(pw) for v in pair)
    return torch.nn.functional.pad(x, flat)

kernel_name = 'concat_heads__ssm_conv_s5__grouped_kv_mqa__prompt'

def setup_inputs():

    _w = (lambda a: (lambda t: t.to(torch.bfloat16) if t.is_floating_point() else t)(torch.as_tensor(a)))
    def _A_setup():
        B, S, D = 1, 2048, 576
        P = D
        Lambda_re = -0.5 * (lambda _x: torch.exp(torch.as_tensor(_x)))((lambda *s: torch.randn(*s, dtype=torch.bfloat16) * 0.2)(P))
        Lambda_im = (lambda *s: torch.randn(*s, dtype=torch.bfloat16) * 0.4)(P) * 1.0
        B_re = (lambda *s: torch.randn(*s, dtype=torch.bfloat16) * 0.2)(P, D) * (D ** -0.5)
        B_im = (lambda *s: torch.randn(*s, dtype=torch.bfloat16) * 0.2)(P, D) * (D ** -0.5)
        C_re = (lambda *s: torch.randn(*s, dtype=torch.bfloat16) * 0.2)(D, P) * (P ** -0.5)
        C_im = (lambda *s: torch.randn(*s, dtype=torch.bfloat16) * 0.2)(D, P) * (P ** -0.5)
        log_dt = (lambda *s: torch.randn(*s, dtype=torch.bfloat16) * 0.2)(P) * 0.3 - 2.0
        Dskip = (lambda *s: torch.randn(*s, dtype=torch.bfloat16) * 0.05)(D)
        return {
            "x": _w((lambda *s: torch.randn(*s, dtype=torch.bfloat16) * 0.05)(B, S, D)),
            "Lambda_re": _w(Lambda_re),
            "Lambda_im": _w(Lambda_im),
            "B_re": _w(B_re),
            "B_im": _w(B_im),
            "C_re": _w(C_re),
            "C_im": _w(C_im),
            "log_dt": _w(log_dt),
            "Dskip": _w(Dskip),
        }
    _A_in = _A_setup()

    def _B_setup():
        B, S, D, H = 1, 2048, 576, 32
        Dh = D // H
        return {
            "x": _w((lambda *s: torch.randn(*s, dtype=torch.bfloat16) * 0.05)(B, S, D)),
            "wq": _w((lambda *s: torch.randn(*s, dtype=torch.bfloat16) * 0.8)(D, H * Dh)),
            "wk": _w((lambda *s: torch.randn(*s, dtype=torch.bfloat16) * 0.8)(D, Dh)),
            "wv": _w((lambda *s: torch.randn(*s, dtype=torch.bfloat16) * 0.05)(D, Dh)),
            "wo": _w((lambda *s: torch.randn(*s, dtype=torch.bfloat16) * 0.05)(H * Dh, D)),
        }
    _B_in = _B_setup()

    return {
        "A_x": _A_in["x"],
        "A_Lambda_re": _A_in["Lambda_re"],
        "A_Lambda_im": _A_in["Lambda_im"],
        "A_B_re": _A_in["B_re"],
        "A_B_im": _A_in["B_im"],
        "A_C_re": _A_in["C_re"],
        "A_C_im": _A_in["C_im"],
        "A_log_dt": _A_in["log_dt"],
        "A_Dskip": _A_in["Dskip"],
        "B_x": _B_in["x"],
        "B_wq": _B_in["wq"],
        "B_wk": _B_in["wk"],
        "B_wv": _B_in["wv"],
        "B_wo": _B_in["wo"],
    }

def reference(A_x, A_Lambda_re, A_Lambda_im, A_B_re, A_B_im, A_C_re, A_C_im, A_log_dt, A_Dskip, B_x, B_wq, B_wk, B_wv, B_wo):
    def _A_ref(x, Lambda_re, Lambda_im, B_re, B_im, C_re, C_im, log_dt, Dskip):
        Bsz, L, H = x.shape
        Lam = Lambda_re + 1j * Lambda_im
        Bmat = B_re + 1j * B_im
        Cmat = C_re + 1j * C_im
        dt = torch.exp(log_dt)
        Lam_bar = torch.exp(dt * Lam)
        B_bar = ((Lam_bar - 1.0) / Lam)[:, None] * Bmat
        Bu = torch.einsum("bld,pd->blp", x + 0j, B_bar)
        h = torch.zeros_like(Bu[:, 0, :])
        hs = []
        for t in range(L):
            h = Lam_bar[None, :] * h + Bu[:, t, :]
            hs.append(h)
        hseq = torch.stack(hs, 1)
        y = 2.0 * torch.einsum("blp,dp->bld", hseq, Cmat).real + x * Dskip[None, None, :]
        return y

    def _B_ref(x, wq, wk, wv, wo):
        B, S, D = x.shape
        H = 32
        Dh = D // H
        q = (lambda x, *d: x.permute(*d))((x @ wq).reshape(B, S, H, Dh), 0, 2, 1, 3)
        k = x @ wk
        v = x @ wv
        scores = torch.einsum("bhqd,bkd->bhqk", q, k) * (Dh ** -0.5)
        p = _softmax(scores, axis=-1)
        o = torch.einsum("bhqk,bkd->bhqd", p, v)
        return (lambda x, *d: x.permute(*d))(o, 0, 2, 1, 3).reshape(B, S, H * Dh) @ wo

    a = _A_ref(A_x, A_Lambda_re, A_Lambda_im, A_B_re, A_B_im, A_C_re, A_C_im, A_log_dt, A_Dskip)
    b = _B_ref(B_x, B_wq, B_wk, B_wv, B_wo)
    return torch.concatenate([a, b], axis=-1)
```

```asm
; @launch kernel=k1_kernel grid=(256,1,1) block=(256,1,1) lds=163840
; @launch kernel=k2_kernel grid=(256,1,1) block=(768,1,1) lds=88192
; @launch kernel=k3_kernel grid=(256,1,1) block=(256,1,1) lds=163840
.amdgcn_target "amdgcn-amd-amdhsa--gfx950"
.text
.globl k1_kernel
.p2align 8
.type k1_kernel,@function
k1_kernel:
    s_cmp_ge_u32 s2, 256
    s_cbranch_scc1 L_k1_end
    s_load_dwordx16 s[16:31], s[0:1], 0
    s_load_dwordx16 s[32:47], s[0:1], 64
    s_load_dwordx2 s[48:49], s[0:1], 128
    s_bfe_u32 s15, s2, 0x50003
    s_getpc_b64 s[12:13]
Lpc_1:
    s_add_u32 s12, s12, k1_kernel-Lpc_1
    s_addc_u32 s13, s13, -1
    s_mul_i32 s14, s15, 2048
    v_lshlrev_b32 v254, 3, v0
    v_add_u32 v254, s14, v254
    v_min_u32 v254, L_code_end-k1_kernel-4, v254
    global_load_dword v255, v254, s[12:13]
    v_and_b32 v1, 63, v0
    v_lshrrev_b32 v2, 6, v0
    s_and_b32 s6, s2, 1
    v_readfirstlane_b32 s5, v2
    s_bfe_u32 s7, s2, 0x20003
    s_lshr_b32 s8, s2, 5
    s_bfe_u32 s3, s2, 0x20001
    s_lshl_b32 s3, s3, 2
    s_add_u32 s3, s3, s7
    s_add_u32 s51, s7, s8
    s_lshl_b32 s51, s51, 1
    s_sub_u32 s9, s51, 9
    s_min_u32 s51, s51, s9
    s_sub_u32 s9, s51, 9
    s_min_u32 s51, s51, s9
    s_lshl_b32 s51, s51, 7
    s_mul_i32 s4, s6, 5
    s_add_u32 s4, s4, s8
    s_sub_u32 s7, 5, s6
    s_cmp_lt_u32 s8, s7
    s_cbranch_scc1 L_k1_ssm
    s_sub_u32 s8, s8, s7
    s_cmp_eq_u32 s8, 3
    s_cbranch_scc1 L_k1_kv
    s_mul_i32 s4, s6, 3
    s_add_u32 s4, s4, s8
    s_lshl_b32 s6, s3, 7
    s_lshl_b32 s7, s5, 5
    s_add_u32 s6, s6, s7
    v_lshrrev_b32 v3, 4, v1
    v_and_b32 v2, 7, v1
    v_xor_b32 v2, v2, v3
    v_lshlrev_b32 v2, 4, v2
    v_lshrrev_b32 v5, 4, v1
    v_xor_b32 v5, 4, v5
    v_and_b32 v4, 7, v1
    v_xor_b32 v4, v4, v5
    v_lshlrev_b32 v4, 4, v4
    v_lshrrev_b32 v6, 3, v1
    v_add_u32 v6, s6, v6
    v_mul_u32_u24 v6, 1152, v6
    v_add_u32 v7, v6, v2
    v_add_u32 v8, v6, v4
    v_add_u32 v8, 8192, v8
    v_add_u32 v9, v6, v2
    v_add_u32 v9, 16384, v9
    v_add_u32 v10, v6, v4
    v_add_u32 v10, 24576, v10
    s_mul_i32 s7, s4, 192
    s_mul_i32 s8, s5, 192
    v_add_u32 v11, s8, v1
    v_mul_u32_u24 v12, 43691, v11
    v_lshrrev_b32 v12, 19, v12
    v_mul_u32_u24 v13, 12, v12
    v_sub_u32 v13, v11, v13
    v_mul_u32_u24 v14, 1152, v12
    v_lshl_add_u32 v14, v13, 4, v14
    v_add_u32 v14, s7, v14
    v_add_u32 v11, s8, v1
    v_add_u32 v11, 64, v11
    v_mul_u32_u24 v12, 43691, v11
    v_lshrrev_b32 v12, 19, v12
    v_mul_u32_u24 v13, 12, v12
    v_sub_u32 v13, v11, v13
    v_mul_u32_u24 v15, 1152, v12
    v_lshl_add_u32 v15, v13, 4, v15
    v_add_u32 v15, s7, v15
    v_subrev_u32 v15, 1024, v15
    v_add_u32 v11, s8, v1
    v_add_u32 v11, 128, v11
    v_mul_u32_u24 v12, 43691, v11
    v_lshrrev_b32 v12, 19, v12
    v_mul_u32_u24 v13, 12, v12
    v_sub_u32 v13, v11, v13
    v_mul_u32_u24 v16, 1152, v12
    v_lshl_add_u32 v16, v13, 4, v16
    v_add_u32 v16, s7, v16
    v_subrev_u32 v16, 2048, v16
    s_lshl_b32 s10, s5, 12
    s_mul_i32 s11, s5, 3072
    s_add_u32 s11, s11, 16384
    s_waitcnt lgkmcnt(0)
    s_mov_b32 s52, s34
    s_mov_b32 s53, s35
    s_mov_b32 s54, 0x240000
    s_mov_b32 s55, 0x00020000
    s_mov_b32 s56, s36
    s_mov_b32 s57, s37
    s_mov_b32 s58, 0xa2000
    s_mov_b32 s59, 0x00020000
    s_mov_b32 s60, s48
    s_mov_b32 s61, s49
    s_mov_b32 s62, 0x240000
    s_mov_b32 s63, 0x00020000
    s_add_u32 m0, s10, 0
    s_add_u32 s51, s51, 128
    s_sub_u32 s9, s51, 1152
    s_min_u32 s51, s51, s9
    buffer_load_dwordx4 v7, s[52:55], s51 offen lds
    buffer_load_dwordx4 v8, s[52:55], s51 offen offset:1024 lds
    buffer_load_dwordx4 v9, s[52:55], s51 offen offset:2048 lds
    buffer_load_dwordx4 v10, s[52:55], s51 offen offset:3072 lds
    s_add_u32 m0, s11, 0
    s_mul_i32 s9, s51, 576
    buffer_load_dwordx4 v14, s[56:59], s9 offen lds
    buffer_load_dwordx4 v15, s[56:59], s9 offen offset:1024 lds
    buffer_load_dwordx4 v16, s[56:59], s9 offen offset:2048 lds
    s_add_u32 m0, s10, 28672
    s_add_u32 s51, s51, 128
    s_sub_u32 s9, s51, 1152
    s_min_u32 s51, s51, s9
    buffer_load_dwordx4 v7, s[52:55], s51 offen lds
    buffer_load_dwordx4 v8, s[52:55], s51 offen offset:1024 lds
    buffer_load_dwordx4 v9, s[52:55], s51 offen offset:2048 lds
    buffer_load_dwordx4 v10, s[52:55], s51 offen offset:3072 lds
    s_add_u32 m0, s11, 28672
    s_mul_i32 s9, s51, 576
    buffer_load_dwordx4 v14, s[56:59], s9 offen lds
    buffer_load_dwordx4 v15, s[56:59], s9 offen offset:1024 lds
    buffer_load_dwordx4 v16, s[56:59], s9 offen offset:2048 lds
    v_and_b32 v17, 31, v1
    v_bfe_u32 v18, v1, 1, 3
    v_lshrrev_b32 v19, 5, v1
    v_xor_b32 v18, v18, v19
    v_lshlrev_b32 v18, 4, v18
    v_lshl_add_u32 v19, v17, 7, v18
    v_add_u32 v19, s10, v19
    v_add_u32 v20, 0x10000, v19
    v_add_u32 v21, 0x20000, v19
    v_xor_b32 v22, 32, v19
    v_add_u32 v23, 0x10000, v22
    v_add_u32 v24, 0x20000, v22
    v_xor_b32 v25, 64, v19
    v_add_u32 v26, 0x10000, v25
    v_add_u32 v27, 0x20000, v25
    v_xor_b32 v28, 96, v19
    v_add_u32 v29, 0x10000, v28
    v_add_u32 v30, 0x20000, v28
    v_bfe_u32 v31, v1, 2, 2
    v_lshrrev_b32 v33, 5, v1
    v_lshl_add_u32 v33, v33, 3, v31
    v_mul_u32_u24 v34, 192, v33
    v_and_b32 v32, 1, v1
    v_lshl_add_u32 v34, v32, 5, v34
    v_bfe_u32 v32, v1, 4, 1
    v_lshl_add_u32 v34, v32, 4, v34
    v_bfe_u32 v32, v1, 1, 1
    v_lshl_add_u32 v34, v32, 3, v34
    v_add_u32 v35, 0x10000, v34
    v_add_u32 v36, 0x20000, v34
    s_mul_i32 s8, s5, 6656
    s_movk_i32 s12, 208
    s_waitcnt vmcnt(7)
    s_barrier
    ds_read_b128 v[40:43], v19 offset:0
    ds_read_b64_tr_b16 v[44:45], v34 offset:16384
    ds_read_b64_tr_b16 v[46:47], v34 offset:17152
    ds_read_b64_tr_b16 v[48:49], v34 offset:16448
    ds_read_b64_tr_b16 v[50:51], v34 offset:17216
    ds_read_b64_tr_b16 v[52:53], v34 offset:16512
    ds_read_b64_tr_b16 v[54:55], v34 offset:17280
    ds_read_b128 v[56:59], v22 offset:0
    ds_read_b64_tr_b16 v[60:61], v34 offset:19456
    ds_read_b64_tr_b16 v[62:63], v34 offset:20224
    ds_read_b64_tr_b16 v[64:65], v34 offset:19520
    ds_read_b64_tr_b16 v[66:67], v34 offset:20288
    ds_read_b64_tr_b16 v[68:69], v34 offset:19584
    ds_read_b64_tr_b16 v[70:71], v34 offset:20352
    ds_read_b128 v[72:75], v25 offset:0
    ds_read_b64_tr_b16 v[76:77], v34 offset:22528
    ds_read_b64_tr_b16 v[78:79], v34 offset:23296
    ds_read_b64_tr_b16 v[80:81], v34 offset:22592
    ds_read_b64_tr_b16 v[82:83], v34 offset:23360
    ds_read_b64_tr_b16 v[84:85], v34 offset:22656
    ds_read_b64_tr_b16 v[86:87], v34 offset:23424
    s_waitcnt lgkmcnt(14)
    v_mfma_f32_32x32x16_bf16 v[88:103], v[44:47], v[40:43], 0
    s_add_u32 m0, s10, 57344
    s_add_u32 s51, s51, 128
    s_sub_u32 s9, s51, 1152
    s_min_u32 s51, s51, s9
    buffer_load_dwordx4 v7, s[52:55], s51 offen lds
    v_mfma_f32_32x32x16_bf16 v[104:119], v[48:51], v[40:43], 0
    buffer_load_dwordx4 v8, s[52:55], s51 offen offset:1024 lds
    v_mfma_f32_32x32x16_bf16 v[120:135], v[52:55], v[40:43], 0
    buffer_load_dwordx4 v9, s[52:55], s51 offen offset:2048 lds
    ds_read_b128 v[40:43], v28 offset:0
    ds_read_b64_tr_b16 v[44:45], v34 offset:25600
    ds_read_b64_tr_b16 v[46:47], v34 offset:26368
    ds_read_b64_tr_b16 v[48:49], v34 offset:25664
    ds_read_b64_tr_b16 v[50:51], v34 offset:26432
    ds_read_b64_tr_b16 v[52:53], v34 offset:25728
    ds_read_b64_tr_b16 v[54:55], v34 offset:26496
    s_waitcnt lgkmcnt(14)
    v_mfma_f32_32x32x16_bf16 v[88:103], v[60:63], v[56:59], v[88:103]
    buffer_load_dwordx4 v10, s[52:55], s51 offen offset:3072 lds
    v_mfma_f32_32x32x16_bf16 v[104:119], v[64:67], v[56:59], v[104:119]
    s_add_u32 m0, s11, 57344
    s_mul_i32 s9, s51, 576
    buffer_load_dwordx4 v14, s[56:59], s9 offen lds
    v_mfma_f32_32x32x16_bf16 v[120:135], v[68:71], v[56:59], v[120:135]
    buffer_load_dwordx4 v15, s[56:59], s9 offen offset:1024 lds
    s_waitcnt vmcnt(6) lgkmcnt(0)
    s_barrier
    ds_read_b128 v[56:59], v19 offset:28672
    ds_read_b64_tr_b16 v[60:61], v34 offset:45056
    ds_read_b64_tr_b16 v[62:63], v34 offset:45824
    ds_read_b64_tr_b16 v[64:65], v34 offset:45120
    ds_read_b64_tr_b16 v[66:67], v34 offset:45888
    ds_read_b64_tr_b16 v[68:69], v34 offset:45184
    ds_read_b64_tr_b16 v[70:71], v34 offset:45952
    v_mfma_f32_32x32x16_bf16 v[88:103], v[76:79], v[72:75], v[88:103]
    buffer_load_dwordx4 v16, s[56:59], s9 offen offset:2048 lds
    v_mfma_f32_32x32x16_bf16 v[104:119], v[80:83], v[72:75], v[104:119]
    s_add_u32 m0, s10, 86016
    s_add_u32 s51, s51, 128
    s_sub_u32 s9, s51, 1152
    s_min_u32 s51, s51, s9
    buffer_load_dwordx4 v7, s[52:55], s51 offen lds
    v_mfma_f32_32x32x16_bf16 v[120:135], v[84:87], v[72:75], v[120:135]
    buffer_load_dwordx4 v8, s[52:55], s51 offen offset:1024 lds
    ds_read_b128 v[72:75], v22 offset:28672
    ds_read_b64_tr_b16 v[76:77], v34 offset:48128
    ds_read_b64_tr_b16 v[78:79], v34 offset:48896
    ds_read_b64_tr_b16 v[80:81], v34 offset:48192
    ds_read_b64_tr_b16 v[82:83], v34 offset:48960
    ds_read_b64_tr_b16 v[84:85], v34 offset:48256
    ds_read_b64_tr_b16 v[86:87], v34 offset:49024
    v_mfma_f32_32x32x16_bf16 v[88:103], v[44:47], v[40:43], v[88:103]
    buffer_load_dwordx4 v9, s[52:55], s51 offen offset:2048 lds
    v_mfma_f32_32x32x16_bf16 v[104:119], v[48:51], v[40:43], v[104:119]
    buffer_load_dwordx4 v10, s[52:55], s51 offen offset:3072 lds
    v_mfma_f32_32x32x16_bf16 v[120:135], v[52:55], v[40:43], v[120:135]
    s_add_u32 m0, s11, 86016
    s_mul_i32 s9, s51, 576
    buffer_load_dwordx4 v14, s[56:59], s9 offen lds
    ds_read_b128 v[40:43], v25 offset:28672
    ds_read_b64_tr_b16 v[44:45], v34 offset:51200
    ds_read_b64_tr_b16 v[46:47], v34 offset:51968
    ds_read_b64_tr_b16 v[48:49], v34 offset:51264
    ds_read_b64_tr_b16 v[50:51], v34 offset:52032
    ds_read_b64_tr_b16 v[52:53], v34 offset:51328
    ds_read_b64_tr_b16 v[54:55], v34 offset:52096
    s_waitcnt lgkmcnt(14)
    v_mfma_f32_32x32x16_bf16 v[88:103], v[60:63], v[56:59], v[88:103]
    buffer_load_dwordx4 v15, s[56:59], s9 offen offset:1024 lds
    v_and_b32 v136, 31, v1
    v_mfma_f32_32x32x16_bf16 v[104:119], v[64:67], v[56:59], v[104:119]
    buffer_load_dwordx4 v16, s[56:59], s9 offen offset:2048 lds
    v_mul_u32_u24 v136, 208, v136
    v_mfma_f32_32x32x16_bf16 v[120:135], v[68:71], v[56:59], v[120:135]
    s_add_u32 m0, s10, 114688
    s_add_u32 s51, s51, 128
    s_sub_u32 s9, s51, 1152
    s_min_u32 s51, s51, s9
    buffer_load_dwordx4 v7, s[52:55], s51 offen lds
    v_lshrrev_b32 v137, 5, v1
    ds_read_b128 v[56:59], v28 offset:28672
    ds_read_b64_tr_b16 v[60:61], v34 offset:54272
    ds_read_b64_tr_b16 v[62:63], v34 offset:55040
    ds_read_b64_tr_b16 v[64:65], v34 offset:54336
    ds_read_b64_tr_b16 v[66:67], v34 offset:55104
    ds_read_b64_tr_b16 v[68:69], v34 offset:54400
    ds_read_b64_tr_b16 v[70:71], v34 offset:55168
    s_waitcnt lgkmcnt(14)
    v_mfma_f32_32x32x16_bf16 v[88:103], v[76:79], v[72:75], v[88:103]
    buffer_load_dwordx4 v8, s[52:55], s51 offen offset:1024 lds
    v_lshl_add_u32 v136, v137, 5, v136
    v_mfma_f32_32x32x16_bf16 v[104:119], v[80:83], v[72:75], v[104:119]
    buffer_load_dwordx4 v9, s[52:55], s51 offen offset:2048 lds
    v_add_u32 v136, s8, v136
    v_mfma_f32_32x32x16_bf16 v[120:135], v[84:87], v[72:75], v[120:135]
    buffer_load_dwordx4 v10, s[52:55], s51 offen offset:3072 lds
    v_add_u32 v137, 0, v1
    s_waitcnt vmcnt(11) lgkmcnt(0)
    s_barrier
    ds_read_b128 v[72:75], v19 offset:57344
    ds_read_b64_tr_b16 v[76:77], v35 offset:8192
    ds_read_b64_tr_b16 v[78:79], v35 offset:8960
    ds_read_b64_tr_b16 v[80:81], v35 offset:8256
    ds_read_b64_tr_b16 v[82:83], v35 offset:9024
    ds_read_b64_tr_b16 v[84:85], v35 offset:8320
    ds_read_b64_tr_b16 v[86:87], v35 offset:9088
    v_mfma_f32_32x32x16_bf16 v[88:103], v[44:47], v[40:43], v[88:103]
    s_add_u32 m0, s11, 114688
    s_mul_i32 s9, s51, 576
    buffer_load_dwordx4 v14, s[56:59], s9 offen lds
    v_mul_u32_u24 v138, 43691, v137
    v_mfma_f32_32x32x16_bf16 v[104:119], v[48:51], v[40:43], v[104:119]
    buffer_load_dwordx4 v15, s[56:59], s9 offen offset:1024 lds
    v_lshrrev_b32 v138, 19, v138
    v_mfma_f32_32x32x16_bf16 v[120:135], v[52:55], v[40:43], v[120:135]
    buffer_load_dwordx4 v16, s[56:59], s9 offen offset:2048 lds
    v_mul_u32_u24 v139, 12, v138
    ds_read_b128 v[40:43], v22 offset:57344
    ds_read_b64_tr_b16 v[44:45], v35 offset:11264
    ds_read_b64_tr_b16 v[46:47], v35 offset:12032
    ds_read_b64_tr_b16 v[48:49], v35 offset:11328
    ds_read_b64_tr_b16 v[50:51], v35 offset:12096
    ds_read_b64_tr_b16 v[52:53], v35 offset:11392
    ds_read_b64_tr_b16 v[54:55], v35 offset:12160
    v_mfma_f32_32x32x16_bf16 v[88:103], v[60:63], v[56:59], v[88:103]
    s_add_u32 m0, s10, 0
    s_add_u32 s51, s51, 128
    s_sub_u32 s9, s51, 1152
    s_min_u32 s51, s51, s9
    buffer_load_dwordx4 v7, s[52:55], s51 offen lds
    v_sub_u32 v139, v137, v139
    v_mfma_f32_32x32x16_bf16 v[104:119], v[64:67], v[56:59], v[104:119]
    buffer_load_dwordx4 v8, s[52:55], s51 offen offset:1024 lds
    v_lshlrev_b32 v139, 4, v139
    v_mfma_f32_32x32x16_bf16 v[120:135], v[68:71], v[56:59], v[120:135]
    buffer_load_dwordx4 v9, s[52:55], s51 offen offset:2048 lds
    v_mad_u32_u24 v140, v138, s12, v139
    ds_read_b128 v[56:59], v25 offset:57344
    ds_read_b64_tr_b16 v[60:61], v35 offset:14336
    ds_read_b64_tr_b16 v[62:63], v35 offset:15104
    ds_read_b64_tr_b16 v[64:65], v35 offset:14400
    ds_read_b64_tr_b16 v[66:67], v35 offset:15168
    ds_read_b64_tr_b16 v[68:69], v35 offset:14464
    ds_read_b64_tr_b16 v[70:71], v35 offset:15232
    s_waitcnt lgkmcnt(14)
    v_mfma_f32_32x32x16_bf16 v[88:103], v[76:79], v[72:75], v[88:103]
    buffer_load_dwordx4 v10, s[52:55], s51 offen offset:3072 lds
    v_add_u32 v140, s8, v140
    v_mfma_f32_32x32x16_bf16 v[104:119], v[80:83], v[72:75], v[104:119]
    s_add_u32 m0, s11, 0
    s_mul_i32 s9, s51, 576
    buffer_load_dwordx4 v14, s[56:59], s9 offen lds
    v_add_u32 v138, s6, v138
    v_mfma_f32_32x32x16_bf16 v[120:135], v[84:87], v[72:75], v[120:135]
    buffer_load_dwordx4 v15, s[56:59], s9 offen offset:1024 lds
    v_mul_u32_u24 v138, 1152, v138
    ds_read_b128 v[72:75], v28 offset:57344
    ds_read_b64_tr_b16 v[76:77], v35 offset:17408
    ds_read_b64_tr_b16 v[78:79], v35 offset:18176
    ds_read_b64_tr_b16 v[80:81], v35 offset:17472
    ds_read_b64_tr_b16 v[82:83], v35 offset:18240
    ds_read_b64_tr_b16 v[84:85], v35 offset:17536
    ds_read_b64_tr_b16 v[86:87], v35 offset:18304
    s_waitcnt lgkmcnt(14)
    v_mfma_f32_32x32x16_bf16 v[88:103], v[44:47], v[40:43], v[88:103]
    buffer_load_dwordx4 v16, s[56:59], s9 offen offset:2048 lds
    v_add3_u32 v141, v138, v139, s7
    v_mfma_f32_32x32x16_bf16 v[104:119], v[48:51], v[40:43], v[104:119]
    s_add_u32 m0, s10, 28672
    s_add_u32 s51, s51, 128
    s_sub_u32 s9, s51, 1152
    s_min_u32 s51, s51, s9
    buffer_load_dwordx4 v7, s[52:55], s51 offen lds
    v_add_u32 v137, 64, v1
    v_mfma_f32_32x32x16_bf16 v[120:135], v[52:55], v[40:43], v[120:135]
    buffer_load_dwordx4 v8, s[52:55], s51 offen offset:1024 lds
    v_mul_u32_u24 v138, 43691, v137
    s_waitcnt vmcnt(16) lgkmcnt(0)
    s_barrier
    ds_read_b128 v[40:43], v20 offset:20480
    ds_read_b64_tr_b16 v[44:45], v35 offset:36864
    ds_read_b64_tr_b16 v[46:47], v35 offset:37632
    ds_read_b64_tr_b16 v[48:49], v35 offset:36928
    ds_read_b64_tr_b16 v[50:51], v35 offset:37696
    ds_read_b64_tr_b16 v[52:53], v35 offset:36992
    ds_read_b64_tr_b16 v[54:55], v35 offset:37760
    v_mfma_f32_32x32x16_bf16 v[88:103], v[60:63], v[56:59], v[88:103]
    buffer_load_dwordx4 v9, s[52:55], s51 offen offset:2048 lds
    v_lshrrev_b32 v138, 19, v138
    v_mfma_f32_32x32x16_bf16 v[104:119], v[64:67], v[56:59], v[104:119]
    buffer_load_dwordx4 v10, s[52:55], s51 offen offset:3072 lds
    v_mul_u32_u24 v139, 12, v138
    v_mfma_f32_32x32x16_bf16 v[120:135], v[68:71], v[56:59], v[120:135]
    s_add_u32 m0, s11, 28672
    s_mul_i32 s9, s51, 576
    buffer_load_dwordx4 v14, s[56:59], s9 offen lds
    v_sub_u32 v139, v137, v139
    ds_read_b128 v[56:59], v23 offset:20480
    ds_read_b64_tr_b16 v[60:61], v35 offset:39936
    ds_read_b64_tr_b16 v[62:63], v35 offset:40704
    ds_read_b64_tr_b16 v[64:65], v35 offset:40000
    ds_read_b64_tr_b16 v[66:67], v35 offset:40768
    ds_read_b64_tr_b16 v[68:69], v35 offset:40064
    ds_read_b64_tr_b16 v[70:71], v35 offset:40832
    v_mfma_f32_32x32x16_bf16 v[88:103], v[76:79], v[72:75], v[88:103]
    buffer_load_dwordx4 v15, s[56:59], s9 offen offset:1024 lds
    v_lshlrev_b32 v139, 4, v139
    v_mfma_f32_32x32x16_bf16 v[104:119], v[80:83], v[72:75], v[104:119]
    buffer_load_dwordx4 v16, s[56:59], s9 offen offset:2048 lds
    v_mad_u32_u24 v142, v138, s12, v139
    v_mfma_f32_32x32x16_bf16 v[120:135], v[84:87], v[72:75], v[120:135]
    s_add_u32 m0, s10, 57344
    s_add_u32 s51, s51, 128
    s_sub_u32 s9, s51, 1152
    s_min_u32 s51, s51, s9
    buffer_load_dwordx4 v7, s[52:55], s51 offen lds
    v_add_u32 v142, s8, v142
    ds_read_b128 v[72:75], v26 offset:20480
    ds_read_b64_tr_b16 v[76:77], v35 offset:43008
    ds_read_b64_tr_b16 v[78:79], v35 offset:43776
    ds_read_b64_tr_b16 v[80:81], v35 offset:43072
    ds_read_b64_tr_b16 v[82:83], v35 offset:43840
    ds_read_b64_tr_b16 v[84:85], v35 offset:43136
    ds_read_b64_tr_b16 v[86:87], v35 offset:43904
    s_waitcnt lgkmcnt(14)
    v_mfma_f32_32x32x16_bf16 v[88:103], v[44:47], v[40:43], v[88:103]
    buffer_load_dwordx4 v8, s[52:55], s51 offen offset:1024 lds
    v_add_u32 v138, s6, v138
    v_mfma_f32_32x32x16_bf16 v[104:119], v[48:51], v[40:43], v[104:119]
    buffer_load_dwordx4 v9, s[52:55], s51 offen offset:2048 lds
    v_mul_u32_u24 v138, 1152, v138
    v_mfma_f32_32x32x16_bf16 v[120:135], v[52:55], v[40:43], v[120:135]
    buffer_load_dwordx4 v10, s[52:55], s51 offen offset:3072 lds
    v_add3_u32 v143, v138, v139, s7
    ds_read_b128 v[40:43], v29 offset:20480
    ds_read_b64_tr_b16 v[44:45], v35 offset:46080
    ds_read_b64_tr_b16 v[46:47], v35 offset:46848
    ds_read_b64_tr_b16 v[48:49], v35 offset:46144
    ds_read_b64_tr_b16 v[50:51], v35 offset:46912
    ds_read_b64_tr_b16 v[52:53], v35 offset:46208
    ds_read_b64_tr_b16 v[54:55], v35 offset:46976
    s_waitcnt lgkmcnt(14)
    v_mfma_f32_32x32x16_bf16 v[88:103], v[60:63], v[56:59], v[88:103]
    s_add_u32 m0, s11, 57344
    s_mul_i32 s9, s51, 576
    buffer_load_dwordx4 v14, s[56:59], s9 offen lds
    v_add_u32 v137, 128, v1
    v_mfma_f32_32x32x16_bf16 v[104:119], v[64:67], v[56:59], v[104:119]
    buffer_load_dwordx4 v15, s[56:59], s9 offen offset:1024 lds
    v_mul_u32_u24 v138, 43691, v137
    v_mfma_f32_32x32x16_bf16 v[120:135], v[68:71], v[56:59], v[120:135]
    buffer_load_dwordx4 v16, s[56:59], s9 offen offset:2048 lds
    v_lshrrev_b32 v138, 19, v138
    s_waitcnt vmcnt(21) lgkmcnt(0)
    s_barrier
    ds_read_b128 v[56:59], v20 offset:49152
    ds_read_b64_tr_b16 v[60:61], v36 offset:0
    ds_read_b64_tr_b16 v[62:63], v36 offset:768
    ds_read_b64_tr_b16 v[64:65], v36 offset:64
    ds_read_b64_tr_b16 v[66:67], v36 offset:832
    ds_read_b64_tr_b16 v[68:69], v36 offset:128
    ds_read_b64_tr_b16 v[70:71], v36 offset:896
    v_mfma_f32_32x32x16_bf16 v[88:103], v[76:79], v[72:75], v[88:103]
    s_add_u32 m0, s10, 86016
    s_add_u32 s51, s51, 128
    s_sub_u32 s9, s51, 1152
    s_min_u32 s51, s51, s9
    buffer_load_dwordx4 v7, s[52:55], s51 offen lds
    v_mul_u32_u24 v139, 12, v138
    v_mfma_f32_32x32x16_bf16 v[104:119], v[80:83], v[72:75], v[104:119]
    buffer_load_dwordx4 v8, s[52:55], s51 offen offset:1024 lds
    v_sub_u32 v139, v137, v139
    v_mfma_f32_32x32x16_bf16 v[120:135], v[84:87], v[72:75], v[120:135]
    buffer_load_dwordx4 v9, s[52:55], s51 offen offset:2048 lds
    v_lshlrev_b32 v139, 4, v139
    ds_read_b128 v[72:75], v23 offset:49152
    ds_read_b64_tr_b16 v[76:77], v36 offset:3072
    ds_read_b64_tr_b16 v[78:79], v36 offset:3840
    ds_read_b64_tr_b16 v[80:81], v36 offset:3136
    ds_read_b64_tr_b16 v[82:83], v36 offset:3904
    ds_read_b64_tr_b16 v[84:85], v36 offset:3200
    ds_read_b64_tr_b16 v[86:87], v36 offset:3968
    v_mfma_f32_32x32x16_bf16 v[88:103], v[44:47], v[40:43], v[88:103]
    buffer_load_dwordx4 v10, s[52:55], s51 offen offset:3072 lds
    v_mad_u32_u24 v144, v138, s12, v139
    v_mfma_f32_32x32x16_bf16 v[104:119], v[48:51], v[40:43], v[104:119]
    s_add_u32 m0, s11, 86016
    s_mul_i32 s9, s51, 576
    buffer_load_dwordx4 v14, s[56:59], s9 offen lds
    v_add_u32 v144, s8, v144
    v_mfma_f32_32x32x16_bf16 v[120:135], v[52:55], v[40:43], v[120:135]
    buffer_load_dwordx4 v15, s[56:59], s9 offen offset:1024 lds
    v_add_u32 v138, s6, v138
    ds_read_b128 v[40:43], v26 offset:49152
    ds_read_b64_tr_b16 v[44:45], v36 offset:6144
    ds_read_b64_tr_b16 v[46:47], v36 offset:6912
    ds_read_b64_tr_b16 v[48:49], v36 offset:6208
    ds_read_b64_tr_b16 v[50:51], v36 offset:6976
    ds_read_b64_tr_b16 v[52:53], v36 offset:6272
    ds_read_b64_tr_b16 v[54:55], v36 offset:7040
    s_waitcnt lgkmcnt(14)
    v_mfma_f32_32x32x16_bf16 v[88:103], v[60:63], v[56:59], v[88:103]
    buffer_load_dwordx4 v16, s[56:59], s9 offen offset:2048 lds
    v_mul_u32_u24 v138, 1152, v138
    v_mfma_f32_32x32x16_bf16 v[104:119], v[64:67], v[56:59], v[104:119]
    v_add3_u32 v145, v138, v139, s7
    v_mfma_f32_32x32x16_bf16 v[120:135], v[68:71], v[56:59], v[120:135]
    v_add_u32 v137, 192, v1
    ds_read_b128 v[56:59], v29 offset:49152
    ds_read_b64_tr_b16 v[60:61], v36 offset:9216
    ds_read_b64_tr_b16 v[62:63], v36 offset:9984
    ds_read_b64_tr_b16 v[64:65], v36 offset:9280
    ds_read_b64_tr_b16 v[66:67], v36 offset:10048
    ds_read_b64_tr_b16 v[68:69], v36 offset:9344
    ds_read_b64_tr_b16 v[70:71], v36 offset:10112
    s_waitcnt lgkmcnt(14)
    v_mfma_f32_32x32x16_bf16 v[88:103], v[76:79], v[72:75], v[88:103]
    v_mul_u32_u24 v138, 43691, v137
    v_mfma_f32_32x32x16_bf16 v[104:119], v[80:83], v[72:75], v[104:119]
    v_lshrrev_b32 v138, 19, v138
    v_mfma_f32_32x32x16_bf16 v[120:135], v[84:87], v[72:75], v[120:135]
    v_mul_u32_u24 v139, 12, v138
    s_waitcnt vmcnt(21) lgkmcnt(0)
    s_barrier
    ds_read_b128 v[72:75], v19 offset:0
    ds_read_b64_tr_b16 v[76:77], v34 offset:16384
    ds_read_b64_tr_b16 v[78:79], v34 offset:17152
    ds_read_b64_tr_b16 v[80:81], v34 offset:16448
    ds_read_b64_tr_b16 v[82:83], v34 offset:17216
    ds_read_b64_tr_b16 v[84:85], v34 offset:16512
    ds_read_b64_tr_b16 v[86:87], v34 offset:17280
    v_mfma_f32_32x32x16_bf16 v[88:103], v[44:47], v[40:43], v[88:103]
    v_sub_u32 v139, v137, v139
    v_mfma_f32_32x32x16_bf16 v[104:119], v[48:51], v[40:43], v[104:119]
    v_lshlrev_b32 v139, 4, v139
    v_mfma_f32_32x32x16_bf16 v[120:135], v[52:55], v[40:43], v[120:135]
    v_mad_u32_u24 v146, v138, s12, v139
    ds_read_b128 v[40:43], v22 offset:0
    ds_read_b64_tr_b16 v[44:45], v34 offset:19456
    ds_read_b64_tr_b16 v[46:47], v34 offset:20224
    ds_read_b64_tr_b16 v[48:49], v34 offset:19520
    ds_read_b64_tr_b16 v[50:51], v34 offset:20288
    ds_read_b64_tr_b16 v[52:53], v34 offset:19584
    ds_read_b64_tr_b16 v[54:55], v34 offset:20352
    v_mfma_f32_32x32x16_bf16 v[88:103], v[60:63], v[56:59], v[88:103]
    v_add_u32 v146, s8, v146
    v_mfma_f32_32x32x16_bf16 v[104:119], v[64:67], v[56:59], v[104:119]
    v_add_u32 v138, s6, v138
    v_mfma_f32_32x32x16_bf16 v[120:135], v[68:71], v[56:59], v[120:135]
    v_mul_u32_u24 v138, 1152, v138
    ds_read_b128 v[56:59], v25 offset:0
    ds_read_b64_tr_b16 v[60:61], v34 offset:22528
    ds_read_b64_tr_b16 v[62:63], v34 offset:23296
    ds_read_b64_tr_b16 v[64:65], v34 offset:22592
    ds_read_b64_tr_b16 v[66:67], v34 offset:23360
    ds_read_b64_tr_b16 v[68:69], v34 offset:22656
    ds_read_b64_tr_b16 v[70:71], v34 offset:23424
    s_waitcnt lgkmcnt(14)
    v_mfma_f32_32x32x16_bf16 v[88:103], v[76:79], v[72:75], v[88:103]
    v_add3_u32 v147, v138, v139, s7
    v_mfma_f32_32x32x16_bf16 v[104:119], v[80:83], v[72:75], v[104:119]
    v_add_u32 v137, 256, v1
    v_mfma_f32_32x32x16_bf16 v[120:135], v[84:87], v[72:75], v[120:135]
    v_mul_u32_u24 v138, 43691, v137
    ds_read_b128 v[72:75], v28 offset:0
    ds_read_b64_tr_b16 v[76:77], v34 offset:25600
    ds_read_b64_tr_b16 v[78:79], v34 offset:26368
    ds_read_b64_tr_b16 v[80:81], v34 offset:25664
    ds_read_b64_tr_b16 v[82:83], v34 offset:26432
    ds_read_b64_tr_b16 v[84:85], v34 offset:25728
    ds_read_b64_tr_b16 v[86:87], v34 offset:26496
    s_waitcnt lgkmcnt(14)
    v_mfma_f32_32x32x16_bf16 v[88:103], v[44:47], v[40:43], v[88:103]
    v_lshrrev_b32 v138, 19, v138
    v_mfma_f32_32x32x16_bf16 v[104:119], v[48:51], v[40:43], v[104:119]
    v_mul_u32_u24 v139, 12, v138
    v_mfma_f32_32x32x16_bf16 v[120:135], v[52:55], v[40:43], v[120:135]
    v_sub_u32 v139, v137, v139
    s_waitcnt vmcnt(14) lgkmcnt(0)
    s_barrier
    ds_read_b128 v[40:43], v19 offset:28672
    ds_read_b64_tr_b16 v[44:45], v34 offset:45056
    ds_read_b64_tr_b16 v[46:47], v34 offset:45824
    ds_read_b64_tr_b16 v[48:49], v34 offset:45120
    ds_read_b64_tr_b16 v[50:51], v34 offset:45888
    ds_read_b64_tr_b16 v[52:53], v34 offset:45184
    ds_read_b64_tr_b16 v[54:55], v34 offset:45952
    v_mfma_f32_32x32x16_bf16 v[88:103], v[60:63], v[56:59], v[88:103]
    v_lshlrev_b32 v139, 4, v139
    v_mfma_f32_32x32x16_bf16 v[104:119], v[64:67], v[56:59], v[104:119]
    v_mad_u32_u24 v148, v138, s12, v139
    v_mfma_f32_32x32x16_bf16 v[120:135], v[68:71], v[56:59], v[120:135]
    v_add_u32 v148, s8, v148
    ds_read_b128 v[56:59], v22 offset:28672
    ds_read_b64_tr_b16 v[60:61], v34 offset:48128
    ds_read_b64_tr_b16 v[62:63], v34 offset:48896
    ds_read_b64_tr_b16 v[64:65], v34 offset:48192
    ds_read_b64_tr_b16 v[66:67], v34 offset:48960
    ds_read_b64_tr_b16 v[68:69], v34 offset:48256
    ds_read_b64_tr_b16 v[70:71], v34 offset:49024
    v_mfma_f32_32x32x16_bf16 v[88:103], v[76:79], v[72:75], v[88:103]
    v_add_u32 v138, s6, v138
    v_mfma_f32_32x32x16_bf16 v[104:119], v[80:83], v[72:75], v[104:119]
    v_mul_u32_u24 v138, 1152, v138
    v_mfma_f32_32x32x16_bf16 v[120:135], v[84:87], v[72:75], v[120:135]
    v_add3_u32 v149, v138, v139, s7
    ds_read_b128 v[72:75], v25 offset:28672
    ds_read_b64_tr_b16 v[76:77], v34 offset:51200
    ds_read_b64_tr_b16 v[78:79], v34 offset:51968
    ds_read_b64_tr_b16 v[80:81], v34 offset:51264
    ds_read_b64_tr_b16 v[82:83], v34 offset:52032
    ds_read_b64_tr_b16 v[84:85], v34 offset:51328
    ds_read_b64_tr_b16 v[86:87], v34 offset:52096
    s_waitcnt lgkmcnt(14)
    v_mfma_f32_32x32x16_bf16 v[88:103], v[44:47], v[40:43], v[88:103]
    v_add_u32 v137, 320, v1
    v_mfma_f32_32x32x16_bf16 v[104:119], v[48:51], v[40:43], v[104:119]
    v_mul_u32_u24 v138, 43691, v137
    v_mfma_f32_32x32x16_bf16 v[120:135], v[52:55], v[40:43], v[120:135]
    v_lshrrev_b32 v138, 19, v138
    ds_read_b128 v[40:43], v28 offset:28672
    ds_read_b64_tr_b16 v[44:45], v34 offset:54272
    ds_read_b64_tr_b16 v[46:47], v34 offset:55040
    ds_read_b64_tr_b16 v[48:49], v34 offset:54336
    ds_read_b64_tr_b16 v[50:51], v34 offset:55104
    ds_read_b64_tr_b16 v[52:53], v34 offset:54400
    ds_read_b64_tr_b16 v[54:55], v34 offset:55168
    s_waitcnt lgkmcnt(14)
    v_mfma_f32_32x32x16_bf16 v[88:103], v[60:63], v[56:59], v[88:103]
    v_mul_u32_u24 v139, 12, v138
    v_mfma_f32_32x32x16_bf16 v[104:119], v[64:67], v[56:59], v[104:119]
    v_sub_u32 v139, v137, v139
    v_mfma_f32_32x32x16_bf16 v[120:135], v[68:71], v[56:59], v[120:135]
    v_lshlrev_b32 v139, 4, v139
    s_waitcnt vmcnt(7) lgkmcnt(0)
    s_barrier
    ds_read_b128 v[56:59], v19 offset:57344
    ds_read_b64_tr_b16 v[60:61], v35 offset:8192
    ds_read_b64_tr_b16 v[62:63], v35 offset:8960
    ds_read_b64_tr_b16 v[64:65], v35 offset:8256
    ds_read_b64_tr_b16 v[66:67], v35 offset:9024
    ds_read_b64_tr_b16 v[68:69], v35 offset:8320
    ds_read_b64_tr_b16 v[70:71], v35 offset:9088
    v_mfma_f32_32x32x16_bf16 v[88:103], v[76:79], v[72:75], v[88:103]
    v_mad_u32_u24 v150, v138, s12, v139
    v_mfma_f32_32x32x16_bf16 v[104:119], v[80:83], v[72:75], v[104:119]
    v_add_u32 v150, s8, v150
    v_mfma_f32_32x32x16_bf16 v[120:135], v[84:87], v[72:75], v[120:135]
    v_add_u32 v138, s6, v138
    ds_read_b128 v[72:75], v22 offset:57344
    ds_read_b64_tr_b16 v[76:77], v35 offset:11264
    ds_read_b64_tr_b16 v[78:79], v35 offset:12032
    ds_read_b64_tr_b16 v[80:81], v35 offset:11328
    ds_read_b64_tr_b16 v[82:83], v35 offset:12096
    ds_read_b64_tr_b16 v[84:85], v35 offset:11392
    ds_read_b64_tr_b16 v[86:87], v35 offset:12160
    v_mfma_f32_32x32x16_bf16 v[88:103], v[44:47], v[40:43], v[88:103]
    v_mul_u32_u24 v138, 1152, v138
    v_mfma_f32_32x32x16_bf16 v[104:119], v[48:51], v[40:43], v[104:119]
    v_add3_u32 v151, v138, v139, s7
    v_mfma_f32_32x32x16_bf16 v[120:135], v[52:55], v[40:43], v[120:135]
    ds_read_b128 v[40:43], v25 offset:57344
    ds_read_b64_tr_b16 v[44:45], v35 offset:14336
    ds_read_b64_tr_b16 v[46:47], v35 offset:15104
    ds_read_b64_tr_b16 v[48:49], v35 offset:14400
    ds_read_b64_tr_b16 v[50:51], v35 offset:15168
    ds_read_b64_tr_b16 v[52:53], v35 offset:14464
    ds_read_b64_tr_b16 v[54:55], v35 offset:15232
    s_waitcnt lgkmcnt(14)
    v_mfma_f32_32x32x16_bf16 v[88:103], v[60:63], v[56:59], v[88:103]
    v_mfma_f32_32x32x16_bf16 v[104:119], v[64:67], v[56:59], v[104:119]
    v_mfma_f32_32x32x16_bf16 v[120:135], v[68:71], v[56:59], v[120:135]
    ds_read_b128 v[56:59], v28 offset:57344
    ds_read_b64_tr_b16 v[60:61], v35 offset:17408
    ds_read_b64_tr_b16 v[62:63], v35 offset:18176
    ds_read_b64_tr_b16 v[64:65], v35 offset:17472
    ds_read_b64_tr_b16 v[66:67], v35 offset:18240
    ds_read_b64_tr_b16 v[68:69], v35 offset:17536
    ds_read_b64_tr_b16 v[70:71], v35 offset:18304
    s_waitcnt lgkmcnt(14)
    v_mfma_f32_32x32x16_bf16 v[88:103], v[76:79], v[72:75], v[88:103]
    v_mfma_f32_32x32x16_bf16 v[104:119], v[80:83], v[72:75], v[104:119]
    v_mfma_f32_32x32x16_bf16 v[120:135], v[84:87], v[72:75], v[120:135]
    s_waitcnt vmcnt(0) lgkmcnt(0)
    s_barrier
    ds_read_b128 v[72:75], v20 offset:20480
    ds_read_b64_tr_b16 v[76:77], v35 offset:36864
    ds_read_b64_tr_b16 v[78:79], v35 offset:37632
    ds_read_b64_tr_b16 v[80:81], v35 offset:36928
    ds_read_b64_tr_b16 v[82:83], v35 offset:37696
    ds_read_b64_tr_b16 v[84:85], v35 offset:36992
    ds_read_b64_tr_b16 v[86:87], v35 offset:37760
    v_mfma_f32_32x32x16_bf16 v[88:103], v[44:47], v[40:43], v[88:103]
    v_mfma_f32_32x32x16_bf16 v[104:119], v[48:51], v[40:43], v[104:119]
    v_mfma_f32_32x32x16_bf16 v[120:135], v[52:55], v[40:43], v[120:135]
    ds_read_b128 v[40:43], v23 offset:20480
    ds_read_b64_tr_b16 v[44:45], v35 offset:39936
    ds_read_b64_tr_b16 v[46:47], v35 offset:40704
    ds_read_b64_tr_b16 v[48:49], v35 offset:40000
    ds_read_b64_tr_b16 v[50:51], v35 offset:40768
    ds_read_b64_tr_b16 v[52:53], v35 offset:40064
    ds_read_b64_tr_b16 v[54:55], v35 offset:40832
    v_mfma_f32_32x32x16_bf16 v[88:103], v[60:63], v[56:59], v[88:103]
    v_mfma_f32_32x32x16_bf16 v[104:119], v[64:67], v[56:59], v[104:119]
    v_mfma_f32_32x32x16_bf16 v[120:135], v[68:71], v[56:59], v[120:135]
    ds_read_b128 v[56:59], v26 offset:20480
    ds_read_b64_tr_b16 v[60:61], v35 offset:43008
    ds_read_b64_tr_b16 v[62:63], v35 offset:43776
    ds_read_b64_tr_b16 v[64:65], v35 offset:43072
    ds_read_b64_tr_b16 v[66:67], v35 offset:43840
    ds_read_b64_tr_b16 v[68:69], v35 offset:43136
    ds_read_b64_tr_b16 v[70:71], v35 offset:43904
    s_waitcnt lgkmcnt(14)
    v_mfma_f32_32x32x16_bf16 v[88:103], v[76:79], v[72:75], v[88:103]
    v_mfma_f32_32x32x16_bf16 v[104:119], v[80:83], v[72:75], v[104:119]
    v_mfma_f32_32x32x16_bf16 v[120:135], v[84:87], v[72:75], v[120:135]
    ds_read_b128 v[72:75], v29 offset:20480
    ds_read_b64_tr_b16 v[76:77], v35 offset:46080
    ds_read_b64_tr_b16 v[78:79], v35 offset:46848
    ds_read_b64_tr_b16 v[80:81], v35 offset:46144
    ds_read_b64_tr_b16 v[82:83], v35 offset:46912
    ds_read_b64_tr_b16 v[84:85], v35 offset:46208
    ds_read_b64_tr_b16 v[86:87], v35 offset:46976
    s_waitcnt lgkmcnt(14)
    v_mfma_f32_32x32x16_bf16 v[88:103], v[44:47], v[40:43], v[88:103]
    v_mfma_f32_32x32x16_bf16 v[104:119], v[48:51], v[40:43], v[104:119]
    v_mfma_f32_32x32x16_bf16 v[120:135], v[52:55], v[40:43], v[120:135]
    s_waitcnt lgkmcnt(7)
    v_mfma_f32_32x32x16_bf16 v[88:103], v[60:63], v[56:59], v[88:103]
    v_mfma_f32_32x32x16_bf16 v[104:119], v[64:67], v[56:59], v[104:119]
    v_mfma_f32_32x32x16_bf16 v[120:135], v[68:71], v[56:59], v[120:135]
    s_waitcnt lgkmcnt(0)
    v_mfma_f32_32x32x16_bf16 v[88:103], v[76:79], v[72:75], v[88:103]
    v_mfma_f32_32x32x16_bf16 v[104:119], v[80:83], v[72:75], v[104:119]
    v_mfma_f32_32x32x16_bf16 v[120:135], v[84:87], v[72:75], v[120:135]
    s_nop 7
    s_nop 7
    s_mov_b32 s9, 0x3eae1a93
    v_mul_f32 v88, s9, v88
    v_mul_f32 v89, s9, v89
    v_mul_f32 v90, s9, v90
    v_mul_f32 v91, s9, v91
    v_mul_f32 v92, s9, v92
    v_mul_f32 v93, s9, v93
    v_mul_f32 v94, s9, v94
    v_mul_f32 v95, s9, v95
    v_mul_f32 v96, s9, v96
    v_mul_f32 v97, s9, v97
    v_mul_f32 v98, s9, v98
    v_mul_f32 v99, s9, v99
    v_mul_f32 v100, s9, v100
    v_mul_f32 v101, s9, v101
    v_mul_f32 v102, s9, v102
    v_mul_f32 v103, s9, v103
    v_cvt_pk_bf16_f32 v40, v88, v89
    v_cvt_pk_bf16_f32 v41, v90, v91
    v_cvt_pk_bf16_f32 v42, v92, v93
    v_cvt_pk_bf16_f32 v43, v94, v95
    v_cvt_pk_bf16_f32 v44, v96, v97
    v_cvt_pk_bf16_f32 v45, v98, v99
    v_cvt_pk_bf16_f32 v46, v100, v101
    v_cvt_pk_bf16_f32 v47, v102, v103
    ds_write_b128 v136, v[40:43] offset:0
    ds_write_b128 v136, v[44:47] offset:16
    v_mul_f32 v104, s9, v104
    v_mul_f32 v105, s9, v105
    v_mul_f32 v106, s9, v106
    v_mul_f32 v107, s9, v107
    v_mul_f32 v108, s9, v108
    v_mul_f32 v109, s9, v109
    v_mul_f32 v110, s9, v110
    v_mul_f32 v111, s9, v111
    v_mul_f32 v112, s9, v112
    v_mul_f32 v113, s9, v113
    v_mul_f32 v114, s9, v114
    v_mul_f32 v115, s9, v115
    v_mul_f32 v116, s9, v116
    v_mul_f32 v117, s9, v117
    v_mul_f32 v118, s9, v118
    v_mul_f32 v119, s9, v119
    v_cvt_pk_bf16_f32 v48, v104, v105
    v_cvt_pk_bf16_f32 v49, v106, v107
    v_cvt_pk_bf16_f32 v50, v108, v109
    v_cvt_pk_bf16_f32 v51, v110, v111
    v_cvt_pk_bf16_f32 v52, v112, v113
    v_cvt_pk_bf16_f32 v53, v114, v115
    v_cvt_pk_bf16_f32 v54, v116, v117
    v_cvt_pk_bf16_f32 v55, v118, v119
    ds_write_b128 v136, v[48:51] offset:64
    ds_write_b128 v136, v[52:55] offset:80
    v_mul_f32 v120, s9, v120
    v_mul_f32 v121, s9, v121
    v_mul_f32 v122, s9, v122
    v_mul_f32 v123, s9, v123
    v_mul_f32 v124, s9, v124
    v_mul_f32 v125, s9, v125
    v_mul_f32 v126, s9, v126
    v_mul_f32 v127, s9, v127
    v_mul_f32 v128, s9, v128
    v_mul_f32 v129, s9, v129
    v_mul_f32 v130, s9, v130
    v_mul_f32 v131, s9, v131
    v_mul_f32 v132, s9, v132
    v_mul_f32 v133, s9, v133
    v_mul_f32 v134, s9, v134
    v_mul_f32 v135, s9, v135
    v_cvt_pk_bf16_f32 v56, v120, v121
    v_cvt_pk_bf16_f32 v57, v122, v123
    v_cvt_pk_bf16_f32 v58, v124, v125
    v_cvt_pk_bf16_f32 v59, v126, v127
    v_cvt_pk_bf16_f32 v60, v128, v129
    v_cvt_pk_bf16_f32 v61, v130, v131
    v_cvt_pk_bf16_f32 v62, v132, v133
    v_cvt_pk_bf16_f32 v63, v134, v135
    ds_write_b128 v136, v[56:59] offset:128
    ds_write_b128 v136, v[60:63] offset:144
    s_waitcnt lgkmcnt(0)
    ds_read_b128 v[88:91], v140
    ds_read_b128 v[92:95], v142
    ds_read_b128 v[96:99], v144
    ds_read_b128 v[100:103], v146
    ds_read_b128 v[104:107], v148
    ds_read_b128 v[108:111], v150
    s_waitcnt lgkmcnt(5)
    buffer_store_dwordx4 v[88:91], v141, s[60:63], 0 offen sc0 sc1
    s_waitcnt lgkmcnt(4)
    buffer_store_dwordx4 v[92:95], v143, s[60:63], 0 offen sc0 sc1
    s_waitcnt lgkmcnt(3)
    buffer_store_dwordx4 v[96:99], v145, s[60:63], 0 offen sc0 sc1
    s_waitcnt lgkmcnt(2)
    buffer_store_dwordx4 v[100:103], v147, s[60:63], 0 offen sc0 sc1
    s_waitcnt lgkmcnt(1)
    buffer_store_dwordx4 v[104:107], v149, s[60:63], 0 offen sc0 sc1
    s_waitcnt lgkmcnt(0)
    buffer_store_dwordx4 v[108:111], v151, s[60:63], 0 offen sc0 sc1
    s_endpgm
L_k1_kv:
    s_lshl_b32 s6, s3, 7
    s_lshl_b32 s7, s5, 5
    s_add_u32 s6, s6, s7
    v_lshrrev_b32 v3, 4, v1
    v_and_b32 v2, 7, v1
    v_xor_b32 v2, v2, v3
    v_lshlrev_b32 v2, 4, v2
    v_lshrrev_b32 v5, 4, v1
    v_xor_b32 v5, 4, v5
    v_and_b32 v4, 7, v1
    v_xor_b32 v4, v4, v5
    v_lshlrev_b32 v4, 4, v4
    v_lshrrev_b32 v6, 3, v1
    v_add_u32 v6, s6, v6
    v_mul_u32_u24 v6, 1152, v6
    v_add_u32 v7, v6, v2
    v_add_u32 v8, v6, v4
    v_add_u32 v8, 8192, v8
    v_add_u32 v9, v6, v2
    v_add_u32 v9, 16384, v9
    v_add_u32 v10, v6, v4
    v_add_u32 v10, 24576, v10
    s_lshl_b32 s7, s5, 4
    v_lshrrev_b32 v11, 2, v1
    v_add_u32 v11, s7, v11
    v_mul_u32_u24 v11, 36, v11
    v_and_b32 v12, 3, v1
    v_lshl_add_u32 v11, v12, 4, v11
    s_lshl_b32 s10, s5, 12
    s_lshl_b32 s11, s5, 10
    s_waitcnt lgkmcnt(0)
    s_mov_b32 s52, s34
    s_mov_b32 s53, s35
    s_mov_b32 s54, 0x240000
    s_mov_b32 s55, 0x00020000
    s_mov_b32 s56, s38
    s_mov_b32 s57, s39
    s_mov_b32 s58, 0x5100
    s_mov_b32 s59, 0x00020000
    s_mov_b32 s60, s40
    s_mov_b32 s61, s41
    s_mov_b32 s62, 0x5100
    s_mov_b32 s63, 0x00020000
    s_add_u32 s64, s48, 0x280000
    s_addc_u32 s65, s49, 0
    s_mov_b32 s66, 0x24000
    s_mov_b32 s67, 0x00020000
    s_add_u32 m0, s10, 0
    s_add_u32 s51, s51, 128
    s_sub_u32 s9, s51, 1152
    s_min_u32 s51, s51, s9
    buffer_load_dwordx4 v7, s[52:55], s51 offen lds
    buffer_load_dwordx4 v8, s[52:55], s51 offen offset:1024 lds
    buffer_load_dwordx4 v9, s[52:55], s51 offen offset:2048 lds
    buffer_load_dwordx4 v10, s[52:55], s51 offen offset:3072 lds
    s_add_u32 m0, s11, 16384
    s_mul_i32 s9, s51, 18
    buffer_load_dwordx4 v11, s[56:59], s9 offen lds
    s_add_u32 m0, s11, 20480
    s_nop 0
    buffer_load_dwordx4 v11, s[60:63], s9 offen lds
    s_add_u32 m0, s10, 24576
    s_add_u32 s51, s51, 128
    s_sub_u32 s9, s51, 1152
    s_min_u32 s51, s51, s9
    buffer_load_dwordx4 v7, s[52:55], s51 offen lds
    buffer_load_dwordx4 v8, s[52:55], s51 offen offset:1024 lds
    buffer_load_dwordx4 v9, s[52:55], s51 offen offset:2048 lds
    buffer_load_dwordx4 v10, s[52:55], s51 offen offset:3072 lds
    s_add_u32 m0, s11, 40960
    s_mul_i32 s9, s51, 18
    buffer_load_dwordx4 v11, s[56:59], s9 offen lds
    s_add_u32 m0, s11, 45056
    s_nop 0
    buffer_load_dwordx4 v11, s[60:63], s9 offen lds
    v_and_b32 v13, 31, v1
    v_bfe_u32 v14, v1, 1, 3
    v_lshrrev_b32 v15, 5, v1
    v_xor_b32 v14, v14, v15
    v_lshlrev_b32 v14, 4, v14
    v_lshl_add_u32 v15, v13, 7, v14
    v_add_u32 v15, s10, v15
    v_add_u32 v16, 0x10000, v15
    v_add_u32 v17, 0x20000, v15
    v_xor_b32 v18, 32, v15
    v_add_u32 v19, 0x10000, v18
    v_add_u32 v20, 0x20000, v18
    v_xor_b32 v21, 64, v15
    v_add_u32 v22, 0x10000, v21
    v_add_u32 v23, 0x20000, v21
    v_xor_b32 v24, 96, v15
    v_add_u32 v25, 0x10000, v24
    v_add_u32 v26, 0x20000, v24
    v_bfe_u32 v27, v1, 2, 2
    v_lshrrev_b32 v29, 5, v1
    v_lshl_add_u32 v29, v29, 3, v27
    v_mul_u32_u24 v30, 64, v29
    v_and_b32 v28, 1, v1
    v_lshl_add_u32 v30, v28, 5, v30
    v_bfe_u32 v28, v1, 4, 1
    v_lshl_add_u32 v30, v28, 4, v30
    v_bfe_u32 v28, v1, 1, 1
    v_lshl_add_u32 v30, v28, 3, v30
    v_add_u32 v31, 0x10000, v30
    v_add_u32 v32, 0x20000, v30
    v_bfe_u32 v33, v1, 2, 2
    v_lshrrev_b32 v35, 5, v1
    v_lshl_add_u32 v35, v35, 3, v33
    v_mul_u32_u24 v36, 64, v35
    v_bfe_u32 v34, v1, 4, 1
    v_lshl_add_u32 v36, v34, 5, v36
    v_and_b32 v34, 3, v1
    v_lshl_add_u32 v36, v34, 3, v36
    v_add_u32 v37, 0x10000, v36
    v_add_u32 v38, 0x20000, v36
    s_waitcnt vmcnt(6)
    s_barrier
    ds_read_b128 v[40:43], v15 offset:0
    ds_read_b64_tr_b16 v[44:45], v30 offset:16384
    ds_read_b64_tr_b16 v[46:47], v30 offset:16640
    ds_read_b64_tr_b16 v[48:49], v36 offset:20480
    ds_read_b64_tr_b16 v[50:51], v36 offset:20736
    ds_read_b128 v[52:55], v18 offset:0
    ds_read_b64_tr_b16 v[56:57], v30 offset:17408
    ds_read_b64_tr_b16 v[58:59], v30 offset:17664
    ds_read_b64_tr_b16 v[60:61], v36 offset:21504
    ds_read_b64_tr_b16 v[62:63], v36 offset:21760
    ds_read_b128 v[64:67], v21 offset:0
    ds_read_b64_tr_b16 v[68:69], v30 offset:18432
    ds_read_b64_tr_b16 v[70:71], v30 offset:18688
    ds_read_b64_tr_b16 v[72:73], v36 offset:22528
    ds_read_b64_tr_b16 v[74:75], v36 offset:22784
    s_waitcnt lgkmcnt(10)
    v_mfma_f32_32x32x16_bf16 v[76:91], v[44:47], v[40:43], 0
    s_add_u32 m0, s10, 49152
    s_add_u32 s51, s51, 128
    s_sub_u32 s9, s51, 1152
    s_min_u32 s51, s51, s9
    buffer_load_dwordx4 v7, s[52:55], s51 offen lds
    v_mfma_f32_32x32x16_bf16 v[92:107], v[40:43], v[48:51], 0
    buffer_load_dwordx4 v8, s[52:55], s51 offen offset:1024 lds
    ds_read_b128 v[40:43], v24 offset:0
    ds_read_b64_tr_b16 v[44:45], v30 offset:19456
    ds_read_b64_tr_b16 v[46:47], v30 offset:19712
    ds_read_b64_tr_b16 v[48:49], v36 offset:23552
    ds_read_b64_tr_b16 v[50:51], v36 offset:23808
    s_waitcnt lgkmcnt(10)
    v_mfma_f32_32x32x16_bf16 v[76:91], v[56:59], v[52:55], v[76:91]
    buffer_load_dwordx4 v9, s[52:55], s51 offen offset:2048 lds
    v_mfma_f32_32x32x16_bf16 v[92:107], v[52:55], v[60:63], v[92:107]
    buffer_load_dwordx4 v10, s[52:55], s51 offen offset:3072 lds
    s_waitcnt vmcnt(4) lgkmcnt(0)
    s_barrier
    ds_read_b128 v[52:55], v15 offset:24576
    ds_read_b64_tr_b16 v[56:57], v30 offset:40960
    ds_read_b64_tr_b16 v[58:59], v30 offset:41216
    ds_read_b64_tr_b16 v[60:61], v36 offset:45056
    ds_read_b64_tr_b16 v[62:63], v36 offset:45312
    v_mfma_f32_32x32x16_bf16 v[76:91], v[68:71], v[64:67], v[76:91]
    s_add_u32 m0, s11, 65536
    s_mul_i32 s9, s51, 18
    buffer_load_dwordx4 v11, s[56:59], s9 offen lds
    v_mfma_f32_32x32x16_bf16 v[92:107], v[64:67], v[72:75], v[92:107]
    s_add_u32 m0, s11, 69632
    s_nop 0
    buffer_load_dwordx4 v11, s[60:63], s9 offen lds
    ds_read_b128 v[64:67], v18 offset:24576
    ds_read_b64_tr_b16 v[68:69], v30 offset:41984
    ds_read_b64_tr_b16 v[70:71], v30 offset:42240
    ds_read_b64_tr_b16 v[72:73], v36 offset:46080
    ds_read_b64_tr_b16 v[74:75], v36 offset:46336
    v_mfma_f32_32x32x16_bf16 v[76:91], v[44:47], v[40:43], v[76:91]
    s_add_u32 m0, s10, 73728
    s_add_u32 s51, s51, 128
    s_sub_u32 s9, s51, 1152
    s_min_u32 s51, s51, s9
    buffer_load_dwordx4 v7, s[52:55], s51 offen lds
    v_mfma_f32_32x32x16_bf16 v[92:107], v[40:43], v[48:51], v[92:107]
    buffer_load_dwordx4 v8, s[52:55], s51 offen offset:1024 lds
    ds_read_b128 v[40:43], v21 offset:24576
    ds_read_b64_tr_b16 v[44:45], v30 offset:43008
    ds_read_b64_tr_b16 v[46:47], v30 offset:43264
    ds_read_b64_tr_b16 v[48:49], v36 offset:47104
    ds_read_b64_tr_b16 v[50:51], v36 offset:47360
    s_waitcnt lgkmcnt(10)
    v_mfma_f32_32x32x16_bf16 v[76:91], v[56:59], v[52:55], v[76:91]
    buffer_load_dwordx4 v9, s[52:55], s51 offen offset:2048 lds
    v_mfma_f32_32x32x16_bf16 v[92:107], v[52:55], v[60:63], v[92:107]
    buffer_load_dwordx4 v10, s[52:55], s51 offen offset:3072 lds
    ds_read_b128 v[52:55], v24 offset:24576
    ds_read_b64_tr_b16 v[56:57], v30 offset:44032
    ds_read_b64_tr_b16 v[58:59], v30 offset:44288
    ds_read_b64_tr_b16 v[60:61], v36 offset:48128
    ds_read_b64_tr_b16 v[62:63], v36 offset:48384
    s_waitcnt lgkmcnt(10)
    v_mfma_f32_32x32x16_bf16 v[76:91], v[68:71], v[64:67], v[76:91]
    s_add_u32 m0, s11, 90112
    s_mul_i32 s9, s51, 18
    buffer_load_dwordx4 v11, s[56:59], s9 offen lds
    v_mfma_f32_32x32x16_bf16 v[92:107], v[64:67], v[72:75], v[92:107]
    s_add_u32 m0, s11, 94208
    s_nop 0
    buffer_load_dwordx4 v11, s[60:63], s9 offen lds
    s_waitcnt vmcnt(6) lgkmcnt(0)
    s_barrier
    ds_read_b128 v[64:67], v15 offset:49152
    ds_read_b64_tr_b16 v[68:69], v31 offset:0
    ds_read_b64_tr_b16 v[70:71], v31 offset:256
    ds_read_b64_tr_b16 v[72:73], v37 offset:4096
    ds_read_b64_tr_b16 v[74:75], v37 offset:4352
    v_mfma_f32_32x32x16_bf16 v[76:91], v[44:47], v[40:43], v[76:91]
    s_add_u32 m0, s10, 98304
    s_add_u32 s51, s51, 128
    s_sub_u32 s9, s51, 1152
    s_min_u32 s51, s51, s9
    buffer_load_dwordx4 v7, s[52:55], s51 offen lds
    v_mfma_f32_32x32x16_bf16 v[92:107], v[40:43], v[48:51], v[92:107]
    buffer_load_dwordx4 v8, s[52:55], s51 offen offset:1024 lds
    ds_read_b128 v[40:43], v18 offset:49152
    ds_read_b64_tr_b16 v[44:45], v31 offset:1024
    ds_read_b64_tr_b16 v[46:47], v31 offset:1280
    ds_read_b64_tr_b16 v[48:49], v37 offset:5120
    ds_read_b64_tr_b16 v[50:51], v37 offset:5376
    v_mfma_f32_32x32x16_bf16 v[76:91], v[56:59], v[52:55], v[76:91]
    buffer_load_dwordx4 v9, s[52:55], s51 offen offset:2048 lds
    v_mfma_f32_32x32x16_bf16 v[92:107], v[52:55], v[60:63], v[92:107]
    buffer_load_dwordx4 v10, s[52:55], s51 offen offset:3072 lds
    ds_read_b128 v[52:55], v21 offset:49152
    ds_read_b64_tr_b16 v[56:57], v31 offset:2048
    ds_read_b64_tr_b16 v[58:59], v31 offset:2304
    ds_read_b64_tr_b16 v[60:61], v37 offset:6144
    ds_read_b64_tr_b16 v[62:63], v37 offset:6400
    s_waitcnt lgkmcnt(10)
    v_mfma_f32_32x32x16_bf16 v[76:91], v[68:71], v[64:67], v[76:91]
    s_add_u32 m0, s11, 114688
    s_mul_i32 s9, s51, 18
    buffer_load_dwordx4 v11, s[56:59], s9 offen lds
    v_mfma_f32_32x32x16_bf16 v[92:107], v[64:67], v[72:75], v[92:107]
    s_add_u32 m0, s11, 118784
    s_nop 0
    buffer_load_dwordx4 v11, s[60:63], s9 offen lds
    ds_read_b128 v[64:67], v24 offset:49152
    ds_read_b64_tr_b16 v[68:69], v31 offset:3072
    ds_read_b64_tr_b16 v[70:71], v31 offset:3328
    ds_read_b64_tr_b16 v[72:73], v37 offset:7168
    ds_read_b64_tr_b16 v[74:75], v37 offset:7424
    s_waitcnt lgkmcnt(10)
    v_mfma_f32_32x32x16_bf16 v[76:91], v[44:47], v[40:43], v[76:91]
    s_add_u32 m0, s10, 122880
    s_add_u32 s51, s51, 128
    s_sub_u32 s9, s51, 1152
    s_min_u32 s51, s51, s9
    buffer_load_dwordx4 v7, s[52:55], s51 offen lds
    v_mfma_f32_32x32x16_bf16 v[92:107], v[40:43], v[48:51], v[92:107]
    buffer_load_dwordx4 v8, s[52:55], s51 offen offset:1024 lds
    s_waitcnt vmcnt(8) lgkmcnt(0)
    s_barrier
    ds_read_b128 v[40:43], v16 offset:8192
    ds_read_b64_tr_b16 v[44:45], v31 offset:24576
    ds_read_b64_tr_b16 v[46:47], v31 offset:24832
    ds_read_b64_tr_b16 v[48:49], v37 offset:28672
    ds_read_b64_tr_b16 v[50:51], v37 offset:28928
    v_mfma_f32_32x32x16_bf16 v[76:91], v[56:59], v[52:55], v[76:91]
    buffer_load_dwordx4 v9, s[52:55], s51 offen offset:2048 lds
    v_mfma_f32_32x32x16_bf16 v[92:107], v[52:55], v[60:63], v[92:107]
    buffer_load_dwordx4 v10, s[52:55], s51 offen offset:3072 lds
    ds_read_b128 v[52:55], v19 offset:8192
    ds_read_b64_tr_b16 v[56:57], v31 offset:25600
    ds_read_b64_tr_b16 v[58:59], v31 offset:25856
    ds_read_b64_tr_b16 v[60:61], v37 offset:29696
    ds_read_b64_tr_b16 v[62:63], v37 offset:29952
    v_mfma_f32_32x32x16_bf16 v[76:91], v[68:71], v[64:67], v[76:91]
    s_add_u32 m0, s11, 139264
    s_mul_i32 s9, s51, 18
    buffer_load_dwordx4 v11, s[56:59], s9 offen lds
    v_mfma_f32_32x32x16_bf16 v[92:107], v[64:67], v[72:75], v[92:107]
    s_add_u32 m0, s11, 143360
    s_nop 0
    buffer_load_dwordx4 v11, s[60:63], s9 offen lds
    ds_read_b128 v[64:67], v22 offset:8192
    ds_read_b64_tr_b16 v[68:69], v31 offset:26624
    ds_read_b64_tr_b16 v[70:71], v31 offset:26880
    ds_read_b64_tr_b16 v[72:73], v37 offset:30720
    ds_read_b64_tr_b16 v[74:75], v37 offset:30976
    s_waitcnt lgkmcnt(10)
    v_mfma_f32_32x32x16_bf16 v[76:91], v[44:47], v[40:43], v[76:91]
    s_add_u32 m0, s10, 0
    s_add_u32 s51, s51, 128
    s_sub_u32 s9, s51, 1152
    s_min_u32 s51, s51, s9
    buffer_load_dwordx4 v7, s[52:55], s51 offen lds
    v_mfma_f32_32x32x16_bf16 v[92:107], v[40:43], v[48:51], v[92:107]
    buffer_load_dwordx4 v8, s[52:55], s51 offen offset:1024 lds
    ds_read_b128 v[40:43], v25 offset:8192
    ds_read_b64_tr_b16 v[44:45], v31 offset:27648
    ds_read_b64_tr_b16 v[46:47], v31 offset:27904
    ds_read_b64_tr_b16 v[48:49], v37 offset:31744
    ds_read_b64_tr_b16 v[50:51], v37 offset:32000
    s_waitcnt lgkmcnt(10)
    v_mfma_f32_32x32x16_bf16 v[76:91], v[56:59], v[52:55], v[76:91]
    buffer_load_dwordx4 v9, s[52:55], s51 offen offset:2048 lds
    v_mfma_f32_32x32x16_bf16 v[92:107], v[52:55], v[60:63], v[92:107]
    buffer_load_dwordx4 v10, s[52:55], s51 offen offset:3072 lds
    s_waitcnt vmcnt(10) lgkmcnt(0)
    s_barrier
    ds_read_b128 v[52:55], v16 offset:32768
    ds_read_b64_tr_b16 v[56:57], v31 offset:49152
    ds_read_b64_tr_b16 v[58:59], v31 offset:49408
    ds_read_b64_tr_b16 v[60:61], v37 offset:53248
    ds_read_b64_tr_b16 v[62:63], v37 offset:53504
    v_mfma_f32_32x32x16_bf16 v[76:91], v[68:71], v[64:67], v[76:91]
    s_add_u32 m0, s11, 16384
    s_mul_i32 s9, s51, 18
    buffer_load_dwordx4 v11, s[56:59], s9 offen lds
    v_mfma_f32_32x32x16_bf16 v[92:107], v[64:67], v[72:75], v[92:107]
    s_add_u32 m0, s11, 20480
    s_nop 0
    buffer_load_dwordx4 v11, s[60:63], s9 offen lds
    ds_read_b128 v[64:67], v19 offset:32768
    ds_read_b64_tr_b16 v[68:69], v31 offset:50176
    ds_read_b64_tr_b16 v[70:71], v31 offset:50432
    ds_read_b64_tr_b16 v[72:73], v37 offset:54272
    ds_read_b64_tr_b16 v[74:75], v37 offset:54528
    v_mfma_f32_32x32x16_bf16 v[76:91], v[44:47], v[40:43], v[76:91]
    s_add_u32 m0, s10, 24576
    s_add_u32 s51, s51, 128
    s_sub_u32 s9, s51, 1152
    s_min_u32 s51, s51, s9
    buffer_load_dwordx4 v7, s[52:55], s51 offen lds
    v_mfma_f32_32x32x16_bf16 v[92:107], v[40:43], v[48:51], v[92:107]
    buffer_load_dwordx4 v8, s[52:55], s51 offen offset:1024 lds
    ds_read_b128 v[40:43], v22 offset:32768
    ds_read_b64_tr_b16 v[44:45], v31 offset:51200
    ds_read_b64_tr_b16 v[46:47], v31 offset:51456
    ds_read_b64_tr_b16 v[48:49], v37 offset:55296
    ds_read_b64_tr_b16 v[50:51], v37 offset:55552
    s_waitcnt lgkmcnt(10)
    v_mfma_f32_32x32x16_bf16 v[76:91], v[56:59], v[52:55], v[76:91]
    buffer_load_dwordx4 v9, s[52:55], s51 offen offset:2048 lds
    v_mfma_f32_32x32x16_bf16 v[92:107], v[52:55], v[60:63], v[92:107]
    buffer_load_dwordx4 v10, s[52:55], s51 offen offset:3072 lds
    ds_read_b128 v[52:55], v25 offset:32768
    ds_read_b64_tr_b16 v[56:57], v31 offset:52224
    ds_read_b64_tr_b16 v[58:59], v31 offset:52480
    ds_read_b64_tr_b16 v[60:61], v37 offset:56320
    ds_read_b64_tr_b16 v[62:63], v37 offset:56576
    s_waitcnt lgkmcnt(10)
    v_mfma_f32_32x32x16_bf16 v[76:91], v[68:71], v[64:67], v[76:91]
    s_add_u32 m0, s11, 40960
    s_mul_i32 s9, s51, 18
    buffer_load_dwordx4 v11, s[56:59], s9 offen lds
    v_mfma_f32_32x32x16_bf16 v[92:107], v[64:67], v[72:75], v[92:107]
    s_add_u32 m0, s11, 45056
    s_nop 0
    buffer_load_dwordx4 v11, s[60:63], s9 offen lds
    s_waitcnt vmcnt(12) lgkmcnt(0)
    s_barrier
    ds_read_b128 v[64:67], v16 offset:57344
    ds_read_b64_tr_b16 v[68:69], v32 offset:8192
    ds_read_b64_tr_b16 v[70:71], v32 offset:8448
    ds_read_b64_tr_b16 v[72:73], v38 offset:12288
    ds_read_b64_tr_b16 v[74:75], v38 offset:12544
    v_mfma_f32_32x32x16_bf16 v[76:91], v[44:47], v[40:43], v[76:91]
    s_add_u32 m0, s10, 49152
    s_add_u32 s51, s51, 128
    s_sub_u32 s9, s51, 1152
    s_min_u32 s51, s51, s9
    buffer_load_dwordx4 v7, s[52:55], s51 offen lds
    v_mfma_f32_32x32x16_bf16 v[92:107], v[40:43], v[48:51], v[92:107]
    buffer_load_dwordx4 v8, s[52:55], s51 offen offset:1024 lds
    ds_read_b128 v[40:43], v19 offset:57344
    ds_read_b64_tr_b16 v[44:45], v32 offset:9216
    ds_read_b64_tr_b16 v[46:47], v32 offset:9472
    ds_read_b64_tr_b16 v[48:49], v38 offset:13312
    ds_read_b64_tr_b16 v[50:51], v38 offset:13568
    v_mfma_f32_32x32x16_bf16 v[76:91], v[56:59], v[52:55], v[76:91]
    buffer_load_dwordx4 v9, s[52:55], s51 offen offset:2048 lds
    v_mfma_f32_32x32x16_bf16 v[92:107], v[52:55], v[60:63], v[92:107]
    buffer_load_dwordx4 v10, s[52:55], s51 offen offset:3072 lds
    ds_read_b128 v[52:55], v22 offset:57344
    ds_read_b64_tr_b16 v[56:57], v32 offset:10240
    ds_read_b64_tr_b16 v[58:59], v32 offset:10496
    ds_read_b64_tr_b16 v[60:61], v38 offset:14336
    ds_read_b64_tr_b16 v[62:63], v38 offset:14592
    s_waitcnt lgkmcnt(10)
    v_mfma_f32_32x32x16_bf16 v[76:91], v[68:71], v[64:67], v[76:91]
    s_add_u32 m0, s11, 65536
    s_mul_i32 s9, s51, 18
    buffer_load_dwordx4 v11, s[56:59], s9 offen lds
    v_mfma_f32_32x32x16_bf16 v[92:107], v[64:67], v[72:75], v[92:107]
    s_add_u32 m0, s11, 69632
    s_nop 0
    buffer_load_dwordx4 v11, s[60:63], s9 offen lds
    ds_read_b128 v[64:67], v25 offset:57344
    ds_read_b64_tr_b16 v[68:69], v32 offset:11264
    ds_read_b64_tr_b16 v[70:71], v32 offset:11520
    ds_read_b64_tr_b16 v[72:73], v38 offset:15360
    ds_read_b64_tr_b16 v[74:75], v38 offset:15616
    s_waitcnt lgkmcnt(10)
    v_mfma_f32_32x32x16_bf16 v[76:91], v[44:47], v[40:43], v[76:91]
    v_mfma_f32_32x32x16_bf16 v[92:107], v[40:43], v[48:51], v[92:107]
    s_waitcnt vmcnt(12) lgkmcnt(0)
    s_barrier
    ds_read_b128 v[40:43], v15 offset:0
    ds_read_b64_tr_b16 v[44:45], v30 offset:16384
    ds_read_b64_tr_b16 v[46:47], v30 offset:16640
    ds_read_b64_tr_b16 v[48:49], v36 offset:20480
    ds_read_b64_tr_b16 v[50:51], v36 offset:20736
    v_mfma_f32_32x32x16_bf16 v[76:91], v[56:59], v[52:55], v[76:91]
    v_mfma_f32_32x32x16_bf16 v[92:107], v[52:55], v[60:63], v[92:107]
    ds_read_b128 v[52:55], v18 offset:0
    ds_read_b64_tr_b16 v[56:57], v30 offset:17408
    ds_read_b64_tr_b16 v[58:59], v30 offset:17664
    ds_read_b64_tr_b16 v[60:61], v36 offset:21504
    ds_read_b64_tr_b16 v[62:63], v36 offset:21760
    v_mfma_f32_32x32x16_bf16 v[76:91], v[68:71], v[64:67], v[76:91]
    v_mfma_f32_32x32x16_bf16 v[92:107], v[64:67], v[72:75], v[92:107]
    ds_read_b128 v[64:67], v21 offset:0
    ds_read_b64_tr_b16 v[68:69], v30 offset:18432
    ds_read_b64_tr_b16 v[70:71], v30 offset:18688
    ds_read_b64_tr_b16 v[72:73], v36 offset:22528
    ds_read_b64_tr_b16 v[74:75], v36 offset:22784
    s_waitcnt lgkmcnt(10)
    v_mfma_f32_32x32x16_bf16 v[76:91], v[44:47], v[40:43], v[76:91]
    v_mfma_f32_32x32x16_bf16 v[92:107], v[40:43], v[48:51], v[92:107]
    ds_read_b128 v[40:43], v24 offset:0
    ds_read_b64_tr_b16 v[44:45], v30 offset:19456
    ds_read_b64_tr_b16 v[46:47], v30 offset:19712
    ds_read_b64_tr_b16 v[48:49], v36 offset:23552
    ds_read_b64_tr_b16 v[50:51], v36 offset:23808
    s_waitcnt lgkmcnt(10)
    v_mfma_f32_32x32x16_bf16 v[76:91], v[56:59], v[52:55], v[76:91]
    v_mfma_f32_32x32x16_bf16 v[92:107], v[52:55], v[60:63], v[92:107]
    s_waitcnt vmcnt(6) lgkmcnt(0)
    s_barrier
    ds_read_b128 v[52:55], v15 offset:24576
    ds_read_b64_tr_b16 v[56:57], v30 offset:40960
    ds_read_b64_tr_b16 v[58:59], v30 offset:41216
    ds_read_b64_tr_b16 v[60:61], v36 offset:45056
    ds_read_b64_tr_b16 v[62:63], v36 offset:45312
    v_mfma_f32_32x32x16_bf16 v[76:91], v[68:71], v[64:67], v[76:91]
    v_mfma_f32_32x32x16_bf16 v[92:107], v[64:67], v[72:75], v[92:107]
    ds_read_b128 v[64:67], v18 offset:24576
    ds_read_b64_tr_b16 v[68:69], v30 offset:41984
    ds_read_b64_tr_b16 v[70:71], v30 offset:42240
    ds_read_b64_tr_b16 v[72:73], v36 offset:46080
    ds_read_b64_tr_b16 v[74:75], v36 offset:46336
    v_mfma_f32_32x32x16_bf16 v[76:91], v[44:47], v[40:43], v[76:91]
    v_mfma_f32_32x32x16_bf16 v[92:107], v[40:43], v[48:51], v[92:107]
    ds_read_b128 v[40:43], v21 offset:24576
    ds_read_b64_tr_b16 v[44:45], v30 offset:43008
    ds_read_b64_tr_b16 v[46:47], v30 offset:43264
    ds_read_b64_tr_b16 v[48:49], v36 offset:47104
    ds_read_b64_tr_b16 v[50:51], v36 offset:47360
    s_waitcnt lgkmcnt(10)
    v_mfma_f32_32x32x16_bf16 v[76:91], v[56:59], v[52:55], v[76:91]
    v_mfma_f32_32x32x16_bf16 v[92:107], v[52:55], v[60:63], v[92:107]
    ds_read_b128 v[52:55], v24 offset:24576
    ds_read_b64_tr_b16 v[56:57], v30 offset:44032
    ds_read_b64_tr_b16 v[58:59], v30 offset:44288
    ds_read_b64_tr_b16 v[60:61], v36 offset:48128
    ds_read_b64_tr_b16 v[62:63], v36 offset:48384
    s_waitcnt lgkmcnt(10)
    v_mfma_f32_32x32x16_bf16 v[76:91], v[68:71], v[64:67], v[76:91]
    v_mfma_f32_32x32x16_bf16 v[92:107], v[64:67], v[72:75], v[92:107]
    s_waitcnt vmcnt(0) lgkmcnt(0)
    s_barrier
    ds_read_b128 v[64:67], v15 offset:49152
    ds_read_b64_tr_b16 v[68:69], v31 offset:0
    ds_read_b64_tr_b16 v[70:71], v31 offset:256
    ds_read_b64_tr_b16 v[72:73], v37 offset:4096
    ds_read_b64_tr_b16 v[74:75], v37 offset:4352
    v_mfma_f32_32x32x16_bf16 v[76:91], v[44:47], v[40:43], v[76:91]
    v_mfma_f32_32x32x16_bf16 v[92:107], v[40:43], v[48:51], v[92:107]
    ds_read_b128 v[40:43], v18 offset:49152
    ds_read_b64_tr_b16 v[44:45], v31 offset:1024
    ds_read_b64_tr_b16 v[46:47], v31 offset:1280
    ds_read_b64_tr_b16 v[48:49], v37 offset:5120
    ds_read_b64_tr_b16 v[50:51], v37 offset:5376
    v_mfma_f32_32x32x16_bf16 v[76:91], v[56:59], v[52:55], v[76:91]
    v_mfma_f32_32x32x16_bf16 v[92:107], v[52:55], v[60:63], v[92:107]
    ds_read_b128 v[52:55], v21 offset:49152
    ds_read_b64_tr_b16 v[56:57], v31 offset:2048
    ds_read_b64_tr_b16 v[58:59], v31 offset:2304
    ds_read_b64_tr_b16 v[60:61], v37 offset:6144
    ds_read_b64_tr_b16 v[62:63], v37 offset:6400
    s_waitcnt lgkmcnt(10)
    v_mfma_f32_32x32x16_bf16 v[76:91], v[68:71], v[64:67], v[76:91]
    v_mfma_f32_32x32x16_bf16 v[92:107], v[64:67], v[72:75], v[92:107]
    ds_read_b128 v[64:67], v24 offset:49152
    ds_read_b64_tr_b16 v[68:69], v31 offset:3072
    ds_read_b64_tr_b16 v[70:71], v31 offset:3328
    ds_read_b64_tr_b16 v[72:73], v37 offset:7168
    ds_read_b64_tr_b16 v[74:75], v37 offset:7424
    s_waitcnt lgkmcnt(10)
    v_mfma_f32_32x32x16_bf16 v[76:91], v[44:47], v[40:43], v[76:91]
    v_mfma_f32_32x32x16_bf16 v[92:107], v[40:43], v[48:51], v[92:107]
    s_waitcnt lgkmcnt(5)
    v_mfma_f32_32x32x16_bf16 v[76:91], v[56:59], v[52:55], v[76:91]
    v_mfma_f32_32x32x16_bf16 v[92:107], v[52:55], v[60:63], v[92:107]
    s_waitcnt lgkmcnt(0)
    v_mfma_f32_32x32x16_bf16 v[76:91], v[68:71], v[64:67], v[76:91]
    v_mfma_f32_32x32x16_bf16 v[92:107], v[64:67], v[72:75], v[92:107]
    s_lshl_b32 s6, s3, 2
    s_add_u32 s6, s6, s5
    s_mul_i32 s6, s6, 2304
    v_and_b32 v108, 31, v1
    v_lshrrev_b32 v109, 5, v1
    v_and_b32 v110, 0x13, v108
    v_bfe_u32 v111, v108, 2, 1
    v_lshl_add_u32 v110, v111, 3, v110
    v_bfe_u32 v111, v108, 3, 1
    v_lshl_add_u32 v110, v111, 2, v110
    v_lshlrev_b32 v112, 4, v110
    v_lshlrev_b32 v113, 2, v110
    v_lshl_add_u32 v114, v109, 3, v112
    s_nop 7
    s_nop 7
    v_cvt_pk_bf16_f32 v40, v76, v77
    v_cvt_pk_bf16_f32 v41, v78, v79
    v_cvt_pk_bf16_f32 v42, v80, v81
    v_cvt_pk_bf16_f32 v43, v82, v83
    v_cvt_pk_bf16_f32 v44, v84, v85
    v_cvt_pk_bf16_f32 v45, v86, v87
    v_cvt_pk_bf16_f32 v46, v88, v89
    v_cvt_pk_bf16_f32 v47, v90, v91
    v_cvt_pk_bf16_f32 v48, v92, v93
    v_cvt_pk_bf16_f32 v49, v94, v95
    v_cvt_pk_bf16_f32 v50, v96, v97
    v_cvt_pk_bf16_f32 v51, v98, v99
    v_cvt_pk_bf16_f32 v52, v100, v101
    v_cvt_pk_bf16_f32 v53, v102, v103
    v_cvt_pk_bf16_f32 v54, v104, v105
    v_cvt_pk_bf16_f32 v55, v106, v107
    s_mov_b32 exec_hi, 0
    buffer_store_dwordx4 v[40:43], v112, s[64:67], s6 offen sc0 sc1
    buffer_store_dwordx4 v[44:47], v112, s[64:67], s6 offen offset:512 sc0 sc1
    s_mov_b32 exec_hi, -1
    s_mov_b32 exec_lo, 0
    buffer_store_dword v40, v113, s[64:67], s6 offen offset:1024 sc0 sc1
    s_mov_b32 exec_lo, 0x3ffff
    s_mov_b32 exec_hi, 0x3ffff
    buffer_store_dwordx2 v[48:49], v114, s[64:67], s6 offen offset:1152 sc0 sc1
    buffer_store_dwordx2 v[50:51], v114, s[64:67], s6 offen offset:1440 sc0 sc1
    buffer_store_dwordx2 v[52:53], v114, s[64:67], s6 offen offset:1728 sc0 sc1
    buffer_store_dwordx2 v[54:55], v114, s[64:67], s6 offen offset:2016 sc0 sc1
    s_mov_b64 exec, -1
    s_endpgm
L_k1_ssm:
    s_lshr_b32 s12, s5, 1
    s_and_b32 s13, s5, 1
    s_lshl_b32 s14, s4, 6
    s_lshl_b32 s6, s13, 5
    s_add_u32 s6, s6, s14
    v_and_b32 v2, 31, v1
    v_add_u32 v2, s6, v2
    v_lshlrev_b32 v3, 1, v2
    v_lshrrev_b32 v8, 4, v1
    v_and_b32 v7, 7, v1
    v_xor_b32 v7, v7, v8
    v_lshlrev_b32 v7, 4, v7
    v_lshrrev_b32 v10, 4, v1
    v_xor_b32 v10, 4, v10
    v_and_b32 v9, 7, v1
    v_xor_b32 v9, v9, v10
    v_lshlrev_b32 v9, 4, v9
    s_lshl_b32 s6, s3, 7
    s_lshl_b32 s7, s12, 6
    s_add_u32 s6, s6, s7
    s_lshl_b32 s7, s13, 3
    s_add_u32 s7, s7, s6
    v_and_b32 v11, 32, v1
    v_bfe_u32 v12, v1, 3, 1
    v_lshl_add_u32 v11, v12, 4, v11
    v_bfe_u32 v12, v1, 4, 1
    v_add3_u32 v11, v11, v12, s7
    v_mul_u32_u24 v11, 1152, v11
    v_add_u32 v13, v11, v7
    v_add_u32 v14, v11, v9
    v_add_u32 v14, 1280, v14
    v_add_u32 v15, v11, v7
    v_add_u32 v15, 2560, v15
    v_add_u32 v16, v11, v9
    v_add_u32 v16, 3840, v16
    s_lshl_b32 s7, s13, 5
    s_add_u32 s7, s7, s14
    v_lshrrev_b32 v11, 3, v1
    v_add_u32 v11, s7, v11
    v_mul_u32_u24 v11, 1152, v11
    v_add_u32 v17, v11, v7
    v_add_u32 v18, v11, v9
    v_add_u32 v18, 8192, v18
    v_add_u32 v19, v11, v7
    v_add_u32 v19, 16384, v19
    v_add_u32 v20, v11, v9
    v_add_u32 v20, 24576, v20
    s_lshl_b32 s10, s5, 12
    s_waitcnt lgkmcnt(0)
    s_mov_b32 s52, s16
    s_mov_b32 s53, s17
    s_mov_b32 s54, 0x240000
    s_mov_b32 s55, 0x00020000
    s_cmp_lt_u32 s5, 2
    s_cselect_b32 s56, s22, s24
    s_cselect_b32 s57, s23, s25
    s_mov_b32 s58, 0xa2000
    s_mov_b32 s59, 0x00020000
    s_mov_b32 s60, s18
    s_mov_b32 s61, s19
    s_mov_b32 s62, 0x480
    s_mov_b32 s63, 0x00020000
    s_mov_b32 s64, s20
    s_mov_b32 s65, s21
    s_mov_b32 s66, 0x480
    s_mov_b32 s67, 0x00020000
    s_mov_b32 s68, s30
    s_mov_b32 s69, s31
    s_mov_b32 s70, 0x480
    s_mov_b32 s71, 0x00020000
    s_add_u32 m0, s10, 0
    s_add_u32 s51, s51, 128
    s_sub_u32 s9, s51, 1152
    s_min_u32 s51, s51, s9
    buffer_load_dwordx4 v13, s[52:55], s51 offen lds
    buffer_load_dwordx4 v14, s[52:55], s51 offen offset:1024 lds
    buffer_load_dwordx4 v15, s[52:55], s51 offen offset:2048 lds
    buffer_load_dwordx4 v16, s[52:55], s51 offen offset:3072 lds
    s_add_u32 m0, s10, 16384
    s_nop 0
    buffer_load_dwordx4 v17, s[56:59], s51 offen lds
    buffer_load_dwordx4 v18, s[56:59], s51 offen offset:1024 lds
    buffer_load_dwordx4 v19, s[56:59], s51 offen offset:2048 lds
    buffer_load_dwordx4 v20, s[56:59], s51 offen offset:3072 lds
    s_add_u32 m0, s10, 32768
    s_add_u32 s51, s51, 128
    s_sub_u32 s9, s51, 1152
    s_min_u32 s51, s51, s9
    buffer_load_dwordx4 v13, s[52:55], s51 offen lds
    buffer_load_dwordx4 v14, s[52:55], s51 offen offset:1024 lds
    buffer_load_dwordx4 v15, s[52:55], s51 offen offset:2048 lds
    buffer_load_dwordx4 v16, s[52:55], s51 offen offset:3072 lds
    s_add_u32 m0, s10, 49152
    s_nop 0
    buffer_load_dwordx4 v17, s[56:59], s51 offen lds
    buffer_load_dwordx4 v18, s[56:59], s51 offen offset:1024 lds
    buffer_load_dwordx4 v19, s[56:59], s51 offen offset:2048 lds
    buffer_load_dwordx4 v20, s[56:59], s51 offen offset:3072 lds
    buffer_load_ushort v4, v3, s[60:63], 0 offen
    buffer_load_ushort v5, v3, s[64:67], 0 offen
    buffer_load_ushort v6, v3, s[68:71], 0 offen
    s_lshl_b32 s15, s12, 13
    s_lshl_b32 s50, s13, 12
    s_add_u32 s50, s50, 16384
    v_and_b32 v21, 31, v1
    v_bfe_u32 v22, v1, 1, 3
    v_lshrrev_b32 v23, 5, v1
    v_xor_b32 v22, v22, v23
    v_lshlrev_b32 v22, 4, v22
    v_lshl_add_u32 v23, v21, 7, v22
    v_add_u32 v23, s15, v23
    v_add_u32 v24, 0x10000, v23
    v_add_u32 v25, 0x20000, v23
    v_xor_b32 v26, 32, v23
    v_add_u32 v27, 0x10000, v26
    v_add_u32 v28, 0x20000, v26
    v_xor_b32 v29, 64, v23
    v_add_u32 v30, 0x10000, v29
    v_add_u32 v31, 0x20000, v29
    v_xor_b32 v32, 96, v23
    v_add_u32 v33, 0x10000, v32
    v_add_u32 v34, 0x20000, v32
    v_and_b32 v35, 31, v1
    v_bfe_u32 v36, v1, 1, 3
    v_lshrrev_b32 v37, 5, v1
    v_xor_b32 v36, v36, v37
    v_lshlrev_b32 v36, 4, v36
    v_lshl_add_u32 v37, v35, 7, v36
    v_add_u32 v37, s50, v37
    v_add_u32 v38, 0x10000, v37
    v_add_u32 v39, 0x20000, v37
    v_xor_b32 v40, 32, v37
    v_add_u32 v41, 0x10000, v40
    v_add_u32 v42, 0x20000, v40
    v_xor_b32 v43, 64, v37
    v_add_u32 v44, 0x10000, v43
    v_add_u32 v45, 0x20000, v43
    v_xor_b32 v46, 96, v37
    v_add_u32 v47, 0x10000, v46
    v_add_u32 v48, 0x20000, v46
    s_waitcnt vmcnt(11)
    s_barrier
    ds_read_b128 v[52:55], v23 offset:0
    ds_read_b128 v[56:59], v37 offset:0
    ds_read_b128 v[60:63], v23 offset:4096
    ds_read_b128 v[64:67], v37 offset:8192
    ds_read_b128 v[68:71], v26 offset:0
    ds_read_b128 v[72:75], v40 offset:0
    ds_read_b128 v[76:79], v26 offset:4096
    ds_read_b128 v[80:83], v40 offset:8192
    ds_read_b128 v[84:87], v29 offset:0
    ds_read_b128 v[88:91], v43 offset:0
    ds_read_b128 v[92:95], v29 offset:4096
    ds_read_b128 v[96:99], v43 offset:8192
    s_waitcnt lgkmcnt(8)
    v_mfma_f32_32x32x16_bf16 v[100:115], v[52:55], v[56:59], 0
    s_add_u32 m0, s10, 65536
    s_add_u32 s51, s51, 128
    s_sub_u32 s9, s51, 1152
    s_min_u32 s51, s51, s9
    buffer_load_dwordx4 v13, s[52:55], s51 offen lds
    v_mfma_f32_32x32x16_bf16 v[116:131], v[60:63], v[56:59], 0
    buffer_load_dwordx4 v14, s[52:55], s51 offen offset:1024 lds
    v_mfma_f32_32x32x16_bf16 v[132:147], v[52:55], v[64:67], 0
    buffer_load_dwordx4 v15, s[52:55], s51 offen offset:2048 lds
    v_mfma_f32_32x32x16_bf16 v[148:163], v[60:63], v[64:67], 0
    buffer_load_dwordx4 v16, s[52:55], s51 offen offset:3072 lds
    ds_read_b128 v[52:55], v32 offset:0
    ds_read_b128 v[56:59], v46 offset:0
    ds_read_b128 v[60:63], v32 offset:4096
    ds_read_b128 v[64:67], v46 offset:8192
    s_waitcnt lgkmcnt(8)
    v_mfma_f32_32x32x16_bf16 v[100:115], v[68:71], v[72:75], v[100:115]
    s_add_u32 m0, s10, 81920
    s_nop 0
    buffer_load_dwordx4 v17, s[56:59], s51 offen lds
    v_mfma_f32_32x32x16_bf16 v[116:131], v[76:79], v[72:75], v[116:131]
    buffer_load_dwordx4 v18, s[56:59], s51 offen offset:1024 lds
    v_mfma_f32_32x32x16_bf16 v[132:147], v[68:71], v[80:83], v[132:147]
    buffer_load_dwordx4 v19, s[56:59], s51 offen offset:2048 lds
    v_mfma_f32_32x32x16_bf16 v[148:163], v[76:79], v[80:83], v[148:163]
    buffer_load_dwordx4 v20, s[56:59], s51 offen offset:3072 lds
    s_waitcnt vmcnt(11) lgkmcnt(0)
    s_barrier
    ds_read_b128 v[68:71], v23 offset:32768
    ds_read_b128 v[72:75], v37 offset:32768
    ds_read_b128 v[76:79], v23 offset:36864
    ds_read_b128 v[80:83], v37 offset:40960
    v_mfma_f32_32x32x16_bf16 v[100:115], v[84:87], v[88:91], v[100:115]
    s_add_u32 m0, s10, 98304
    s_add_u32 s51, s51, 128
    s_sub_u32 s9, s51, 1152
    s_min_u32 s51, s51, s9
    buffer_load_dwordx4 v13, s[52:55], s51 offen lds
    v_mfma_f32_32x32x16_bf16 v[116:131], v[92:95], v[88:91], v[116:131]
    buffer_load_dwordx4 v14, s[52:55], s51 offen offset:1024 lds
    v_mfma_f32_32x32x16_bf16 v[132:147], v[84:87], v[96:99], v[132:147]
    buffer_load_dwordx4 v15, s[52:55], s51 offen offset:2048 lds
    v_mfma_f32_32x32x16_bf16 v[148:163], v[92:95], v[96:99], v[148:163]
    buffer_load_dwordx4 v16, s[52:55], s51 offen offset:3072 lds
    ds_read_b128 v[84:87], v26 offset:32768
    ds_read_b128 v[88:91], v40 offset:32768
    ds_read_b128 v[92:95], v26 offset:36864
    ds_read_b128 v[96:99], v40 offset:40960
    v_mfma_f32_32x32x16_bf16 v[100:115], v[52:55], v[56:59], v[100:115]
    s_add_u32 m0, s10, 114688
    s_nop 0
    buffer_load_dwordx4 v17, s[56:59], s51 offen lds
    v_mfma_f32_32x32x16_bf16 v[116:131], v[60:63], v[56:59], v[116:131]
    buffer_load_dwordx4 v18, s[56:59], s51 offen offset:1024 lds
    v_mfma_f32_32x32x16_bf16 v[132:147], v[52:55], v[64:67], v[132:147]
    buffer_load_dwordx4 v19, s[56:59], s51 offen offset:2048 lds
    v_mfma_f32_32x32x16_bf16 v[148:163], v[60:63], v[64:67], v[148:163]
    buffer_load_dwordx4 v20, s[56:59], s51 offen offset:3072 lds
    ds_read_b128 v[52:55], v29 offset:32768
    ds_read_b128 v[56:59], v43 offset:32768
    ds_read_b128 v[60:63], v29 offset:36864
    ds_read_b128 v[64:67], v43 offset:40960
    s_waitcnt lgkmcnt(8)
    v_mfma_f32_32x32x16_bf16 v[100:115], v[68:71], v[72:75], v[100:115]
    s_add_u32 m0, s10, 131072
    s_add_u32 s51, s51, 128
    s_sub_u32 s9, s51, 1152
    s_min_u32 s51, s51, s9
    buffer_load_dwordx4 v13, s[52:55], s51 offen lds
    v_mfma_f32_32x32x16_bf16 v[116:131], v[76:79], v[72:75], v[116:131]
    buffer_load_dwordx4 v14, s[52:55], s51 offen offset:1024 lds
    v_mfma_f32_32x32x16_bf16 v[132:147], v[68:71], v[80:83], v[132:147]
    buffer_load_dwordx4 v15, s[52:55], s51 offen offset:2048 lds
    v_mfma_f32_32x32x16_bf16 v[148:163], v[76:79], v[80:83], v[148:163]
    buffer_load_dwordx4 v16, s[52:55], s51 offen offset:3072 lds
    ds_read_b128 v[68:71], v32 offset:32768
    ds_read_b128 v[72:75], v46 offset:32768
    ds_read_b128 v[76:79], v32 offset:36864
    ds_read_b128 v[80:83], v46 offset:40960
    s_waitcnt lgkmcnt(8)
    v_mfma_f32_32x32x16_bf16 v[100:115], v[84:87], v[88:91], v[100:115]
    s_add_u32 m0, s10, 147456
    s_nop 0
    buffer_load_dwordx4 v17, s[56:59], s51 offen lds
    v_mfma_f32_32x32x16_bf16 v[116:131], v[92:95], v[88:91], v[116:131]
    buffer_load_dwordx4 v18, s[56:59], s51 offen offset:1024 lds
    v_mfma_f32_32x32x16_bf16 v[132:147], v[84:87], v[96:99], v[132:147]
    buffer_load_dwordx4 v19, s[56:59], s51 offen offset:2048 lds
    v_mfma_f32_32x32x16_bf16 v[148:163], v[92:95], v[96:99], v[148:163]
    buffer_load_dwordx4 v20, s[56:59], s51 offen offset:3072 lds
    s_waitcnt vmcnt(16) lgkmcnt(0)
    s_barrier
    ds_read_b128 v[84:87], v24 offset:0
    ds_read_b128 v[88:91], v38 offset:0
    ds_read_b128 v[92:95], v24 offset:4096
    ds_read_b128 v[96:99], v38 offset:8192
    v_mfma_f32_32x32x16_bf16 v[100:115], v[52:55], v[56:59], v[100:115]
    s_add_u32 m0, s10, 0
    s_add_u32 s51, s51, 128
    s_sub_u32 s9, s51, 1152
    s_min_u32 s51, s51, s9
    buffer_load_dwordx4 v13, s[52:55], s51 offen lds
    v_mfma_f32_32x32x16_bf16 v[116:131], v[60:63], v[56:59], v[116:131]
    buffer_load_dwordx4 v14, s[52:55], s51 offen offset:1024 lds
    v_mfma_f32_32x32x16_bf16 v[132:147], v[52:55], v[64:67], v[132:147]
    buffer_load_dwordx4 v15, s[52:55], s51 offen offset:2048 lds
    v_mfma_f32_32x32x16_bf16 v[148:163], v[60:63], v[64:67], v[148:163]
    buffer_load_dwordx4 v16, s[52:55], s51 offen offset:3072 lds
    ds_read_b128 v[52:55], v27 offset:0
    ds_read_b128 v[56:59], v41 offset:0
    ds_read_b128 v[60:63], v27 offset:4096
    ds_read_b128 v[64:67], v41 offset:8192
    v_mfma_f32_32x32x16_bf16 v[100:115], v[68:71], v[72:75], v[100:115]
    s_add_u32 m0, s10, 16384
    s_nop 0
    buffer_load_dwordx4 v17, s[56:59], s51 offen lds
    v_mfma_f32_32x32x16_bf16 v[116:131], v[76:79], v[72:75], v[116:131]
    buffer_load_dwordx4 v18, s[56:59], s51 offen offset:1024 lds
    v_mfma_f32_32x32x16_bf16 v[132:147], v[68:71], v[80:83], v[132:147]
    buffer_load_dwordx4 v19, s[56:59], s51 offen offset:2048 lds
    v_mfma_f32_32x32x16_bf16 v[148:163], v[76:79], v[80:83], v[148:163]
    buffer_load_dwordx4 v20, s[56:59], s51 offen offset:3072 lds
    ds_read_b128 v[68:71], v30 offset:0
    ds_read_b128 v[72:75], v44 offset:0
    ds_read_b128 v[76:79], v30 offset:4096
    ds_read_b128 v[80:83], v44 offset:8192
    s_waitcnt lgkmcnt(8)
    v_mfma_f32_32x32x16_bf16 v[100:115], v[84:87], v[88:91], v[100:115]
    s_add_u32 m0, s10, 32768
    s_add_u32 s51, s51, 128
    s_sub_u32 s9, s51, 1152
    s_min_u32 s51, s51, s9
    buffer_load_dwordx4 v13, s[52:55], s51 offen lds
    v_mfma_f32_32x32x16_bf16 v[116:131], v[92:95], v[88:91], v[116:131]
    buffer_load_dwordx4 v14, s[52:55], s51 offen offset:1024 lds
    v_mfma_f32_32x32x16_bf16 v[132:147], v[84:87], v[96:99], v[132:147]
    buffer_load_dwordx4 v15, s[52:55], s51 offen offset:2048 lds
    v_mfma_f32_32x32x16_bf16 v[148:163], v[92:95], v[96:99], v[148:163]
    buffer_load_dwordx4 v16, s[52:55], s51 offen offset:3072 lds
    ds_read_b128 v[84:87], v33 offset:0
    ds_read_b128 v[88:91], v47 offset:0
    ds_read_b128 v[92:95], v33 offset:4096
    ds_read_b128 v[96:99], v47 offset:8192
    s_waitcnt lgkmcnt(8)
    v_mfma_f32_32x32x16_bf16 v[100:115], v[52:55], v[56:59], v[100:115]
    s_add_u32 m0, s10, 49152
    s_nop 0
    buffer_load_dwordx4 v17, s[56:59], s51 offen lds
    v_mfma_f32_32x32x16_bf16 v[116:131], v[60:63], v[56:59], v[116:131]
    buffer_load_dwordx4 v18, s[56:59], s51 offen offset:1024 lds
    v_mfma_f32_32x32x16_bf16 v[132:147], v[52:55], v[64:67], v[132:147]
    buffer_load_dwordx4 v19, s[56:59], s51 offen offset:2048 lds
    v_mfma_f32_32x32x16_bf16 v[148:163], v[60:63], v[64:67], v[148:163]
    buffer_load_dwordx4 v20, s[56:59], s51 offen offset:3072 lds
    s_waitcnt vmcnt(24) lgkmcnt(0)
    s_barrier
    ds_read_b128 v[52:55], v24 offset:32768
    ds_read_b128 v[56:59], v38 offset:32768
    ds_read_b128 v[60:63], v24 offset:36864
    ds_read_b128 v[64:67], v38 offset:40960
    v_mfma_f32_32x32x16_bf16 v[100:115], v[68:71], v[72:75], v[100:115]
    s_add_u32 m0, s10, 65536
    s_add_u32 s51, s51, 128
    s_sub_u32 s9, s51, 1152
    s_min_u32 s51, s51, s9
    buffer_load_dwordx4 v13, s[52:55], s51 offen lds
    v_mfma_f32_32x32x16_bf16 v[116:131], v[76:79], v[72:75], v[116:131]
    buffer_load_dwordx4 v14, s[52:55], s51 offen offset:1024 lds
    v_mfma_f32_32x32x16_bf16 v[132:147], v[68:71], v[80:83], v[132:147]
    buffer_load_dwordx4 v15, s[52:55], s51 offen offset:2048 lds
    v_mfma_f32_32x32x16_bf16 v[148:163], v[76:79], v[80:83], v[148:163]
    buffer_load_dwordx4 v16, s[52:55], s51 offen offset:3072 lds
    ds_read_b128 v[68:71], v27 offset:32768
    ds_read_b128 v[72:75], v41 offset:32768
    ds_read_b128 v[76:79], v27 offset:36864
    ds_read_b128 v[80:83], v41 offset:40960
    v_mfma_f32_32x32x16_bf16 v[100:115], v[84:87], v[88:91], v[100:115]
    s_add_u32 m0, s10, 81920
    s_nop 0
    buffer_load_dwordx4 v17, s[56:59], s51 offen lds
    v_mfma_f32_32x32x16_bf16 v[116:131], v[92:95], v[88:91], v[116:131]
    buffer_load_dwordx4 v18, s[56:59], s51 offen offset:1024 lds
    v_mfma_f32_32x32x16_bf16 v[132:147], v[84:87], v[96:99], v[132:147]
    buffer_load_dwordx4 v19, s[56:59], s51 offen offset:2048 lds
    v_mfma_f32_32x32x16_bf16 v[148:163], v[92:95], v[96:99], v[148:163]
    buffer_load_dwordx4 v20, s[56:59], s51 offen offset:3072 lds
    ds_read_b128 v[84:87], v30 offset:32768
    ds_read_b128 v[88:91], v44 offset:32768
    ds_read_b128 v[92:95], v30 offset:36864
    ds_read_b128 v[96:99], v44 offset:40960
    s_waitcnt lgkmcnt(8)
    v_mfma_f32_32x32x16_bf16 v[100:115], v[52:55], v[56:59], v[100:115]
    v_lshlrev_b32 v4, 16, v4
    v_mfma_f32_32x32x16_bf16 v[116:131], v[60:63], v[56:59], v[116:131]
    v_lshlrev_b32 v5, 16, v5
    v_mfma_f32_32x32x16_bf16 v[132:147], v[52:55], v[64:67], v[132:147]
    v_lshlrev_b32 v6, 16, v6
    v_mfma_f32_32x32x16_bf16 v[148:163], v[60:63], v[64:67], v[148:163]
    v_mul_f32 v180, 0x3fb8aa3b, v6
    ds_read_b128 v[52:55], v33 offset:32768
    ds_read_b128 v[56:59], v47 offset:32768
    ds_read_b128 v[60:63], v33 offset:36864
    ds_read_b128 v[64:67], v47 offset:40960
    s_waitcnt lgkmcnt(8)
    v_mfma_f32_32x32x16_bf16 v[100:115], v[68:71], v[72:75], v[100:115]
    v_exp_f32 v180, v180
    v_mfma_f32_32x32x16_bf16 v[116:131], v[76:79], v[72:75], v[116:131]
    s_nop 0
    v_mfma_f32_32x32x16_bf16 v[132:147], v[68:71], v[80:83], v[132:147]
    v_cvt_pk_bf16_f32 v180, v180, v180
    v_mfma_f32_32x32x16_bf16 v[148:163], v[76:79], v[80:83], v[148:163]
    v_and_b32 v180, 0xffff0000, v180
    s_waitcnt vmcnt(24) lgkmcnt(0)
    s_barrier
    ds_read_b128 v[68:71], v25 offset:0
    ds_read_b128 v[72:75], v39 offset:0
    ds_read_b128 v[76:79], v25 offset:4096
    ds_read_b128 v[80:83], v39 offset:8192
    v_mfma_f32_32x32x16_bf16 v[100:115], v[84:87], v[88:91], v[100:115]
    s_add_u32 m0, s10, 98304
    s_add_u32 s51, s51, 128
    s_sub_u32 s9, s51, 1152
    s_min_u32 s51, s51, s9
    buffer_load_dwordx4 v13, s[52:55], s51 offen lds
    v_mul_f32 v181, v180, v4
    v_mfma_f32_32x32x16_bf16 v[116:131], v[92:95], v[88:91], v[116:131]
    buffer_load_dwordx4 v14, s[52:55], s51 offen offset:1024 lds
    v_mul_f32 v182, v180, v5
    v_mfma_f32_32x32x16_bf16 v[132:147], v[84:87], v[96:99], v[132:147]
    buffer_load_dwordx4 v15, s[52:55], s51 offen offset:2048 lds
    v_mul_f32 v181, 0x3fb8aa3b, v181
    v_mfma_f32_32x32x16_bf16 v[148:163], v[92:95], v[96:99], v[148:163]
    buffer_load_dwordx4 v16, s[52:55], s51 offen offset:3072 lds
    v_exp_f32 v181, v181
    ds_read_b128 v[84:87], v28 offset:0
    ds_read_b128 v[88:91], v42 offset:0
    ds_read_b128 v[92:95], v28 offset:4096
    ds_read_b128 v[96:99], v42 offset:8192
    v_mfma_f32_32x32x16_bf16 v[100:115], v[52:55], v[56:59], v[100:115]
    s_add_u32 m0, s10, 114688
    s_nop 0
    buffer_load_dwordx4 v17, s[56:59], s51 offen lds
    v_mul_f32 v182, 0.15915494, v182
    v_mfma_f32_32x32x16_bf16 v[116:131], v[60:63], v[56:59], v[116:131]
    buffer_load_dwordx4 v18, s[56:59], s51 offen offset:1024 lds
    v_fract_f32 v182, v182
    v_mfma_f32_32x32x16_bf16 v[132:147], v[52:55], v[64:67], v[132:147]
    buffer_load_dwordx4 v19, s[56:59], s51 offen offset:2048 lds
    v_cos_f32 v183, v182
    v_mfma_f32_32x32x16_bf16 v[148:163], v[60:63], v[64:67], v[148:163]
    buffer_load_dwordx4 v20, s[56:59], s51 offen offset:3072 lds
    v_sin_f32 v184, v182
    ds_read_b128 v[52:55], v31 offset:0
    ds_read_b128 v[56:59], v45 offset:0
    ds_read_b128 v[60:63], v31 offset:4096
    ds_read_b128 v[64:67], v45 offset:8192
    s_waitcnt lgkmcnt(8)
    v_mfma_f32_32x32x16_bf16 v[100:115], v[68:71], v[72:75], v[100:115]
    s_nop 0
    v_mfma_f32_32x32x16_bf16 v[116:131], v[76:79], v[72:75], v[116:131]
    v_mul_f32 v164, v181, v183
    v_mfma_f32_32x32x16_bf16 v[132:147], v[68:71], v[80:83], v[132:147]
    v_mul_f32 v166, v181, v184
    v_mfma_f32_32x32x16_bf16 v[148:163], v[76:79], v[80:83], v[148:163]
    v_mov_b32 v165, v164
    ds_read_b128 v[68:71], v34 offset:0
    ds_read_b128 v[72:75], v48 offset:0
    ds_read_b128 v[76:79], v34 offset:4096
    ds_read_b128 v[80:83], v48 offset:8192
    s_waitcnt lgkmcnt(8)
    v_mfma_f32_32x32x16_bf16 v[100:115], v[84:87], v[88:91], v[100:115]
    v_mov_b32 v167, v166
    v_mfma_f32_32x32x16_bf16 v[116:131], v[92:95], v[88:91], v[116:131]
    v_add_f32 v181, -1.0, v164
    v_mfma_f32_32x32x16_bf16 v[132:147], v[84:87], v[96:99], v[132:147]
    v_mul_f32 v182, v4, v4
    v_mfma_f32_32x32x16_bf16 v[148:163], v[92:95], v[96:99], v[148:163]
    v_fma_f32 v182, v5, v5, v182
    s_waitcnt vmcnt(24) lgkmcnt(0)
    s_barrier
    ds_read_b128 v[84:87], v23 offset:0
    ds_read_b128 v[88:91], v37 offset:0
    ds_read_b128 v[92:95], v23 offset:4096
    ds_read_b128 v[96:99], v37 offset:8192
    v_mfma_f32_32x32x16_bf16 v[100:115], v[52:55], v[56:59], v[100:115]
    v_rcp_f32 v182, v182
    v_mfma_f32_32x32x16_bf16 v[116:131], v[60:63], v[56:59], v[116:131]
    v_mul_f32 v183, v181, v4
    v_mfma_f32_32x32x16_bf16 v[132:147], v[52:55], v[64:67], v[132:147]
    v_fma_f32 v183, v166, v5, v183
    v_mfma_f32_32x32x16_bf16 v[148:163], v[60:63], v[64:67], v[148:163]
    v_mul_f32 v184, v166, v4
    ds_read_b128 v[52:55], v26 offset:0
    ds_read_b128 v[56:59], v40 offset:0
    ds_read_b128 v[60:63], v26 offset:4096
    ds_read_b128 v[64:67], v40 offset:8192
    v_mfma_f32_32x32x16_bf16 v[100:115], v[68:71], v[72:75], v[100:115]
    v_fma_f32 v184, -v181, v5, v184
    v_mfma_f32_32x32x16_bf16 v[116:131], v[76:79], v[72:75], v[116:131]
    v_add_f32 v182, v182, v182
    v_mfma_f32_32x32x16_bf16 v[132:147], v[68:71], v[80:83], v[132:147]
    v_mul_f32 v168, v183, v182
    v_mfma_f32_32x32x16_bf16 v[148:163], v[76:79], v[80:83], v[148:163]
    v_mul_f32 v170, v184, v182
    ds_read_b128 v[68:71], v29 offset:0
    ds_read_b128 v[72:75], v43 offset:0
    ds_read_b128 v[76:79], v29 offset:4096
    ds_read_b128 v[80:83], v43 offset:8192
    s_waitcnt lgkmcnt(8)
    v_mfma_f32_32x32x16_bf16 v[100:115], v[84:87], v[88:91], v[100:115]
    v_mov_b32 v169, v168
    v_mfma_f32_32x32x16_bf16 v[116:131], v[92:95], v[88:91], v[116:131]
    v_mov_b32 v171, v170
    v_mfma_f32_32x32x16_bf16 v[132:147], v[84:87], v[96:99], v[132:147]
    v_mul_f32 v183, v166, v166
    v_mfma_f32_32x32x16_bf16 v[148:163], v[92:95], v[96:99], v[148:163]
    v_mul_f32 v184, v164, v166
    ds_read_b128 v[84:87], v32 offset:0
    ds_read_b128 v[88:91], v46 offset:0
    ds_read_b128 v[92:95], v32 offset:4096
    ds_read_b128 v[96:99], v46 offset:8192
    s_waitcnt lgkmcnt(8)
    v_mfma_f32_32x32x16_bf16 v[100:115], v[52:55], v[56:59], v[100:115]
    v_fma_f32 v172, v164, v164, -v183
    v_mfma_f32_32x32x16_bf16 v[116:131], v[60:63], v[56:59], v[116:131]
    v_add_f32 v173, v184, v184
    v_mfma_f32_32x32x16_bf16 v[132:147], v[52:55], v[64:67], v[132:147]
    v_mul_f32 v183, v173, v173
    v_mfma_f32_32x32x16_bf16 v[148:163], v[60:63], v[64:67], v[148:163]
    v_mul_f32 v184, v172, v173
    s_waitcnt vmcnt(16) lgkmcnt(0)
    s_barrier
    ds_read_b128 v[52:55], v23 offset:32768
    ds_read_b128 v[56:59], v37 offset:32768
    ds_read_b128 v[60:63], v23 offset:36864
    ds_read_b128 v[64:67], v37 offset:40960
    v_mfma_f32_32x32x16_bf16 v[100:115], v[68:71], v[72:75], v[100:115]
    v_fma_f32 v172, v172, v172, -v183
    v_mfma_f32_32x32x16_bf16 v[116:131], v[76:79], v[72:75], v[116:131]
    v_add_f32 v173, v184, v184
    v_mfma_f32_32x32x16_bf16 v[132:147], v[68:71], v[80:83], v[132:147]
    v_mul_f32 v183, v173, v173
    v_mfma_f32_32x32x16_bf16 v[148:163], v[76:79], v[80:83], v[148:163]
    v_mul_f32 v184, v172, v173
    ds_read_b128 v[68:71], v26 offset:32768
    ds_read_b128 v[72:75], v40 offset:32768
    ds_read_b128 v[76:79], v26 offset:36864
    ds_read_b128 v[80:83], v40 offset:40960
    v_mfma_f32_32x32x16_bf16 v[100:115], v[84:87], v[88:91], v[100:115]
    v_fma_f32 v172, v172, v172, -v183
    v_mfma_f32_32x32x16_bf16 v[116:131], v[92:95], v[88:91], v[116:131]
    v_add_f32 v173, v184, v184
    v_mfma_f32_32x32x16_bf16 v[132:147], v[84:87], v[96:99], v[132:147]
    v_mul_f32 v183, v173, v173
    v_mfma_f32_32x32x16_bf16 v[148:163], v[92:95], v[96:99], v[148:163]
    v_mul_f32 v184, v172, v173
    ds_read_b128 v[84:87], v29 offset:32768
    ds_read_b128 v[88:91], v43 offset:32768
    ds_read_b128 v[92:95], v29 offset:36864
    ds_read_b128 v[96:99], v43 offset:40960
    s_waitcnt lgkmcnt(8)
    v_mfma_f32_32x32x16_bf16 v[100:115], v[52:55], v[56:59], v[100:115]
    v_fma_f32 v172, v172, v172, -v183
    v_mfma_f32_32x32x16_bf16 v[116:131], v[60:63], v[56:59], v[116:131]
    v_add_f32 v173, v184, v184
    v_mfma_f32_32x32x16_bf16 v[132:147], v[52:55], v[64:67], v[132:147]
    v_mul_f32 v183, v173, v173
    v_mfma_f32_32x32x16_bf16 v[148:163], v[60:63], v[64:67], v[148:163]
    v_mul_f32 v184, v172, v173
    ds_read_b128 v[52:55], v32 offset:32768
    ds_read_b128 v[56:59], v46 offset:32768
    ds_read_b128 v[60:63], v32 offset:36864
    ds_read_b128 v[64:67], v46 offset:40960
    s_waitcnt lgkmcnt(8)
    v_mfma_f32_32x32x16_bf16 v[100:115], v[68:71], v[72:75], v[100:115]
    v_fma_f32 v176, v172, v172, -v183
    v_mfma_f32_32x32x16_bf16 v[116:131], v[76:79], v[72:75], v[116:131]
    v_add_f32 v177, v184, v184
    v_mfma_f32_32x32x16_bf16 v[132:147], v[68:71], v[80:83], v[132:147]
    v_mul_f32 v183, v177, v177
    v_mfma_f32_32x32x16_bf16 v[148:163], v[76:79], v[80:83], v[148:163]
    v_mul_f32 v184, v176, v177
    s_waitcnt vmcnt(8) lgkmcnt(0)
    s_barrier
    ds_read_b128 v[68:71], v24 offset:0
    ds_read_b128 v[72:75], v38 offset:0
    ds_read_b128 v[76:79], v24 offset:4096
    ds_read_b128 v[80:83], v38 offset:8192
    v_mfma_f32_32x32x16_bf16 v[100:115], v[84:87], v[88:91], v[100:115]
    v_fma_f32 v178, v176, v176, -v183
    v_mfma_f32_32x32x16_bf16 v[116:131], v[92:95], v[88:91], v[116:131]
    v_add_f32 v179, v184, v184
    v_mfma_f32_32x32x16_bf16 v[132:147], v[84:87], v[96:99], v[132:147]
    v_mul_f32 v183, v179, v179
    v_mfma_f32_32x32x16_bf16 v[148:163], v[92:95], v[96:99], v[148:163]
    v_mul_f32 v184, v178, v179
    ds_read_b128 v[84:87], v27 offset:0
    ds_read_b128 v[88:91], v41 offset:0
    ds_read_b128 v[92:95], v27 offset:4096
    ds_read_b128 v[96:99], v41 offset:8192
    v_mfma_f32_32x32x16_bf16 v[100:115], v[52:55], v[56:59], v[100:115]
    v_fma_f32 v174, v178, v178, -v183
    v_mfma_f32_32x32x16_bf16 v[116:131], v[60:63], v[56:59], v[116:131]
    v_add_f32 v175, v184, v184
    v_mfma_f32_32x32x16_bf16 v[132:147], v[52:55], v[64:67], v[132:147]
    v_cmp_lt_u32 vcc, 31, v1
    v_mfma_f32_32x32x16_bf16 v[148:163], v[60:63], v[64:67], v[148:163]
    s_cmp_lg_u32 s12, 0
    s_cselect_b64 s[72:73], -1, 0
    ds_read_b128 v[52:55], v30 offset:0
    ds_read_b128 v[56:59], v44 offset:0
    ds_read_b128 v[60:63], v30 offset:4096
    ds_read_b128 v[64:67], v44 offset:8192
    s_waitcnt lgkmcnt(8)
    v_mfma_f32_32x32x16_bf16 v[100:115], v[68:71], v[72:75], v[100:115]
    v_mov_b32 v190, v164
    v_mfma_f32_32x32x16_bf16 v[116:131], v[76:79], v[72:75], v[116:131]
    v_mov_b32 v191, v166
    v_mfma_f32_32x32x16_bf16 v[132:147], v[68:71], v[80:83], v[132:147]
    v_cndmask_b32 v176, 1.0, v176, vcc
    v_mfma_f32_32x32x16_bf16 v[148:163], v[76:79], v[80:83], v[148:163]
    v_cndmask_b32 v177, 0, v177, vcc
    ds_read_b128 v[68:71], v33 offset:0
    ds_read_b128 v[72:75], v47 offset:0
    ds_read_b128 v[76:79], v33 offset:4096
    ds_read_b128 v[80:83], v47 offset:8192
    s_waitcnt lgkmcnt(8)
    v_mfma_f32_32x32x16_bf16 v[100:115], v[84:87], v[88:91], v[100:115]
    v_cndmask_b32 v178, 1.0, v178, s[72:73]
    v_mfma_f32_32x32x16_bf16 v[116:131], v[92:95], v[88:91], v[116:131]
    v_cndmask_b32 v179, 0, v179, s[72:73]
    v_mfma_f32_32x32x16_bf16 v[132:147], v[84:87], v[96:99], v[132:147]
    v_mul_f32 v192, v176, v178
    v_mfma_f32_32x32x16_bf16 v[148:163], v[92:95], v[96:99], v[148:163]
    v_mul_f32 v193, v176, v179
    s_waitcnt vmcnt(0) lgkmcnt(0)
    s_barrier
    ds_read_b128 v[84:87], v24 offset:32768
    ds_read_b128 v[88:91], v38 offset:32768
    ds_read_b128 v[92:95], v24 offset:36864
    ds_read_b128 v[96:99], v38 offset:40960
    v_mfma_f32_32x32x16_bf16 v[100:115], v[52:55], v[56:59], v[100:115]
    v_fma_f32 v192, -v177, v179, v192
    v_mfma_f32_32x32x16_bf16 v[116:131], v[60:63], v[56:59], v[116:131]
    v_fma_f32 v193, v177, v178, v193
    v_mfma_f32_32x32x16_bf16 v[132:147], v[52:55], v[64:67], v[132:147]
    v_mul_f32 v188, v192, v168
    v_mfma_f32_32x32x16_bf16 v[148:163], v[60:63], v[64:67], v[148:163]
    v_mul_f32 v189, v192, v170
    ds_read_b128 v[52:55], v27 offset:32768
    ds_read_b128 v[56:59], v41 offset:32768
    ds_read_b128 v[60:63], v27 offset:36864
    ds_read_b128 v[64:67], v41 offset:40960
    v_mfma_f32_32x32x16_bf16 v[100:115], v[68:71], v[72:75], v[100:115]
    v_fma_f32 v188, -v193, v170, v188
    v_mfma_f32_32x32x16_bf16 v[116:131], v[76:79], v[72:75], v[116:131]
    v_fma_f32 v189, v193, v168, v189
    v_mfma_f32_32x32x16_bf16 v[132:147], v[68:71], v[80:83], v[132:147]
    v_mfma_f32_32x32x16_bf16 v[148:163], v[76:79], v[80:83], v[148:163]
    ds_read_b128 v[68:71], v30 offset:32768
    ds_read_b128 v[72:75], v44 offset:32768
    ds_read_b128 v[76:79], v30 offset:36864
    ds_read_b128 v[80:83], v44 offset:40960
    s_waitcnt lgkmcnt(8)
    v_mfma_f32_32x32x16_bf16 v[100:115], v[84:87], v[88:91], v[100:115]
    v_mfma_f32_32x32x16_bf16 v[116:131], v[92:95], v[88:91], v[116:131]
    v_mfma_f32_32x32x16_bf16 v[132:147], v[84:87], v[96:99], v[132:147]
    v_mfma_f32_32x32x16_bf16 v[148:163], v[92:95], v[96:99], v[148:163]
    ds_read_b128 v[84:87], v33 offset:32768
    ds_read_b128 v[88:91], v47 offset:32768
    ds_read_b128 v[92:95], v33 offset:36864
    ds_read_b128 v[96:99], v47 offset:40960
    s_waitcnt lgkmcnt(8)
    v_mfma_f32_32x32x16_bf16 v[100:115], v[52:55], v[56:59], v[100:115]
    v_mfma_f32_32x32x16_bf16 v[116:131], v[60:63], v[56:59], v[116:131]
    v_mfma_f32_32x32x16_bf16 v[132:147], v[52:55], v[64:67], v[132:147]
    v_mfma_f32_32x32x16_bf16 v[148:163], v[60:63], v[64:67], v[148:163]
    s_waitcnt lgkmcnt(4)
    v_mfma_f32_32x32x16_bf16 v[100:115], v[68:71], v[72:75], v[100:115]
    v_mfma_f32_32x32x16_bf16 v[116:131], v[76:79], v[72:75], v[116:131]
    v_mfma_f32_32x32x16_bf16 v[132:147], v[68:71], v[80:83], v[132:147]
    v_mfma_f32_32x32x16_bf16 v[148:163], v[76:79], v[80:83], v[148:163]
    s_waitcnt lgkmcnt(0)
    v_mfma_f32_32x32x16_bf16 v[100:115], v[84:87], v[88:91], v[100:115]
    v_mfma_f32_32x32x16_bf16 v[116:131], v[92:95], v[88:91], v[116:131]
    v_mfma_f32_32x32x16_bf16 v[132:147], v[84:87], v[96:99], v[132:147]
    v_mfma_f32_32x32x16_bf16 v[148:163], v[92:95], v[96:99], v[148:163]
    s_add_u32 s60, s48, 0xb00000
    s_addc_u32 s61, s49, 0
    s_mov_b32 s62, 0x12000
    s_mov_b32 s63, 0x00020000
    s_add_u32 s64, s48, 0xb20000
    s_addc_u32 s65, s49, 0
    s_mov_b32 s66, 0xa2000
    s_mov_b32 s67, 0x00020000
    s_add_u32 s68, s48, 0xe00000
    s_addc_u32 s69, s49, 0
    s_mov_b32 s70, 0x480000
    s_mov_b32 s71, 0x00020000
    v_lshrrev_b32 v194, 5, v1
    v_subrev_u32 v196, s14, v2
    v_lshlrev_b32 v196, 3, v196
    s_lshl_b32 s7, s12, 11
    v_lshl_add_u32 v195, v194, 10, v196
    v_add_u32 v195, s7, v195
    s_lshl_b32 s7, s4, 13
    v_add_u32 v197, s7, v196
    s_nop 7
    v_lshlrev_b32 v218, 4, v1
    s_mul_i32 s6, s3, 9
    s_add_u32 s6, s6, s4
    s_lshl_b32 s6, s6, 2
    s_add_u32 s6, s6, s5
    s_lshl_b32 s8, s6, 10
    s_lshl_b32 s6, s6, 13
    s_add_u32 s7, s6, 4096
    s_cmp_lg_u32 s3, 0
    s_cbranch_scc1 Lnoc_2
    s_lshl_b32 s9, s8, 1
    s_add_u32 s9, s9, 589824
    buffer_store_dwordx4 v[188:191], v218, s[64:67], s9 offen sc0 sc1
    buffer_store_dwordx4 v[172:175], v218, s[64:67], s9 offen offset:1024 sc0 sc1
Lnoc_2:
    v_pk_fma_f32 v[102:103], v[164:165], v[100:101], v[102:103]
    v_pk_fma_f32 v[134:135], v[166:167], v[100:101], v[134:135]
    v_pk_fma_f32 v[102:103], v[166:167], v[132:133], v[102:103] neg_lo:[1,0,0] neg_hi:[1,0,0]
    v_pk_fma_f32 v[134:135], v[164:165], v[132:133], v[134:135]
    v_pk_fma_f32 v[104:105], v[164:165], v[102:103], v[104:105]
    v_pk_mul_f32 v[220:221], v[170:171], v[132:133]
    v_pk_fma_f32 v[136:137], v[166:167], v[102:103], v[136:137]
    v_pk_mul_f32 v[222:223], v[170:171], v[100:101]
    v_pk_fma_f32 v[104:105], v[166:167], v[134:135], v[104:105] neg_lo:[1,0,0] neg_hi:[1,0,0]
    v_pk_fma_f32 v[100:101], v[168:169], v[100:101], v[220:221] neg_lo:[0,0,1] neg_hi:[0,0,1]
    v_pk_fma_f32 v[136:137], v[164:165], v[134:135], v[136:137]
    v_pk_fma_f32 v[132:133], v[168:169], v[132:133], v[222:223] neg_lo:[1,0,1] neg_hi:[1,0,1]
    v_pk_fma_f32 v[106:107], v[164:165], v[104:105], v[106:107]
    v_pk_mul_f32 v[224:225], v[170:171], v[134:135]
    v_pk_fma_f32 v[138:139], v[166:167], v[104:105], v[138:139]
    v_pk_mul_f32 v[226:227], v[170:171], v[102:103]
    v_pk_fma_f32 v[106:107], v[166:167], v[136:137], v[106:107] neg_lo:[1,0,0] neg_hi:[1,0,0]
    v_pk_fma_f32 v[102:103], v[168:169], v[102:103], v[224:225] neg_lo:[0,0,1] neg_hi:[0,0,1]
    v_pk_fma_f32 v[138:139], v[164:165], v[136:137], v[138:139]
    v_pk_fma_f32 v[134:135], v[168:169], v[134:135], v[226:227] neg_lo:[1,0,1] neg_hi:[1,0,1]
    v_pk_fma_f32 v[108:109], v[164:165], v[106:107], v[108:109]
    v_pk_mul_f32 v[220:221], v[170:171], v[136:137]
    v_pk_fma_f32 v[140:141], v[166:167], v[106:107], v[140:141]
    v_pk_mul_f32 v[222:223], v[170:171], v[104:105]
    v_pk_fma_f32 v[108:109], v[166:167], v[138:139], v[108:109] neg_lo:[1,0,0] neg_hi:[1,0,0]
    v_pk_fma_f32 v[104:105], v[168:169], v[104:105], v[220:221] neg_lo:[0,0,1] neg_hi:[0,0,1]
    v_pk_fma_f32 v[140:141], v[164:165], v[138:139], v[140:141]
    v_pk_fma_f32 v[136:137], v[168:169], v[136:137], v[222:223] neg_lo:[1,0,1] neg_hi:[1,0,1]
    v_pk_fma_f32 v[110:111], v[164:165], v[108:109], v[110:111]
    v_pk_mul_f32 v[224:225], v[170:171], v[138:139]
    v_pk_fma_f32 v[142:143], v[166:167], v[108:109], v[142:143]
    v_pk_mul_f32 v[226:227], v[170:171], v[106:107]
    v_pk_fma_f32 v[110:111], v[166:167], v[140:141], v[110:111] neg_lo:[1,0,0] neg_hi:[1,0,0]
    v_pk_fma_f32 v[106:107], v[168:169], v[106:107], v[224:225] neg_lo:[0,0,1] neg_hi:[0,0,1]
    v_pk_fma_f32 v[142:143], v[164:165], v[140:141], v[142:143]
    v_pk_fma_f32 v[138:139], v[168:169], v[138:139], v[226:227] neg_lo:[1,0,1] neg_hi:[1,0,1]
    v_pk_fma_f32 v[112:113], v[164:165], v[110:111], v[112:113]
    v_pk_mul_f32 v[220:221], v[170:171], v[140:141]
    v_pk_fma_f32 v[144:145], v[166:167], v[110:111], v[144:145]
    v_pk_mul_f32 v[222:223], v[170:171], v[108:109]
    v_pk_fma_f32 v[112:113], v[166:167], v[142:143], v[112:113] neg_lo:[1,0,0] neg_hi:[1,0,0]
    v_pk_fma_f32 v[108:109], v[168:169], v[108:109], v[220:221] neg_lo:[0,0,1] neg_hi:[0,0,1]
    v_pk_fma_f32 v[144:145], v[164:165], v[142:143], v[144:145]
    v_pk_fma_f32 v[140:141], v[168:169], v[140:141], v[222:223] neg_lo:[1,0,1] neg_hi:[1,0,1]
    v_pk_fma_f32 v[114:115], v[164:165], v[112:113], v[114:115]
    v_pk_mul_f32 v[224:225], v[170:171], v[142:143]
    v_pk_fma_f32 v[146:147], v[166:167], v[112:113], v[146:147]
    v_pk_mul_f32 v[226:227], v[170:171], v[110:111]
    v_pk_fma_f32 v[114:115], v[166:167], v[144:145], v[114:115] neg_lo:[1,0,0] neg_hi:[1,0,0]
    v_pk_fma_f32 v[110:111], v[168:169], v[110:111], v[224:225] neg_lo:[0,0,1] neg_hi:[0,0,1]
    v_pk_fma_f32 v[146:147], v[164:165], v[144:145], v[146:147]
    v_pk_fma_f32 v[142:143], v[168:169], v[142:143], v[226:227] neg_lo:[1,0,1] neg_hi:[1,0,1]
    v_pk_fma_f32 v[116:117], v[164:165], v[114:115], v[116:117]
    v_pk_mul_f32 v[220:221], v[170:171], v[144:145]
    v_pk_fma_f32 v[148:149], v[166:167], v[114:115], v[148:149]
    v_pk_mul_f32 v[222:223], v[170:171], v[112:113]
    v_pk_fma_f32 v[116:117], v[166:167], v[146:147], v[116:117] neg_lo:[1,0,0] neg_hi:[1,0,0]
    v_pk_fma_f32 v[112:113], v[168:169], v[112:113], v[220:221] neg_lo:[0,0,1] neg_hi:[0,0,1]
    v_pk_fma_f32 v[148:149], v[164:165], v[146:147], v[148:149]
    v_pk_fma_f32 v[144:145], v[168:169], v[144:145], v[222:223] neg_lo:[1,0,1] neg_hi:[1,0,1]
    v_pk_fma_f32 v[118:119], v[164:165], v[116:117], v[118:119]
    v_pk_mul_f32 v[224:225], v[170:171], v[146:147]
    v_pk_fma_f32 v[150:151], v[166:167], v[116:117], v[150:151]
    v_pk_mul_f32 v[226:227], v[170:171], v[114:115]
    v_pk_fma_f32 v[118:119], v[166:167], v[148:149], v[118:119] neg_lo:[1,0,0] neg_hi:[1,0,0]
    v_pk_fma_f32 v[114:115], v[168:169], v[114:115], v[224:225] neg_lo:[0,0,1] neg_hi:[0,0,1]
    v_pk_fma_f32 v[150:151], v[164:165], v[148:149], v[150:151]
    v_pk_fma_f32 v[146:147], v[168:169], v[146:147], v[226:227] neg_lo:[1,0,1] neg_hi:[1,0,1]
    v_pk_fma_f32 v[120:121], v[164:165], v[118:119], v[120:121]
    v_cvt_pk_bf16_f32 v52, v100, v102
    v_pk_fma_f32 v[152:153], v[166:167], v[118:119], v[152:153]
    v_cvt_pk_bf16_f32 v53, v104, v106
    v_pk_fma_f32 v[120:121], v[166:167], v[150:151], v[120:121] neg_lo:[1,0,0] neg_hi:[1,0,0]
    v_cvt_pk_bf16_f32 v54, v108, v110
    v_pk_fma_f32 v[152:153], v[164:165], v[150:151], v[152:153]
    v_cvt_pk_bf16_f32 v55, v112, v114
    v_pk_fma_f32 v[122:123], v[164:165], v[120:121], v[122:123]
    buffer_store_dwordx4 v[52:55], v218, s[68:71], s6 offen offset:0 sc0 sc1
    v_pk_fma_f32 v[154:155], v[166:167], v[120:121], v[154:155]
    v_cvt_pk_bf16_f32 v60, v101, v103
    v_pk_fma_f32 v[122:123], v[166:167], v[152:153], v[122:123] neg_lo:[1,0,0] neg_hi:[1,0,0]
    v_cvt_pk_bf16_f32 v61, v105, v107
    v_pk_fma_f32 v[154:155], v[164:165], v[152:153], v[154:155]
    v_cvt_pk_bf16_f32 v62, v109, v111
    v_pk_fma_f32 v[124:125], v[164:165], v[122:123], v[124:125]
    v_cvt_pk_bf16_f32 v63, v113, v115
    v_pk_fma_f32 v[156:157], v[166:167], v[122:123], v[156:157]
    buffer_store_dwordx4 v[60:63], v218, s[68:71], s6 offen offset:2048 sc0 sc1
    v_pk_fma_f32 v[124:125], v[166:167], v[154:155], v[124:125] neg_lo:[1,0,0] neg_hi:[1,0,0]
    v_cvt_pk_bf16_f32 v68, v132, v134
    v_pk_fma_f32 v[156:157], v[164:165], v[154:155], v[156:157]
    v_cvt_pk_bf16_f32 v69, v136, v138
    v_pk_fma_f32 v[126:127], v[164:165], v[124:125], v[126:127]
    v_cvt_pk_bf16_f32 v70, v140, v142
    v_pk_fma_f32 v[158:159], v[166:167], v[124:125], v[158:159]
    v_cvt_pk_bf16_f32 v71, v144, v146
    v_pk_fma_f32 v[126:127], v[166:167], v[156:157], v[126:127] neg_lo:[1,0,0] neg_hi:[1,0,0]
    buffer_store_dwordx4 v[68:71], v218, s[68:71], s7 offen offset:0 sc0 sc1
    v_pk_fma_f32 v[158:159], v[164:165], v[156:157], v[158:159]
    v_cvt_pk_bf16_f32 v76, v133, v135
    v_pk_fma_f32 v[128:129], v[164:165], v[126:127], v[128:129]
    v_cvt_pk_bf16_f32 v77, v137, v139
    v_pk_fma_f32 v[160:161], v[166:167], v[126:127], v[160:161]
    v_cvt_pk_bf16_f32 v78, v141, v143
    v_pk_fma_f32 v[128:129], v[166:167], v[158:159], v[128:129] neg_lo:[1,0,0] neg_hi:[1,0,0]
    v_cvt_pk_bf16_f32 v79, v145, v147
    v_pk_fma_f32 v[160:161], v[164:165], v[158:159], v[160:161]
    buffer_store_dwordx4 v[76:79], v218, s[68:71], s7 offen offset:2048 sc0 sc1
    v_pk_fma_f32 v[130:131], v[164:165], v[128:129], v[130:131]
    v_pk_fma_f32 v[162:163], v[166:167], v[128:129], v[162:163]
    v_pk_fma_f32 v[130:131], v[166:167], v[160:161], v[130:131] neg_lo:[1,0,0] neg_hi:[1,0,0]
    v_pk_fma_f32 v[162:163], v[164:165], v[160:161], v[162:163]
    v_mov_b32 v214, v130
    v_mov_b32 v216, v131
    v_mov_b32 v215, v162
    v_mov_b32 v217, v163
    ds_write_b64 v195, v[214:215]
    ds_write_b64 v195, v[216:217] offset:512
    v_pk_mul_f32 v[220:221], v[170:171], v[148:149]
    v_pk_mul_f32 v[222:223], v[170:171], v[116:117]
    v_pk_fma_f32 v[116:117], v[168:169], v[116:117], v[220:221] neg_lo:[0,0,1] neg_hi:[0,0,1]
    v_pk_fma_f32 v[148:149], v[168:169], v[148:149], v[222:223] neg_lo:[1,0,1] neg_hi:[1,0,1]
    v_pk_mul_f32 v[224:225], v[170:171], v[150:151]
    v_pk_mul_f32 v[226:227], v[170:171], v[118:119]
    v_pk_fma_f32 v[118:119], v[168:169], v[118:119], v[224:225] neg_lo:[0,0,1] neg_hi:[0,0,1]
    v_pk_fma_f32 v[150:151], v[168:169], v[150:151], v[226:227] neg_lo:[1,0,1] neg_hi:[1,0,1]
    v_pk_mul_f32 v[220:221], v[170:171], v[152:153]
    v_pk_mul_f32 v[222:223], v[170:171], v[120:121]
    v_pk_fma_f32 v[120:121], v[168:169], v[120:121], v[220:221] neg_lo:[0,0,1] neg_hi:[0,0,1]
    v_pk_fma_f32 v[152:153], v[168:169], v[152:153], v[222:223] neg_lo:[1,0,1] neg_hi:[1,0,1]
    v_pk_mul_f32 v[224:225], v[170:171], v[154:155]
    v_pk_mul_f32 v[226:227], v[170:171], v[122:123]
    v_pk_fma_f32 v[122:123], v[168:169], v[122:123], v[224:225] neg_lo:[0,0,1] neg_hi:[0,0,1]
    v_pk_fma_f32 v[154:155], v[168:169], v[154:155], v[226:227] neg_lo:[1,0,1] neg_hi:[1,0,1]
    s_waitcnt lgkmcnt(0)
    s_barrier
    ds_read_b64 v[198:199], v196 offset:0
    ds_read_b64 v[200:201], v196 offset:512
    ds_read_b64 v[202:203], v196 offset:1024
    ds_read_b64 v[204:205], v196 offset:1536
    ds_read_b64 v[206:207], v196 offset:2048
    ds_read_b64 v[208:209], v196 offset:2560
    ds_read_b64 v[210:211], v196 offset:3072
    ds_read_b64 v[212:213], v196 offset:3584
    v_pk_mul_f32 v[220:221], v[170:171], v[156:157]
    v_pk_mul_f32 v[222:223], v[170:171], v[124:125]
    v_pk_fma_f32 v[124:125], v[168:169], v[124:125], v[220:221] neg_lo:[0,0,1] neg_hi:[0,0,1]
    v_pk_fma_f32 v[156:157], v[168:169], v[156:157], v[222:223] neg_lo:[1,0,1] neg_hi:[1,0,1]
    v_pk_mul_f32 v[224:225], v[170:171], v[158:159]
    v_pk_mul_f32 v[226:227], v[170:171], v[126:127]
    v_pk_fma_f32 v[126:127], v[168:169], v[126:127], v[224:225] neg_lo:[0,0,1] neg_hi:[0,0,1]
    v_pk_fma_f32 v[158:159], v[168:169], v[158:159], v[226:227] neg_lo:[1,0,1] neg_hi:[1,0,1]
    v_pk_mul_f32 v[220:221], v[170:171], v[160:161]
    v_pk_mul_f32 v[222:223], v[170:171], v[128:129]
    v_pk_fma_f32 v[128:129], v[168:169], v[128:129], v[220:221] neg_lo:[0,0,1] neg_hi:[0,0,1]
    v_pk_fma_f32 v[160:161], v[168:169], v[160:161], v[222:223] neg_lo:[1,0,1] neg_hi:[1,0,1]
    v_pk_mul_f32 v[224:225], v[170:171], v[162:163]
    v_pk_mul_f32 v[226:227], v[170:171], v[130:131]
    v_pk_fma_f32 v[130:131], v[168:169], v[130:131], v[224:225] neg_lo:[0,0,1] neg_hi:[0,0,1]
    v_pk_fma_f32 v[162:163], v[168:169], v[162:163], v[226:227] neg_lo:[1,0,1] neg_hi:[1,0,1]
    v_cvt_pk_bf16_f32 v56, v116, v118
    v_cvt_pk_bf16_f32 v57, v120, v122
    v_cvt_pk_bf16_f32 v58, v124, v126
    v_cvt_pk_bf16_f32 v59, v128, v130
    buffer_store_dwordx4 v[56:59], v218, s[68:71], s6 offen offset:1024 sc0 sc1
    v_cvt_pk_bf16_f32 v64, v117, v119
    v_cvt_pk_bf16_f32 v65, v121, v123
    v_cvt_pk_bf16_f32 v66, v125, v127
    v_cvt_pk_bf16_f32 v67, v129, v131
    buffer_store_dwordx4 v[64:67], v218, s[68:71], s6 offen offset:3072 sc0 sc1
    v_cvt_pk_bf16_f32 v72, v148, v150
    v_cvt_pk_bf16_f32 v73, v152, v154
    v_cvt_pk_bf16_f32 v74, v156, v158
    v_cvt_pk_bf16_f32 v75, v160, v162
    buffer_store_dwordx4 v[72:75], v218, s[68:71], s7 offen offset:1024 sc0 sc1
    v_cvt_pk_bf16_f32 v80, v149, v151
    v_cvt_pk_bf16_f32 v81, v153, v155
    v_cvt_pk_bf16_f32 v82, v157, v159
    v_cvt_pk_bf16_f32 v83, v161, v163
    buffer_store_dwordx4 v[80:83], v218, s[68:71], s7 offen offset:3072 sc0 sc1
    s_waitcnt lgkmcnt(0)
    v_fma_f32 v230, v172, v198, v200
    v_fma_f32 v231, v172, v199, v201
    v_fma_f32 v230, -v173, v199, v230
    v_fma_f32 v231, v173, v198, v231
    v_fma_f32 v232, v172, v230, v202
    v_fma_f32 v233, v172, v231, v203
    v_fma_f32 v232, -v173, v231, v232
    v_fma_f32 v233, v173, v230, v233
    v_fma_f32 v234, v172, v232, v204
    v_fma_f32 v235, v172, v233, v205
    v_fma_f32 v234, -v173, v233, v234
    v_fma_f32 v235, v173, v232, v235
    v_fma_f32 v236, v172, v234, v206
    v_fma_f32 v237, v172, v235, v207
    v_fma_f32 v236, -v173, v235, v236
    v_fma_f32 v237, v173, v234, v237
    v_fma_f32 v238, v172, v236, v208
    v_fma_f32 v239, v172, v237, v209
    v_fma_f32 v238, -v173, v237, v238
    v_fma_f32 v239, v173, v236, v239
    v_fma_f32 v240, v172, v238, v210
    v_fma_f32 v241, v172, v239, v211
    v_fma_f32 v240, -v173, v239, v240
    v_fma_f32 v241, v173, v238, v241
    v_fma_f32 v242, v172, v240, v212
    v_fma_f32 v243, v172, v241, v213
    v_fma_f32 v242, -v173, v241, v242
    v_fma_f32 v243, v173, v240, v243
    v_cmp_lt_u32 vcc, 31, v1
    s_cmp_lg_u32 s12, 0
    s_cselect_b64 s[72:73], -1, 0
    s_cbranch_scc1 Lnopub_3
    s_lshl_b32 s7, s3, 9
    s_mov_b32 exec_hi, 0
    buffer_store_dwordx2 v[242:243], v197, s[60:63], s7 offen sc0 sc1
    s_mov_b32 exec_hi, -1
Lnopub_3:
    v_cndmask_b32 v220, 0, v230, vcc
    v_cndmask_b32 v221, 0, v231, vcc
    v_cndmask_b32 v222, v234, v238, vcc
    v_cndmask_b32 v223, v235, v239, vcc
    v_cndmask_b32 v244, v220, v222, s[72:73]
    v_cndmask_b32 v246, v221, v223, s[72:73]
    v_fma_f32 v245, v172, v244, v214
    v_fma_f32 v247, v172, v246, v215
    v_fma_f32 v245, -v173, v246, v245
    v_fma_f32 v247, v173, v244, v247
    v_pk_mul_f32 v[248:249], v[168:169], v[244:245]
    v_pk_mul_f32 v[250:251], v[168:169], v[246:247]
    v_pk_fma_f32 v[248:249], v[170:171], v[246:247], v[248:249] neg_lo:[1,0,0] neg_hi:[1,0,0]
    v_pk_fma_f32 v[250:251], v[170:171], v[244:245], v[250:251]
    buffer_store_dwordx4 v[248:251], v218, s[64:67], s8 offen sc0 sc1
    s_endpgm
L_k1_end:
    s_endpgm
.globl k2_kernel
.p2align 8
.type k2_kernel,@function
k2_kernel:
    s_cmp_ge_u32 s2, 256
    s_cbranch_scc1 L_att_end
    s_load_dwordx16 s[16:31], s[0:1], 0
    s_load_dwordx16 s[32:47], s[0:1], 64
    s_load_dwordx2 s[48:49], s[0:1], 128
    v_and_b32 v1, 63, v0
    v_lshrrev_b32 v2, 6, v0
    s_and_b32 s6, s2, 7
    v_readfirstlane_b32 s5, v2
    s_lshr_b32 s7, s2, 3
    v_lshlrev_b32 v2, 2, v1
    v_add_u32 v2, 88064, v2
    v_mov_b32 v3, 0
    s_mov_b32 exec_hi, 0
    ds_write_b32 v2, v3
    s_mov_b32 exec_hi, -1
    s_cmp_ge_u32 s5, 8
    s_cbranch_scc1 L_att_g
    s_setprio 0
    s_and_b32 s12, s7, 7
    s_mov_b32 s50, s12
    s_lshl_b32 s6, s6, 3
    s_add_u32 s12, s12, s6
    s_lshr_b32 s4, s7, 3
    s_lshl_b32 s4, s4, 3
    s_add_u32 s13, s4, s5
    v_lshlrev_b32 v3, 4, v1
    v_and_b32 v4, 31, v1
    s_lshl_b32 s6, s12, 5
    v_add_u32 v4, s6, v4
    v_mul_u32_u24 v4, 1152, v4
    v_lshrrev_b32 v5, 5, v1
    s_mul_i32 s6, s13, 36
    v_add_u32 v4, s6, v4
    v_mov_b32 v7, v4
    v_lshl_add_u32 v4, v5, 4, v4
    s_lshl_b32 s10, s5, 11
    s_lshl_b32 s11, s5, 10
    s_add_u32 s11, s11, 16384
    s_waitcnt lgkmcnt(0)
    s_add_u32 s52, s48, 0x280000
    s_addc_u32 s53, s49, 0
    s_mov_b32 s54, 0x24000
    s_mov_b32 s55, 0x00020000
    s_mov_b32 s56, s48
    s_mov_b32 s57, s49
    s_mov_b32 s58, 0x240000
    s_mov_b32 s59, 0x00020000
    s_add_u32 s60, s48, 0x800000
    s_addc_u32 s61, s49, 0
    s_mov_b32 s62, 0x240000
    s_mov_b32 s63, 0x00020000
    s_add_u32 s6, s50, 0
    s_and_b32 s6, s6, 7
    s_mul_i32 s6, s6, 18432
    s_cmp_ge_u32 s5, 2
    s_cbranch_scc1 Lx_4
    s_add_u32 m0, s11, 0
    s_add_u32 s9, s6, s11
    buffer_load_dwordx4 v3, s[52:55], s9 offen lds
Lx_4:
    s_add_u32 m0, s10, 0
    s_add_u32 s9, s6, s10
    buffer_load_dwordx4 v3, s[52:55], s9 offen lds
    buffer_load_dwordx4 v3, s[52:55], s9 offen offset:1024 lds
    buffer_load_dwordx4 v[8:11], v4, s[56:59], 0 offen
    buffer_load_dword v12, v7, s[56:59], 0 offen offset:32
    s_barrier
    v_and_b32 v6, 31, v1
    v_lshlrev_b32 v14, 2, v6
    v_min_u32 v15, 17, v6
    v_lshlrev_b32 v15, 4, v15
    v_mul_u32_u24 v18, 288, v5
    v_add_u32 v15, v15, v18
    v_mov_b32 v16, 88064
    v_mov_b32 v17, 1
    v_mov_b32 v29, 0x3f803f80
    v_mov_b32 v31, 0x3f803f80
    v_mov_b32 v13, 0
    v_and_b32 v105, 27, v6
    v_cmp_eq_u32 vcc, 18, v105
    v_mov_b32 v105, 0x3f803f80
    s_mov_b32 s76, 0x3ffff
    s_mov_b32 s77, 0x3ffff
    v_cndmask_b32 v105, 0, v105, vcc
    v_mov_b32 v32, v105
    v_mov_b32 v33, v105
    v_mov_b32 v34, v105
    v_mov_b32 v35, v105
    v_mov_b32 v36, v105
    v_mov_b32 v37, v105
    v_mov_b32 v38, v105
    v_mov_b32 v39, v105
    v_mov_b32 v40, v105
    v_mov_b32 v41, v105
    v_mov_b32 v42, v105
    v_mov_b32 v43, v105
    v_mov_b32 v44, v105
    v_mov_b32 v45, v105
    v_mov_b32 v46, v105
    v_mov_b32 v47, v105
    v_cmp_gt_u32 s[64:65], 32, v1
    s_waitcnt vmcnt(0)
    s_mov_b64 exec, 1
    ds_add_u32 v16, v17
    s_mov_b64 exec, -1
    s_add_u32 s6, s50, 1
    s_and_b32 s6, s6, 7
    s_mul_i32 s6, s6, 18432
    s_cmp_ge_u32 s5, 2
    s_cbranch_scc1 Lx_5
    s_add_u32 m0, s11, 18432
    s_add_u32 s9, s6, s11
    buffer_load_dwordx4 v3, s[52:55], s9 offen lds
Lx_5:
    s_add_u32 m0, s10, 18432
    s_add_u32 s9, s6, s10
    buffer_load_dwordx4 v3, s[52:55], s9 offen lds
    buffer_load_dwordx4 v3, s[52:55], s9 offen offset:1024 lds
    s_add_u32 s6, s50, 2
    s_and_b32 s6, s6, 7
    s_mul_i32 s6, s6, 18432
    s_cmp_ge_u32 s5, 2
    s_cbranch_scc1 Lx_6
    s_add_u32 m0, s11, 36864
    s_add_u32 s9, s6, s11
    buffer_load_dwordx4 v3, s[52:55], s9 offen lds
Lx_6:
    s_add_u32 m0, s10, 36864
    s_add_u32 s9, s6, s10
    buffer_load_dwordx4 v3, s[52:55], s9 offen lds
    buffer_load_dwordx4 v3, s[52:55], s9 offen offset:1024 lds
L_att_w0:
    ds_read_b32 v18, v16
    s_waitcnt lgkmcnt(0)
    v_readfirstlane_b32 s7, v18
    s_cmp_lt_u32 s7, 8
    s_cbranch_scc1 L_att_w0
    v_cndmask_b32 v12, 0, v12, s[64:65]
    ds_read_b128 v[20:23], v3 offset:0
    ds_read_b32 v28, v14 offset:1024
    ds_read_b128 v[24:27], v3 offset:2304
    ds_read_b32 v30, v14 offset:3328
    s_mov_b64 exec, s[76:77]
    ds_read_b128 v[32:35], v15 offset:1152
    s_mov_b64 exec, -1
    s_waitcnt lgkmcnt(3)
    v_mfma_f32_32x32x16_bf16 v[48:63], v[20:23], v[8:11], 0
    s_nop 7
    s_nop 2
    v_mfma_f32_32x32x8_bf16 v[48:63], v[28:29], v[12:13], v[48:63]
    ds_read_b128 v[20:23], v3 offset:4608
    ds_read_b32 v28, v14 offset:5632
    s_mov_b64 exec, s[76:77]
    ds_read_b128 v[40:43], v15 offset:3456
    ds_read_b128 v[36:39], v15 offset:1728
    s_mov_b64 exec, -1
    s_nop 7
    s_nop 3
    v_max3_f32 v104, v48, v49, v50
    v_max3_f32 v104, v51, v52, v104
    v_max3_f32 v104, v53, v54, v104
    v_max3_f32 v104, v55, v56, v104
    v_max3_f32 v104, v57, v58, v104
    v_max3_f32 v104, v59, v60, v104
    v_max3_f32 v104, v61, v62, v104
    v_max_f32 v104, v63, v104
    v_mov_b32 v105, v104
    s_nop 1
    v_permlane32_swap_b32 v105, v104
    s_nop 1
    v_max_f32 v104, v104, v105
    v_and_b32 v105, 0xffff0000, v104
    v_sub_f32 v104, v104, v105
    v_cvt_pk_bf16_f32 v105, -v105, -v104
    v_cndmask_b32 v13, 0, v105, s[64:65]
    v_lshlrev_b32 v104, 16, v105
    v_and_b32 v105, 0xffff0000, v105
    v_add_f32 v104, v104, v105
    v_add_f32 v48, v48, v104
    v_add_f32 v49, v49, v104
    v_add_f32 v50, v50, v104
    v_add_f32 v51, v51, v104
    v_add_f32 v52, v52, v104
    v_add_f32 v53, v53, v104
    v_add_f32 v54, v54, v104
    v_add_f32 v55, v55, v104
    v_add_f32 v56, v56, v104
    v_add_f32 v57, v57, v104
    v_add_f32 v58, v58, v104
    v_add_f32 v59, v59, v104
    v_add_f32 v60, v60, v104
    v_add_f32 v61, v61, v104
    v_add_f32 v62, v62, v104
    v_add_f32 v63, v63, v104
    s_waitcnt lgkmcnt(4)
    s_setprio 3
    v_mfma_f32_32x32x16_bf16 v[64:79], v[24:27], v[8:11], 0
    v_exp_f32 v48, v48
    v_exp_f32 v49, v49
    v_exp_f32 v50, v50
    v_exp_f32 v51, v51
    v_cvt_pk_bf16_f32 v80, v48, v49
    v_cvt_pk_bf16_f32 v81, v50, v51
    v_exp_f32 v52, v52
    v_exp_f32 v53, v53
    v_exp_f32 v54, v54
    v_exp_f32 v55, v55
    v_cvt_pk_bf16_f32 v82, v52, v53
    v_cvt_pk_bf16_f32 v83, v54, v55
    v_mfma_f32_32x32x8_bf16 v[64:79], v[30:31], v[12:13], v[64:79]
    ds_read_b128 v[24:27], v3 offset:6912
    ds_read_b32 v30, v14 offset:7936
    v_exp_f32 v56, v56
    v_exp_f32 v57, v57
    v_exp_f32 v58, v58
    v_exp_f32 v59, v59
    v_cvt_pk_bf16_f32 v84, v56, v57
    v_cvt_pk_bf16_f32 v85, v58, v59
    v_mfma_f32_32x32x16_bf16 v[88:103], v[32:35], v[80:83], 0
    s_mov_b64 exec, s[76:77]
    ds_read_b128 v[32:35], v15 offset:5760
    ds_read_b128 v[44:47], v15 offset:4032
    s_mov_b64 exec, -1
    v_exp_f32 v60, v60
    v_exp_f32 v61, v61
    v_exp_f32 v62, v62
    v_exp_f32 v63, v63
    v_cvt_pk_bf16_f32 v86, v60, v61
    v_cvt_pk_bf16_f32 v87, v62, v63
    s_waitcnt lgkmcnt(4)
    s_setprio 2
    v_mfma_f32_32x32x16_bf16 v[48:63], v[20:23], v[8:11], 0
    v_exp_f32 v64, v64
    v_exp_f32 v65, v65
    v_exp_f32 v66, v66
    v_exp_f32 v67, v67
    v_cvt_pk_bf16_f32 v80, v64, v65
    v_cvt_pk_bf16_f32 v81, v66, v67
    v_mfma_f32_32x32x16_bf16 v[88:103], v[36:39], v[84:87], v[88:103]
    v_exp_f32 v68, v68
    v_exp_f32 v69, v69
    v_exp_f32 v70, v70
    v_exp_f32 v71, v71
    v_cvt_pk_bf16_f32 v82, v68, v69
    v_cvt_pk_bf16_f32 v83, v70, v71
    v_mfma_f32_32x32x8_bf16 v[48:63], v[28:29], v[12:13], v[48:63]
    ds_read_b128 v[20:23], v3 offset:9216
    ds_read_b32 v28, v14 offset:10240
    v_exp_f32 v72, v72
    v_exp_f32 v73, v73
    v_exp_f32 v74, v74
    v_exp_f32 v75, v75
    v_cvt_pk_bf16_f32 v84, v72, v73
    v_cvt_pk_bf16_f32 v85, v74, v75
    v_mfma_f32_32x32x16_bf16 v[88:103], v[40:43], v[80:83], v[88:103]
    s_mov_b64 exec, s[76:77]
    ds_read_b128 v[40:43], v15 offset:8064
    ds_read_b128 v[36:39], v15 offset:6336
    s_mov_b64 exec, -1
    v_exp_f32 v76, v76
    v_exp_f32 v77, v77
    v_exp_f32 v78, v78
    v_exp_f32 v79, v79
    v_cvt_pk_bf16_f32 v86, v76, v77
    v_cvt_pk_bf16_f32 v87, v78, v79
    s_waitcnt lgkmcnt(4)
    s_setprio 1
    v_mfma_f32_32x32x16_bf16 v[64:79], v[24:27], v[8:11], 0
    v_exp_f32 v48, v48
    v_exp_f32 v49, v49
    v_exp_f32 v50, v50
    v_exp_f32 v51, v51
    v_cvt_pk_bf16_f32 v80, v48, v49
    v_cvt_pk_bf16_f32 v81, v50, v51
    v_mfma_f32_32x32x16_bf16 v[88:103], v[44:47], v[84:87], v[88:103]
    v_exp_f32 v52, v52
    v_exp_f32 v53, v53
    v_exp_f32 v54, v54
    v_exp_f32 v55, v55
    v_cvt_pk_bf16_f32 v82, v52, v53
    v_cvt_pk_bf16_f32 v83, v54, v55
    v_mfma_f32_32x32x8_bf16 v[64:79], v[30:31], v[12:13], v[64:79]
    ds_read_b128 v[24:27], v3 offset:11520
    ds_read_b32 v30, v14 offset:12544
    v_exp_f32 v56, v56
    v_exp_f32 v57, v57
    v_exp_f32 v58, v58
    v_exp_f32 v59, v59
    v_cvt_pk_bf16_f32 v84, v56, v57
    v_cvt_pk_bf16_f32 v85, v58, v59
    v_mfma_f32_32x32x16_bf16 v[88:103], v[32:35], v[80:83], v[88:103]
    s_mov_b64 exec, s[76:77]
    ds_read_b128 v[32:35], v15 offset:10368
    ds_read_b128 v[44:47], v15 offset:8640
    s_mov_b64 exec, -1
    v_exp_f32 v60, v60
    v_exp_f32 v61, v61
    v_exp_f32 v62, v62
    v_exp_f32 v63, v63
    v_cvt_pk_bf16_f32 v86, v60, v61
    v_cvt_pk_bf16_f32 v87, v62, v63
    s_waitcnt lgkmcnt(4)
    s_setprio 0
    v_mfma_f32_32x32x16_bf16 v[48:63], v[20:23], v[8:11], 0
    v_exp_f32 v64, v64
    v_exp_f32 v65, v65
    v_exp_f32 v66, v66
    v_exp_f32 v67, v67
    v_cvt_pk_bf16_f32 v80, v64, v65
    v_cvt_pk_bf16_f32 v81, v66, v67
    v_mfma_f32_32x32x16_bf16 v[88:103], v[36:39], v[84:87], v[88:103]
    s_cmp_lt_u32 s5, 2
    s_cbranch_scc1 Lw_7
    s_waitcnt vmcnt(2)
Lw_7:
    s_waitcnt vmcnt(3)
    s_mov_b64 exec, 1
    ds_add_u32 v16, v17 offset:4
    s_mov_b64 exec, -1
    v_exp_f32 v68, v68
    v_exp_f32 v69, v69
    v_exp_f32 v70, v70
    v_exp_f32 v71, v71
    v_cvt_pk_bf16_f32 v82, v68, v69
    v_cvt_pk_bf16_f32 v83, v70, v71
    v_mfma_f32_32x32x8_bf16 v[48:63], v[28:29], v[12:13], v[48:63]
    ds_read_b128 v[20:23], v3 offset:13824
    ds_read_b32 v28, v14 offset:14848
    v_exp_f32 v72, v72
    v_exp_f32 v73, v73
    v_exp_f32 v74, v74
    v_exp_f32 v75, v75
    v_cvt_pk_bf16_f32 v84, v72, v73
    v_cvt_pk_bf16_f32 v85, v74, v75
    v_mfma_f32_32x32x16_bf16 v[88:103], v[40:43], v[80:83], v[88:103]
    s_mov_b64 exec, s[76:77]
    ds_read_b128 v[40:43], v15 offset:12672
    ds_read_b128 v[36:39], v15 offset:10944
    s_mov_b64 exec, -1
    v_exp_f32 v76, v76
    v_exp_f32 v77, v77
    v_exp_f32 v78, v78
    v_exp_f32 v79, v79
    v_cvt_pk_bf16_f32 v86, v76, v77
    v_cvt_pk_bf16_f32 v87, v78, v79
    s_waitcnt lgkmcnt(4)
    s_setprio 3
    v_mfma_f32_32x32x16_bf16 v[64:79], v[24:27], v[8:11], 0
    v_exp_f32 v48, v48
    v_exp_f32 v49, v49
    v_exp_f32 v50, v50
    v_exp_f32 v51, v51
    v_cvt_pk_bf16_f32 v80, v48, v49
    v_cvt_pk_bf16_f32 v81, v50, v51
    v_mfma_f32_32x32x16_bf16 v[88:103], v[44:47], v[84:87], v[88:103]
    v_exp_f32 v52, v52
    v_exp_f32 v53, v53
    v_exp_f32 v54, v54
    v_exp_f32 v55, v55
    v_cvt_pk_bf16_f32 v82, v52, v53
    v_cvt_pk_bf16_f32 v83, v54, v55
    v_mfma_f32_32x32x8_bf16 v[64:79], v[30:31], v[12:13], v[64:79]
    ds_read_b32 v18, v16 offset:4
    ds_read_b128 v[24:27], v3 offset:16128
    ds_read_b32 v30, v14 offset:17152
    v_exp_f32 v56, v56
    v_exp_f32 v57, v57
    v_exp_f32 v58, v58
    v_exp_f32 v59, v59
    v_cvt_pk_bf16_f32 v84, v56, v57
    v_cvt_pk_bf16_f32 v85, v58, v59
    v_mfma_f32_32x32x16_bf16 v[88:103], v[32:35], v[80:83], v[88:103]
    s_mov_b64 exec, s[76:77]
    ds_read_b128 v[32:35], v15 offset:14976
    ds_read_b128 v[44:47], v15 offset:13248
    s_mov_b64 exec, -1
    v_exp_f32 v60, v60
    v_exp_f32 v61, v61
    v_exp_f32 v62, v62
    v_exp_f32 v63, v63
    v_cvt_pk_bf16_f32 v86, v60, v61
    v_cvt_pk_bf16_f32 v87, v62, v63
    s_waitcnt lgkmcnt(4)
    s_setprio 2
    v_mfma_f32_32x32x16_bf16 v[48:63], v[20:23], v[8:11], 0
    v_exp_f32 v64, v64
    v_exp_f32 v65, v65
    v_exp_f32 v66, v66
    v_exp_f32 v67, v67
    v_cvt_pk_bf16_f32 v80, v64, v65
    v_cvt_pk_bf16_f32 v81, v66, v67
    v_mfma_f32_32x32x16_bf16 v[88:103], v[36:39], v[84:87], v[88:103]
    v_exp_f32 v68, v68
    v_exp_f32 v69, v69
    v_exp_f32 v70, v70
    v_exp_f32 v71, v71
    v_cvt_pk_bf16_f32 v82, v68, v69
    v_cvt_pk_bf16_f32 v83, v70, v71
    v_mfma_f32_32x32x8_bf16 v[48:63], v[28:29], v[12:13], v[48:63]
    v_readfirstlane_b32 s7, v18
    s_cmp_lt_u32 s7, 8
    s_cbranch_scc1 Lsl_8
Lbk_9:
    ds_read_b128 v[20:23], v3 offset:18432
    ds_read_b32 v28, v14 offset:19456
    v_exp_f32 v72, v72
    v_exp_f32 v73, v73
    v_exp_f32 v74, v74
    v_exp_f32 v75, v75
    v_cvt_pk_bf16_f32 v84, v72, v73
    v_cvt_pk_bf16_f32 v85, v74, v75
    v_mfma_f32_32x32x16_bf16 v[88:103], v[40:43], v[80:83], v[88:103]
    s_mov_b64 exec, s[76:77]
    ds_read_b128 v[40:43], v15 offset:17280
    ds_read_b128 v[36:39], v15 offset:15552
    s_mov_b64 exec, -1
    v_exp_f32 v76, v76
    v_exp_f32 v77, v77
    v_exp_f32 v78, v78
    v_exp_f32 v79, v79
    v_cvt_pk_bf16_f32 v86, v76, v77
    v_cvt_pk_bf16_f32 v87, v78, v79
    s_waitcnt lgkmcnt(4)
    s_setprio 1
    v_mfma_f32_32x32x16_bf16 v[64:79], v[24:27], v[8:11], 0
    v_exp_f32 v48, v48
    v_exp_f32 v49, v49
    v_exp_f32 v50, v50
    v_exp_f32 v51, v51
    v_cvt_pk_bf16_f32 v80, v48, v49
    v_cvt_pk_bf16_f32 v81, v50, v51
    v_mfma_f32_32x32x16_bf16 v[88:103], v[44:47], v[84:87], v[88:103]
    v_exp_f32 v52, v52
    v_exp_f32 v53, v53
    v_exp_f32 v54, v54
    v_exp_f32 v55, v55
    v_cvt_pk_bf16_f32 v82, v52, v53
    v_cvt_pk_bf16_f32 v83, v54, v55
    v_mfma_f32_32x32x8_bf16 v[64:79], v[30:31], v[12:13], v[64:79]
    ds_read_b128 v[24:27], v3 offset:20736
    ds_read_b32 v30, v14 offset:21760
    v_exp_f32 v56, v56
    v_exp_f32 v57, v57
    v_exp_f32 v58, v58
    v_exp_f32 v59, v59
    v_cvt_pk_bf16_f32 v84, v56, v57
    v_cvt_pk_bf16_f32 v85, v58, v59
    v_mfma_f32_32x32x16_bf16 v[88:103], v[32:35], v[80:83], v[88:103]
    s_mov_b64 exec, s[76:77]
    ds_read_b128 v[32:35], v15 offset:19584
    ds_read_b128 v[44:47], v15 offset:17856
    s_mov_b64 exec, -1
    v_exp_f32 v60, v60
    v_exp_f32 v61, v61
    v_exp_f32 v62, v62
    v_exp_f32 v63, v63
    v_cvt_pk_bf16_f32 v86, v60, v61
    v_cvt_pk_bf16_f32 v87, v62, v63
    s_waitcnt lgkmcnt(4)
    s_setprio 0
    v_mfma_f32_32x32x16_bf16 v[48:63], v[20:23], v[8:11], 0
    v_exp_f32 v64, v64
    v_exp_f32 v65, v65
    v_exp_f32 v66, v66
    v_exp_f32 v67, v67
    v_cvt_pk_bf16_f32 v80, v64, v65
    v_cvt_pk_bf16_f32 v81, v66, v67
    v_mfma_f32_32x32x16_bf16 v[88:103], v[36:39], v[84:87], v[88:103]
    v_exp_f32 v68, v68
    v_exp_f32 v69, v69
    v_exp_f32 v70, v70
    v_exp_f32 v71, v71
    v_cvt_pk_bf16_f32 v82, v68, v69
    v_cvt_pk_bf16_f32 v83, v70, v71
    v_mfma_f32_32x32x8_bf16 v[48:63], v[28:29], v[12:13], v[48:63]
    ds_read_b128 v[20:23], v3 offset:23040
    ds_read_b32 v28, v14 offset:24064
    v_exp_f32 v72, v72
    v_exp_f32 v73, v73
    v_exp_f32 v74, v74
    v_exp_f32 v75, v75
    v_cvt_pk_bf16_f32 v84, v72, v73
    v_cvt_pk_bf16_f32 v85, v74, v75
    v_mfma_f32_32x32x16_bf16 v[88:103], v[40:43], v[80:83], v[88:103]
    s_mov_b64 exec, s[76:77]
    ds_read_b128 v[40:43], v15 offset:21888
    ds_read_b128 v[36:39], v15 offset:20160
    s_mov_b64 exec, -1
    v_exp_f32 v76, v76
    v_exp_f32 v77, v77
    v_exp_f32 v78, v78
    v_exp_f32 v79, v79
    v_cvt_pk_bf16_f32 v86, v76, v77
    v_cvt_pk_bf16_f32 v87, v78, v79
    s_waitcnt lgkmcnt(4)
    s_setprio 3
    v_mfma_f32_32x32x16_bf16 v[64:79], v[24:27], v[8:11], 0
    v_exp_f32 v48, v48
    v_exp_f32 v49, v49
    v_exp_f32 v50, v50
    v_exp_f32 v51, v51
    v_cvt_pk_bf16_f32 v80, v48, v49
    v_cvt_pk_bf16_f32 v81, v50, v51
    v_mfma_f32_32x32x16_bf16 v[88:103], v[44:47], v[84:87], v[88:103]
    s_mov_b64 exec, 1
    ds_add_u32 v16, v17 offset:32
    s_mov_b64 exec, -1
    v_exp_f32 v52, v52
    v_exp_f32 v53, v53
    v_exp_f32 v54, v54
    v_exp_f32 v55, v55
    v_cvt_pk_bf16_f32 v82, v52, v53
    v_cvt_pk_bf16_f32 v83, v54, v55
    v_mfma_f32_32x32x8_bf16 v[64:79], v[30:31], v[12:13], v[64:79]
    ds_read_b128 v[24:27], v3 offset:25344
    ds_read_b32 v30, v14 offset:26368
    v_exp_f32 v56, v56
    v_exp_f32 v57, v57
    v_exp_f32 v58, v58
    v_exp_f32 v59, v59
    v_cvt_pk_bf16_f32 v84, v56, v57
    v_cvt_pk_bf16_f32 v85, v58, v59
    v_mfma_f32_32x32x16_bf16 v[88:103], v[32:35], v[80:83], v[88:103]
    s_mov_b64 exec, s[76:77]
    ds_read_b128 v[32:35], v15 offset:24192
    ds_read_b128 v[44:47], v15 offset:22464
    s_mov_b64 exec, -1
    v_exp_f32 v60, v60
    v_exp_f32 v61, v61
    v_exp_f32 v62, v62
    v_exp_f32 v63, v63
    v_cvt_pk_bf16_f32 v86, v60, v61
    v_cvt_pk_bf16_f32 v87, v62, v63
    s_waitcnt lgkmcnt(4)
    s_setprio 2
    v_mfma_f32_32x32x16_bf16 v[48:63], v[20:23], v[8:11], 0
    v_exp_f32 v64, v64
    v_exp_f32 v65, v65
    v_exp_f32 v66, v66
    v_exp_f32 v67, v67
    v_cvt_pk_bf16_f32 v80, v64, v65
    v_cvt_pk_bf16_f32 v81, v66, v67
    v_mfma_f32_32x32x16_bf16 v[88:103], v[36:39], v[84:87], v[88:103]
    s_waitcnt vmcnt(0)
    s_mov_b64 exec, 1
    ds_add_u32 v16, v17 offset:8
    s_mov_b64 exec, -1
    v_exp_f32 v68, v68
    v_exp_f32 v69, v69
    v_exp_f32 v70, v70
    v_exp_f32 v71, v71
    v_cvt_pk_bf16_f32 v82, v68, v69
    v_cvt_pk_bf16_f32 v83, v70, v71
    v_mfma_f32_32x32x8_bf16 v[48:63], v[28:29], v[12:13], v[48:63]
    ds_read_b32 v18, v16 offset:32
    ds_read_b128 v[20:23], v3 offset:27648
    ds_read_b32 v28, v14 offset:28672
    v_exp_f32 v72, v72
    v_exp_f32 v73, v73
    v_exp_f32 v74, v74
    v_exp_f32 v75, v75
    v_cvt_pk_bf16_f32 v84, v72, v73
    v_cvt_pk_bf16_f32 v85, v74, v75
    v_mfma_f32_32x32x16_bf16 v[88:103], v[40:43], v[80:83], v[88:103]
    s_mov_b64 exec, s[76:77]
    ds_read_b128 v[40:43], v15 offset:26496
    ds_read_b128 v[36:39], v15 offset:24768
    s_mov_b64 exec, -1
    v_exp_f32 v76, v76
    v_exp_f32 v77, v77
    v_exp_f32 v78, v78
    v_exp_f32 v79, v79
    v_cvt_pk_bf16_f32 v86, v76, v77
    v_cvt_pk_bf16_f32 v87, v78, v79
    s_waitcnt lgkmcnt(4)
    s_setprio 1
    v_mfma_f32_32x32x16_bf16 v[64:79], v[24:27], v[8:11], 0
    v_exp_f32 v48, v48
    v_exp_f32 v49, v49
    v_exp_f32 v50, v50
    v_exp_f32 v51, v51
    v_cvt_pk_bf16_f32 v80, v48, v49
    v_cvt_pk_bf16_f32 v81, v50, v51
    v_mfma_f32_32x32x16_bf16 v[88:103], v[44:47], v[84:87], v[88:103]
    v_readfirstlane_b32 s7, v18
    s_cmp_lt_u32 s7, 8
    s_cbranch_scc1 Lsl_10
Lbk_11:
    s_add_u32 s6, s50, 3
    s_and_b32 s6, s6, 7
    s_mul_i32 s6, s6, 18432
    s_cmp_ge_u32 s5, 2
    s_cbranch_scc1 Lx_12
    s_add_u32 m0, s11, 0
    s_add_u32 s9, s6, s11
    buffer_load_dwordx4 v3, s[52:55], s9 offen lds
Lx_12:
    s_add_u32 m0, s10, 0
    s_add_u32 s9, s6, s10
    buffer_load_dwordx4 v3, s[52:55], s9 offen lds
    buffer_load_dwordx4 v3, s[52:55], s9 offen offset:1024 lds
    v_exp_f32 v52, v52
    v_exp_f32 v53, v53
    v_exp_f32 v54, v54
    v_exp_f32 v55, v55
    v_cvt_pk_bf16_f32 v82, v52, v53
    v_cvt_pk_bf16_f32 v83, v54, v55
    v_mfma_f32_32x32x8_bf16 v[64:79], v[30:31], v[12:13], v[64:79]
    ds_read_b128 v[24:27], v3 offset:29952
    ds_read_b32 v30, v14 offset:30976
    v_exp_f32 v56, v56
    v_exp_f32 v57, v57
    v_exp_f32 v58, v58
    v_exp_f32 v59, v59
    v_cvt_pk_bf16_f32 v84, v56, v57
    v_cvt_pk_bf16_f32 v85, v58, v59
    v_mfma_f32_32x32x16_bf16 v[88:103], v[32:35], v[80:83], v[88:103]
    s_mov_b64 exec, s[76:77]
    ds_read_b128 v[32:35], v15 offset:28800
    ds_read_b128 v[44:47], v15 offset:27072
    s_mov_b64 exec, -1
    v_exp_f32 v60, v60
    v_exp_f32 v61, v61
    v_exp_f32 v62, v62
    v_exp_f32 v63, v63
    v_cvt_pk_bf16_f32 v86, v60, v61
    v_cvt_pk_bf16_f32 v87, v62, v63
    s_waitcnt lgkmcnt(4)
    s_setprio 0
    v_mfma_f32_32x32x16_bf16 v[48:63], v[20:23], v[8:11], 0
    v_exp_f32 v64, v64
    v_exp_f32 v65, v65
    v_exp_f32 v66, v66
    v_exp_f32 v67, v67
    v_cvt_pk_bf16_f32 v80, v64, v65
    v_cvt_pk_bf16_f32 v81, v66, v67
    v_mfma_f32_32x32x16_bf16 v[88:103], v[36:39], v[84:87], v[88:103]
    v_exp_f32 v68, v68
    v_exp_f32 v69, v69
    v_exp_f32 v70, v70
    v_exp_f32 v71, v71
    v_cvt_pk_bf16_f32 v82, v68, v69
    v_cvt_pk_bf16_f32 v83, v70, v71
    v_mfma_f32_32x32x8_bf16 v[48:63], v[28:29], v[12:13], v[48:63]
    ds_read_b128 v[20:23], v3 offset:32256
    ds_read_b32 v28, v14 offset:33280
    v_exp_f32 v72, v72
    v_exp_f32 v73, v73
    v_exp_f32 v74, v74
    v_exp_f32 v75, v75
    v_cvt_pk_bf16_f32 v84, v72, v73
    v_cvt_pk_bf16_f32 v85, v74, v75
    v_mfma_f32_32x32x16_bf16 v[88:103], v[40:43], v[80:83], v[88:103]
    s_mov_b64 exec, s[76:77]
    ds_read_b128 v[40:43], v15 offset:31104
    ds_read_b128 v[36:39], v15 offset:29376
    s_mov_b64 exec, -1
    v_exp_f32 v76, v76
    v_exp_f32 v77, v77
    v_exp_f32 v78, v78
    v_exp_f32 v79, v79
    v_cvt_pk_bf16_f32 v86, v76, v77
    v_cvt_pk_bf16_f32 v87, v78, v79
    s_waitcnt lgkmcnt(4)
    s_setprio 3
    v_mfma_f32_32x32x16_bf16 v[64:79], v[24:27], v[8:11], 0
    v_exp_f32 v48, v48
    v_exp_f32 v49, v49
    v_exp_f32 v50, v50
    v_exp_f32 v51, v51
    v_cvt_pk_bf16_f32 v80, v48, v49
    v_cvt_pk_bf16_f32 v81, v50, v51
    v_mfma_f32_32x32x16_bf16 v[88:103], v[44:47], v[84:87], v[88:103]
    v_exp_f32 v52, v52
    v_exp_f32 v53, v53
    v_exp_f32 v54, v54
    v_exp_f32 v55, v55
    v_cvt_pk_bf16_f32 v82, v52, v53
    v_cvt_pk_bf16_f32 v83, v54, v55
    v_mfma_f32_32x32x8_bf16 v[64:79], v[30:31], v[12:13], v[64:79]
    ds_read_b32 v18, v16 offset:8
    ds_read_b128 v[24:27], v3 offset:34560
    ds_read_b32 v30, v14 offset:35584
    v_exp_f32 v56, v56
    v_exp_f32 v57, v57
    v_exp_f32 v58, v58
    v_exp_f32 v59, v59
    v_cvt_pk_bf16_f32 v84, v56, v57
    v_cvt_pk_bf16_f32 v85, v58, v59
    v_mfma_f32_32x32x16_bf16 v[88:103], v[32:35], v[80:83], v[88:103]
    s_mov_b64 exec, s[76:77]
    ds_read_b128 v[32:35], v15 offset:33408
    ds_read_b128 v[44:47], v15 offset:31680
    s_mov_b64 exec, -1
    v_exp_f32 v60, v60
    v_exp_f32 v61, v61
    v_exp_f32 v62, v62
    v_exp_f32 v63, v63
    v_cvt_pk_bf16_f32 v86, v60, v61
    v_cvt_pk_bf16_f32 v87, v62, v63
    s_waitcnt lgkmcnt(4)
    s_setprio 2
    v_mfma_f32_32x32x16_bf16 v[48:63], v[20:23], v[8:11], 0
    v_exp_f32 v64, v64
    v_exp_f32 v65, v65
    v_exp_f32 v66, v66
    v_exp_f32 v67, v67
    v_cvt_pk_bf16_f32 v80, v64, v65
    v_cvt_pk_bf16_f32 v81, v66, v67
    v_mfma_f32_32x32x16_bf16 v[88:103], v[36:39], v[84:87], v[88:103]
    v_exp_f32 v68, v68
    v_exp_f32 v69, v69
    v_exp_f32 v70, v70
    v_exp_f32 v71, v71
    v_cvt_pk_bf16_f32 v82, v68, v69
    v_cvt_pk_bf16_f32 v83, v70, v71
    v_mfma_f32_32x32x8_bf16 v[48:63], v[28:29], v[12:13], v[48:63]
    v_readfirstlane_b32 s7, v18
    s_cmp_lt_u32 s7, 8
    s_cbranch_scc1 Lsl_13
Lbk_14:
    ds_read_b128 v[20:23], v3 offset:36864
    ds_read_b32 v28, v14 offset:37888
    v_exp_f32 v72, v72
    v_exp_f32 v73, v73
    v_exp_f32 v74, v74
    v_exp_f32 v75, v75
    v_cvt_pk_bf16_f32 v84, v72, v73
    v_cvt_pk_bf16_f32 v85, v74, v75
    v_mfma_f32_32x32x16_bf16 v[88:103], v[40:43], v[80:83], v[88:103]
    s_mov_b64 exec, s[76:77]
    ds_read_b128 v[40:43], v15 offset:35712
    ds_read_b128 v[36:39], v15 offset:33984
    s_mov_b64 exec, -1
    v_exp_f32 v76, v76
    v_exp_f32 v77, v77
    v_exp_f32 v78, v78
    v_exp_f32 v79, v79
    v_cvt_pk_bf16_f32 v86, v76, v77
    v_cvt_pk_bf16_f32 v87, v78, v79
    s_waitcnt lgkmcnt(4)
    s_setprio 1
    v_mfma_f32_32x32x16_bf16 v[64:79], v[24:27], v[8:11], 0
    v_exp_f32 v48, v48
    v_exp_f32 v49, v49
    v_exp_f32 v50, v50
    v_exp_f32 v51, v51
    v_cvt_pk_bf16_f32 v80, v48, v49
    v_cvt_pk_bf16_f32 v81, v50, v51
    v_mfma_f32_32x32x16_bf16 v[88:103], v[44:47], v[84:87], v[88:103]
    v_exp_f32 v52, v52
    v_exp_f32 v53, v53
    v_exp_f32 v54, v54
    v_exp_f32 v55, v55
    v_cvt_pk_bf16_f32 v82, v52, v53
    v_cvt_pk_bf16_f32 v83, v54, v55
    v_mfma_f32_32x32x8_bf16 v[64:79], v[30:31], v[12:13], v[64:79]
    ds_read_b128 v[24:27], v3 offset:39168
    ds_read_b32 v30, v14 offset:40192
    v_exp_f32 v56, v56
    v_exp_f32 v57, v57
    v_exp_f32 v58, v58
    v_exp_f32 v59, v59
    v_cvt_pk_bf16_f32 v84, v56, v57
    v_cvt_pk_bf16_f32 v85, v58, v59
    v_mfma_f32_32x32x16_bf16 v[88:103], v[32:35], v[80:83], v[88:103]
    s_mov_b64 exec, s[76:77]
    ds_read_b128 v[32:35], v15 offset:38016
    ds_read_b128 v[44:47], v15 offset:36288
    s_mov_b64 exec, -1
    v_exp_f32 v60, v60
    v_exp_f32 v61, v61
    v_exp_f32 v62, v62
    v_exp_f32 v63, v63
    v_cvt_pk_bf16_f32 v86, v60, v61
    v_cvt_pk_bf16_f32 v87, v62, v63
    s_waitcnt lgkmcnt(4)
    s_setprio 0
    v_mfma_f32_32x32x16_bf16 v[48:63], v[20:23], v[8:11], 0
    v_exp_f32 v64, v64
    v_exp_f32 v65, v65
    v_exp_f32 v66, v66
    v_exp_f32 v67, v67
    v_cvt_pk_bf16_f32 v80, v64, v65
    v_cvt_pk_bf16_f32 v81, v66, v67
    v_mfma_f32_32x32x16_bf16 v[88:103], v[36:39], v[84:87], v[88:103]
    v_exp_f32 v68, v68
    v_exp_f32 v69, v69
    v_exp_f32 v70, v70
    v_exp_f32 v71, v71
    v_cvt_pk_bf16_f32 v82, v68, v69
    v_cvt_pk_bf16_f32 v83, v70, v71
    v_mfma_f32_32x32x8_bf16 v[48:63], v[28:29], v[12:13], v[48:63]
    ds_read_b128 v[20:23], v3 offset:41472
    ds_read_b32 v28, v14 offset:42496
    v_exp_f32 v72, v72
    v_exp_f32 v73, v73
    v_exp_f32 v74, v74
    v_exp_f32 v75, v75
    v_cvt_pk_bf16_f32 v84, v72, v73
    v_cvt_pk_bf16_f32 v85, v74, v75
    v_mfma_f32_32x32x16_bf16 v[88:103], v[40:43], v[80:83], v[88:103]
    s_mov_b64 exec, s[76:77]
    ds_read_b128 v[40:43], v15 offset:40320
    ds_read_b128 v[36:39], v15 offset:38592
    s_mov_b64 exec, -1
    v_exp_f32 v76, v76
    v_exp_f32 v77, v77
    v_exp_f32 v78, v78
    v_exp_f32 v79, v79
    v_cvt_pk_bf16_f32 v86, v76, v77
    v_cvt_pk_bf16_f32 v87, v78, v79
    s_waitcnt lgkmcnt(4)
    s_setprio 3
    v_mfma_f32_32x32x16_bf16 v[64:79], v[24:27], v[8:11], 0
    v_exp_f32 v48, v48
    v_exp_f32 v49, v49
    v_exp_f32 v50, v50
    v_exp_f32 v51, v51
    v_cvt_pk_bf16_f32 v80, v48, v49
    v_cvt_pk_bf16_f32 v81, v50, v51
    v_mfma_f32_32x32x16_bf16 v[88:103], v[44:47], v[84:87], v[88:103]
    s_mov_b64 exec, 1
    ds_add_u32 v16, v17 offset:36
    s_mov_b64 exec, -1
    v_exp_f32 v52, v52
    v_exp_f32 v53, v53
    v_exp_f32 v54, v54
    v_exp_f32 v55, v55
    v_cvt_pk_bf16_f32 v82, v52, v53
    v_cvt_pk_bf16_f32 v83, v54, v55
    v_mfma_f32_32x32x8_bf16 v[64:79], v[30:31], v[12:13], v[64:79]
    ds_read_b128 v[24:27], v3 offset:43776
    ds_read_b32 v30, v14 offset:44800
    v_exp_f32 v56, v56
    v_exp_f32 v57, v57
    v_exp_f32 v58, v58
    v_exp_f32 v59, v59
    v_cvt_pk_bf16_f32 v84, v56, v57
    v_cvt_pk_bf16_f32 v85, v58, v59
    v_mfma_f32_32x32x16_bf16 v[88:103], v[32:35], v[80:83], v[88:103]
    s_mov_b64 exec, s[76:77]
    ds_read_b128 v[32:35], v15 offset:42624
    ds_read_b128 v[44:47], v15 offset:40896
    s_mov_b64 exec, -1
    v_exp_f32 v60, v60
    v_exp_f32 v61, v61
    v_exp_f32 v62, v62
    v_exp_f32 v63, v63
    v_cvt_pk_bf16_f32 v86, v60, v61
    v_cvt_pk_bf16_f32 v87, v62, v63
    s_waitcnt lgkmcnt(4)
    s_setprio 2
    v_mfma_f32_32x32x16_bf16 v[48:63], v[20:23], v[8:11], 0
    v_exp_f32 v64, v64
    v_exp_f32 v65, v65
    v_exp_f32 v66, v66
    v_exp_f32 v67, v67
    v_cvt_pk_bf16_f32 v80, v64, v65
    v_cvt_pk_bf16_f32 v81, v66, v67
    v_mfma_f32_32x32x16_bf16 v[88:103], v[36:39], v[84:87], v[88:103]
    s_waitcnt vmcnt(0)
    s_mov_b64 exec, 1
    ds_add_u32 v16, v17 offset:12
    s_mov_b64 exec, -1
    v_exp_f32 v68, v68
    v_exp_f32 v69, v69
    v_exp_f32 v70, v70
    v_exp_f32 v71, v71
    v_cvt_pk_bf16_f32 v82, v68, v69
    v_cvt_pk_bf16_f32 v83, v70, v71
    v_mfma_f32_32x32x8_bf16 v[48:63], v[28:29], v[12:13], v[48:63]
    ds_read_b32 v18, v16 offset:36
    ds_read_b128 v[20:23], v3 offset:46080
    ds_read_b32 v28, v14 offset:47104
    v_exp_f32 v72, v72
    v_exp_f32 v73, v73
    v_exp_f32 v74, v74
    v_exp_f32 v75, v75
    v_cvt_pk_bf16_f32 v84, v72, v73
    v_cvt_pk_bf16_f32 v85, v74, v75
    v_mfma_f32_32x32x16_bf16 v[88:103], v[40:43], v[80:83], v[88:103]
    s_mov_b64 exec, s[76:77]
    ds_read_b128 v[40:43], v15 offset:44928
    ds_read_b128 v[36:39], v15 offset:43200
    s_mov_b64 exec, -1
    v_exp_f32 v76, v76
    v_exp_f32 v77, v77
    v_exp_f32 v78, v78
    v_exp_f32 v79, v79
    v_cvt_pk_bf16_f32 v86, v76, v77
    v_cvt_pk_bf16_f32 v87, v78, v79
    s_waitcnt lgkmcnt(4)
    s_setprio 1
    v_mfma_f32_32x32x16_bf16 v[64:79], v[24:27], v[8:11], 0
    v_exp_f32 v48, v48
    v_exp_f32 v49, v49
    v_exp_f32 v50, v50
    v_exp_f32 v51, v51
    v_cvt_pk_bf16_f32 v80, v48, v49
    v_cvt_pk_bf16_f32 v81, v50, v51
    v_mfma_f32_32x32x16_bf16 v[88:103], v[44:47], v[84:87], v[88:103]
    v_readfirstlane_b32 s7, v18
    s_cmp_lt_u32 s7, 8
    s_cbranch_scc1 Lsl_15
Lbk_16:
    s_add_u32 s6, s50, 4
    s_and_b32 s6, s6, 7
    s_mul_i32 s6, s6, 18432
    s_cmp_ge_u32 s5, 2
    s_cbranch_scc1 Lx_17
    s_add_u32 m0, s11, 18432
    s_add_u32 s9, s6, s11
    buffer_load_dwordx4 v3, s[52:55], s9 offen lds
Lx_17:
    s_add_u32 m0, s10, 18432
    s_add_u32 s9, s6, s10
    buffer_load_dwordx4 v3, s[52:55], s9 offen lds
    buffer_load_dwordx4 v3, s[52:55], s9 offen offset:1024 lds
    v_exp_f32 v52, v52
    v_exp_f32 v53, v53
    v_exp_f32 v54, v54
    v_exp_f32 v55, v55
    v_cvt_pk_bf16_f32 v82, v52, v53
    v_cvt_pk_bf16_f32 v83, v54, v55
    v_mfma_f32_32x32x8_bf16 v[64:79], v[30:31], v[12:13], v[64:79]
    ds_read_b128 v[24:27], v3 offset:48384
    ds_read_b32 v30, v14 offset:49408
    v_exp_f32 v56, v56
    v_exp_f32 v57, v57
    v_exp_f32 v58, v58
    v_exp_f32 v59, v59
    v_cvt_pk_bf16_f32 v84, v56, v57
    v_cvt_pk_bf16_f32 v85, v58, v59
    v_mfma_f32_32x32x16_bf16 v[88:103], v[32:35], v[80:83], v[88:103]
    s_mov_b64 exec, s[76:77]
    ds_read_b128 v[32:35], v15 offset:47232
    ds_read_b128 v[44:47], v15 offset:45504
    s_mov_b64 exec, -1
    v_exp_f32 v60, v60
    v_exp_f32 v61, v61
    v_exp_f32 v62, v62
    v_exp_f32 v63, v63
    v_cvt_pk_bf16_f32 v86, v60, v61
    v_cvt_pk_bf16_f32 v87, v62, v63
    s_waitcnt lgkmcnt(4)
    s_setprio 0
    v_mfma_f32_32x32x16_bf16 v[48:63], v[20:23], v[8:11], 0
    v_exp_f32 v64, v64
    v_exp_f32 v65, v65
    v_exp_f32 v66, v66
    v_exp_f32 v67, v67
    v_cvt_pk_bf16_f32 v80, v64, v65
    v_cvt_pk_bf16_f32 v81, v66, v67
    v_mfma_f32_32x32x16_bf16 v[88:103], v[36:39], v[84:87], v[88:103]
    v_exp_f32 v68, v68
    v_exp_f32 v69, v69
    v_exp_f32 v70, v70
    v_exp_f32 v71, v71
    v_cvt_pk_bf16_f32 v82, v68, v69
    v_cvt_pk_bf16_f32 v83, v70, v71
    v_mfma_f32_32x32x8_bf16 v[48:63], v[28:29], v[12:13], v[48:63]
    ds_read_b128 v[20:23], v3 offset:50688
    ds_read_b32 v28, v14 offset:51712
    v_exp_f32 v72, v72
    v_exp_f32 v73, v73
    v_exp_f32 v74, v74
    v_exp_f32 v75, v75
    v_cvt_pk_bf16_f32 v84, v72, v73
    v_cvt_pk_bf16_f32 v85, v74, v75
    v_mfma_f32_32x32x16_bf16 v[88:103], v[40:43], v[80:83], v[88:103]
    s_mov_b64 exec, s[76:77]
    ds_read_b128 v[40:43], v15 offset:49536
    ds_read_b128 v[36:39], v15 offset:47808
    s_mov_b64 exec, -1
    v_exp_f32 v76, v76
    v_exp_f32 v77, v77
    v_exp_f32 v78, v78
    v_exp_f32 v79, v79
    v_cvt_pk_bf16_f32 v86, v76, v77
    v_cvt_pk_bf16_f32 v87, v78, v79
    s_waitcnt lgkmcnt(4)
    s_setprio 3
    v_mfma_f32_32x32x16_bf16 v[64:79], v[24:27], v[8:11], 0
    v_exp_f32 v48, v48
    v_exp_f32 v49, v49
    v_exp_f32 v50, v50
    v_exp_f32 v51, v51
    v_cvt_pk_bf16_f32 v80, v48, v49
    v_cvt_pk_bf16_f32 v81, v50, v51
    v_mfma_f32_32x32x16_bf16 v[88:103], v[44:47], v[84:87], v[88:103]
    v_exp_f32 v52, v52
    v_exp_f32 v53, v53
    v_exp_f32 v54, v54
    v_exp_f32 v55, v55
    v_cvt_pk_bf16_f32 v82, v52, v53
    v_cvt_pk_bf16_f32 v83, v54, v55
    v_mfma_f32_32x32x8_bf16 v[64:79], v[30:31], v[12:13], v[64:79]
    ds_read_b32 v18, v16 offset:12
    ds_read_b128 v[24:27], v3 offset:52992
    ds_read_b32 v30, v14 offset:54016
    v_exp_f32 v56, v56
    v_exp_f32 v57, v57
    v_exp_f32 v58, v58
    v_exp_f32 v59, v59
    v_cvt_pk_bf16_f32 v84, v56, v57
    v_cvt_pk_bf16_f32 v85, v58, v59
    v_mfma_f32_32x32x16_bf16 v[88:103], v[32:35], v[80:83], v[88:103]
    s_mov_b64 exec, s[76:77]
    ds_read_b128 v[32:35], v15 offset:51840
    ds_read_b128 v[44:47], v15 offset:50112
    s_mov_b64 exec, -1
    v_exp_f32 v60, v60
    v_exp_f32 v61, v61
    v_exp_f32 v62, v62
    v_exp_f32 v63, v63
    v_cvt_pk_bf16_f32 v86, v60, v61
    v_cvt_pk_bf16_f32 v87, v62, v63
    s_waitcnt lgkmcnt(4)
    s_setprio 2
    v_mfma_f32_32x32x16_bf16 v[48:63], v[20:23], v[8:11], 0
    v_exp_f32 v64, v64
    v_exp_f32 v65, v65
    v_exp_f32 v66, v66
    v_exp_f32 v67, v67
    v_cvt_pk_bf16_f32 v80, v64, v65
    v_cvt_pk_bf16_f32 v81, v66, v67
    v_mfma_f32_32x32x16_bf16 v[88:103], v[36:39], v[84:87], v[88:103]
    v_exp_f32 v68, v68
    v_exp_f32 v69, v69
    v_exp_f32 v70, v70
    v_exp_f32 v71, v71
    v_cvt_pk_bf16_f32 v82, v68, v69
    v_cvt_pk_bf16_f32 v83, v70, v71
    v_mfma_f32_32x32x8_bf16 v[48:63], v[28:29], v[12:13], v[48:63]
    v_readfirstlane_b32 s7, v18
    s_cmp_lt_u32 s7, 8
    s_cbranch_scc1 Lsl_18
Lbk_19:
    ds_read_b128 v[20:23], v3 offset:0
    ds_read_b32 v28, v14 offset:1024
    v_exp_f32 v72, v72
    v_exp_f32 v73, v73
    v_exp_f32 v74, v74
    v_exp_f32 v75, v75
    v_cvt_pk_bf16_f32 v84, v72, v73
    v_cvt_pk_bf16_f32 v85, v74, v75
    v_mfma_f32_32x32x16_bf16 v[88:103], v[40:43], v[80:83], v[88:103]
    s_mov_b64 exec, s[76:77]
    ds_read_b128 v[40:43], v15 offset:54144
    ds_read_b128 v[36:39], v15 offset:52416
    s_mov_b64 exec, -1
    v_exp_f32 v76, v76
    v_exp_f32 v77, v77
    v_exp_f32 v78, v78
    v_exp_f32 v79, v79
    v_cvt_pk_bf16_f32 v86, v76, v77
    v_cvt_pk_bf16_f32 v87, v78, v79
    s_waitcnt lgkmcnt(4)
    s_setprio 1
    v_mfma_f32_32x32x16_bf16 v[64:79], v[24:27], v[8:11], 0
    v_exp_f32 v48, v48
    v_exp_f32 v49, v49
    v_exp_f32 v50, v50
    v_exp_f32 v51, v51
    v_cvt_pk_bf16_f32 v80, v48, v49
    v_cvt_pk_bf16_f32 v81, v50, v51
    v_mfma_f32_32x32x16_bf16 v[88:103], v[44:47], v[84:87], v[88:103]
    v_exp_f32 v52, v52
    v_exp_f32 v53, v53
    v_exp_f32 v54, v54
    v_exp_f32 v55, v55
    v_cvt_pk_bf16_f32 v82, v52, v53
    v_cvt_pk_bf16_f32 v83, v54, v55
    v_mfma_f32_32x32x8_bf16 v[64:79], v[30:31], v[12:13], v[64:79]
    ds_read_b128 v[24:27], v3 offset:2304
    ds_read_b32 v30, v14 offset:3328
    v_exp_f32 v56, v56
    v_exp_f32 v57, v57
    v_exp_f32 v58, v58
    v_exp_f32 v59, v59
    v_cvt_pk_bf16_f32 v84, v56, v57
    v_cvt_pk_bf16_f32 v85, v58, v59
    v_mfma_f32_32x32x16_bf16 v[88:103], v[32:35], v[80:83], v[88:103]
    s_mov_b64 exec, s[76:77]
    ds_read_b128 v[32:35], v15 offset:1152
    ds_read_b128 v[44:47], v15 offset:54720
    s_mov_b64 exec, -1
    v_exp_f32 v60, v60
    v_exp_f32 v61, v61
    v_exp_f32 v62, v62
    v_exp_f32 v63, v63
    v_cvt_pk_bf16_f32 v86, v60, v61
    v_cvt_pk_bf16_f32 v87, v62, v63
    s_waitcnt lgkmcnt(4)
    s_setprio 0
    v_mfma_f32_32x32x16_bf16 v[48:63], v[20:23], v[8:11], 0
    v_exp_f32 v64, v64
    v_exp_f32 v65, v65
    v_exp_f32 v66, v66
    v_exp_f32 v67, v67
    v_cvt_pk_bf16_f32 v80, v64, v65
    v_cvt_pk_bf16_f32 v81, v66, v67
    v_mfma_f32_32x32x16_bf16 v[88:103], v[36:39], v[84:87], v[88:103]
    v_exp_f32 v68, v68
    v_exp_f32 v69, v69
    v_exp_f32 v70, v70
    v_exp_f32 v71, v71
    v_cvt_pk_bf16_f32 v82, v68, v69
    v_cvt_pk_bf16_f32 v83, v70, v71
    v_mfma_f32_32x32x8_bf16 v[48:63], v[28:29], v[12:13], v[48:63]
    ds_read_b128 v[20:23], v3 offset:4608
    ds_read_b32 v28, v14 offset:5632
    v_exp_f32 v72, v72
    v_exp_f32 v73, v73
    v_exp_f32 v74, v74
    v_exp_f32 v75, v75
    v_cvt_pk_bf16_f32 v84, v72, v73
    v_cvt_pk_bf16_f32 v85, v74, v75
    v_mfma_f32_32x32x16_bf16 v[88:103], v[40:43], v[80:83], v[88:103]
    s_mov_b64 exec, s[76:77]
    ds_read_b128 v[40:43], v15 offset:3456
    ds_read_b128 v[36:39], v15 offset:1728
    s_mov_b64 exec, -1
    v_exp_f32 v76, v76
    v_exp_f32 v77, v77
    v_exp_f32 v78, v78
    v_exp_f32 v79, v79
    v_cvt_pk_bf16_f32 v86, v76, v77
    v_cvt_pk_bf16_f32 v87, v78, v79
    s_waitcnt lgkmcnt(4)
    s_setprio 3
    v_mfma_f32_32x32x16_bf16 v[64:79], v[24:27], v[8:11], 0
    v_exp_f32 v48, v48
    v_exp_f32 v49, v49
    v_exp_f32 v50, v50
    v_exp_f32 v51, v51
    v_cvt_pk_bf16_f32 v80, v48, v49
    v_cvt_pk_bf16_f32 v81, v50, v51
    v_mfma_f32_32x32x16_bf16 v[88:103], v[44:47], v[84:87], v[88:103]
    s_mov_b64 exec, 1
    ds_add_u32 v16, v17 offset:40
    s_mov_b64 exec, -1
    v_exp_f32 v52, v52
    v_exp_f32 v53, v53
    v_exp_f32 v54, v54
    v_exp_f32 v55, v55
    v_cvt_pk_bf16_f32 v82, v52, v53
    v_cvt_pk_bf16_f32 v83, v54, v55
    v_mfma_f32_32x32x8_bf16 v[64:79], v[30:31], v[12:13], v[64:79]
    ds_read_b128 v[24:27], v3 offset:6912
    ds_read_b32 v30, v14 offset:7936
    v_exp_f32 v56, v56
    v_exp_f32 v57, v57
    v_exp_f32 v58, v58
    v_exp_f32 v59, v59
    v_cvt_pk_bf16_f32 v84, v56, v57
    v_cvt_pk_bf16_f32 v85, v58, v59
    v_mfma_f32_32x32x16_bf16 v[88:103], v[32:35], v[80:83], v[88:103]
    s_mov_b64 exec, s[76:77]
    ds_read_b128 v[32:35], v15 offset:5760
    ds_read_b128 v[44:47], v15 offset:4032
    s_mov_b64 exec, -1
    v_exp_f32 v60, v60
    v_exp_f32 v61, v61
    v_exp_f32 v62, v62
    v_exp_f32 v63, v63
    v_cvt_pk_bf16_f32 v86, v60, v61
    v_cvt_pk_bf16_f32 v87, v62, v63
    s_waitcnt lgkmcnt(4)
    s_setprio 2
    v_mfma_f32_32x32x16_bf16 v[48:63], v[20:23], v[8:11], 0
    v_exp_f32 v64, v64
    v_exp_f32 v65, v65
    v_exp_f32 v66, v66
    v_exp_f32 v67, v67
    v_cvt_pk_bf16_f32 v80, v64, v65
    v_cvt_pk_bf16_f32 v81, v66, v67
    v_mfma_f32_32x32x16_bf16 v[88:103], v[36:39], v[84:87], v[88:103]
    s_waitcnt vmcnt(0)
    s_mov_b64 exec, 1
    ds_add_u32 v16, v17 offset:16
    s_mov_b64 exec, -1
    v_exp_f32 v68, v68
    v_exp_f32 v69, v69
    v_exp_f32 v70, v70
    v_exp_f32 v71, v71
    v_cvt_pk_bf16_f32 v82, v68, v69
    v_cvt_pk_bf16_f32 v83, v70, v71
    v_mfma_f32_32x32x8_bf16 v[48:63], v[28:29], v[12:13], v[48:63]
    ds_read_b32 v18, v16 offset:40
    ds_read_b128 v[20:23], v3 offset:9216
    ds_read_b32 v28, v14 offset:10240
    v_exp_f32 v72, v72
    v_exp_f32 v73, v73
    v_exp_f32 v74, v74
    v_exp_f32 v75, v75
    v_cvt_pk_bf16_f32 v84, v72, v73
    v_cvt_pk_bf16_f32 v85, v74, v75
    v_mfma_f32_32x32x16_bf16 v[88:103], v[40:43], v[80:83], v[88:103]
    s_mov_b64 exec, s[76:77]
    ds_read_b128 v[40:43], v15 offset:8064
    ds_read_b128 v[36:39], v15 offset:6336
    s_mov_b64 exec, -1
    v_exp_f32 v76, v76
    v_exp_f32 v77, v77
    v_exp_f32 v78, v78
    v_exp_f32 v79, v79
    v_cvt_pk_bf16_f32 v86, v76, v77
    v_cvt_pk_bf16_f32 v87, v78, v79
    s_waitcnt lgkmcnt(4)
    s_setprio 1
    v_mfma_f32_32x32x16_bf16 v[64:79], v[24:27], v[8:11], 0
    v_exp_f32 v48, v48
    v_exp_f32 v49, v49
    v_exp_f32 v50, v50
    v_exp_f32 v51, v51
    v_cvt_pk_bf16_f32 v80, v48, v49
    v_cvt_pk_bf16_f32 v81, v50, v51
    v_mfma_f32_32x32x16_bf16 v[88:103], v[44:47], v[84:87], v[88:103]
    v_readfirstlane_b32 s7, v18
    s_cmp_lt_u32 s7, 8
    s_cbranch_scc1 Lsl_20
Lbk_21:
    s_add_u32 s6, s50, 5
    s_and_b32 s6, s6, 7
    s_mul_i32 s6, s6, 18432
    s_cmp_ge_u32 s5, 2
    s_cbranch_scc1 Lx_22
    s_add_u32 m0, s11, 36864
    s_add_u32 s9, s6, s11
    buffer_load_dwordx4 v3, s[52:55], s9 offen lds
Lx_22:
    s_add_u32 m0, s10, 36864
    s_add_u32 s9, s6, s10
    buffer_load_dwordx4 v3, s[52:55], s9 offen lds
    buffer_load_dwordx4 v3, s[52:55], s9 offen offset:1024 lds
    v_exp_f32 v52, v52
    v_exp_f32 v53, v53
    v_exp_f32 v54, v54
    v_exp_f32 v55, v55
    v_cvt_pk_bf16_f32 v82, v52, v53
    v_cvt_pk_bf16_f32 v83, v54, v55
    v_mfma_f32_32x32x8_bf16 v[64:79], v[30:31], v[12:13], v[64:79]
    ds_read_b128 v[24:27], v3 offset:11520
    ds_read_b32 v30, v14 offset:12544
    v_exp_f32 v56, v56
    v_exp_f32 v57, v57
    v_exp_f32 v58, v58
    v_exp_f32 v59, v59
    v_cvt_pk_bf16_f32 v84, v56, v57
    v_cvt_pk_bf16_f32 v85, v58, v59
    v_mfma_f32_32x32x16_bf16 v[88:103], v[32:35], v[80:83], v[88:103]
    s_mov_b64 exec, s[76:77]
    ds_read_b128 v[32:35], v15 offset:10368
    ds_read_b128 v[44:47], v15 offset:8640
    s_mov_b64 exec, -1
    v_exp_f32 v60, v60
    v_exp_f32 v61, v61
    v_exp_f32 v62, v62
    v_exp_f32 v63, v63
    v_cvt_pk_bf16_f32 v86, v60, v61
    v_cvt_pk_bf16_f32 v87, v62, v63
    s_waitcnt lgkmcnt(4)
    s_setprio 0
    v_mfma_f32_32x32x16_bf16 v[48:63], v[20:23], v[8:11], 0
    v_exp_f32 v64, v64
    v_exp_f32 v65, v65
    v_exp_f32 v66, v66
    v_exp_f32 v67, v67
    v_cvt_pk_bf16_f32 v80, v64, v65
    v_cvt_pk_bf16_f32 v81, v66, v67
    v_mfma_f32_32x32x16_bf16 v[88:103], v[36:39], v[84:87], v[88:103]
    v_exp_f32 v68, v68
    v_exp_f32 v69, v69
    v_exp_f32 v70, v70
    v_exp_f32 v71, v71
    v_cvt_pk_bf16_f32 v82, v68, v69
    v_cvt_pk_bf16_f32 v83, v70, v71
    v_mfma_f32_32x32x8_bf16 v[48:63], v[28:29], v[12:13], v[48:63]
    ds_read_b128 v[20:23], v3 offset:13824
    ds_read_b32 v28, v14 offset:14848
    v_exp_f32 v72, v72
    v_exp_f32 v73, v73
    v_exp_f32 v74, v74
    v_exp_f32 v75, v75
    v_cvt_pk_bf16_f32 v84, v72, v73
    v_cvt_pk_bf16_f32 v85, v74, v75
    v_mfma_f32_32x32x16_bf16 v[88:103], v[40:43], v[80:83], v[88:103]
    s_mov_b64 exec, s[76:77]
    ds_read_b128 v[40:43], v15 offset:12672
    ds_read_b128 v[36:39], v15 offset:10944
    s_mov_b64 exec, -1
    v_exp_f32 v76, v76
    v_exp_f32 v77, v77
    v_exp_f32 v78, v78
    v_exp_f32 v79, v79
    v_cvt_pk_bf16_f32 v86, v76, v77
    v_cvt_pk_bf16_f32 v87, v78, v79
    s_waitcnt lgkmcnt(4)
    s_setprio 3
    v_mfma_f32_32x32x16_bf16 v[64:79], v[24:27], v[8:11], 0
    v_exp_f32 v48, v48
    v_exp_f32 v49, v49
    v_exp_f32 v50, v50
    v_exp_f32 v51, v51
    v_cvt_pk_bf16_f32 v80, v48, v49
    v_cvt_pk_bf16_f32 v81, v50, v51
    v_mfma_f32_32x32x16_bf16 v[88:103], v[44:47], v[84:87], v[88:103]
    v_exp_f32 v52, v52
    v_exp_f32 v53, v53
    v_exp_f32 v54, v54
    v_exp_f32 v55, v55
    v_cvt_pk_bf16_f32 v82, v52, v53
    v_cvt_pk_bf16_f32 v83, v54, v55
    v_mfma_f32_32x32x8_bf16 v[64:79], v[30:31], v[12:13], v[64:79]
    ds_read_b32 v18, v16 offset:16
    ds_read_b128 v[24:27], v3 offset:16128
    ds_read_b32 v30, v14 offset:17152
    v_exp_f32 v56, v56
    v_exp_f32 v57, v57
    v_exp_f32 v58, v58
    v_exp_f32 v59, v59
    v_cvt_pk_bf16_f32 v84, v56, v57
    v_cvt_pk_bf16_f32 v85, v58, v59
    v_mfma_f32_32x32x16_bf16 v[88:103], v[32:35], v[80:83], v[88:103]
    s_mov_b64 exec, s[76:77]
    ds_read_b128 v[32:35], v15 offset:14976
    ds_read_b128 v[44:47], v15 offset:13248
    s_mov_b64 exec, -1
    v_exp_f32 v60, v60
    v_exp_f32 v61, v61
    v_exp_f32 v62, v62
    v_exp_f32 v63, v63
    v_cvt_pk_bf16_f32 v86, v60, v61
    v_cvt_pk_bf16_f32 v87, v62, v63
    s_waitcnt lgkmcnt(4)
    s_setprio 2
    v_mfma_f32_32x32x16_bf16 v[48:63], v[20:23], v[8:11], 0
    v_exp_f32 v64, v64
    v_exp_f32 v65, v65
    v_exp_f32 v66, v66
    v_exp_f32 v67, v67
    v_cvt_pk_bf16_f32 v80, v64, v65
    v_cvt_pk_bf16_f32 v81, v66, v67
    v_mfma_f32_32x32x16_bf16 v[88:103], v[36:39], v[84:87], v[88:103]
    v_exp_f32 v68, v68
    v_exp_f32 v69, v69
    v_exp_f32 v70, v70
    v_exp_f32 v71, v71
    v_cvt_pk_bf16_f32 v82, v68, v69
    v_cvt_pk_bf16_f32 v83, v70, v71
    v_mfma_f32_32x32x8_bf16 v[48:63], v[28:29], v[12:13], v[48:63]
    v_readfirstlane_b32 s7, v18
    s_cmp_lt_u32 s7, 8
    s_cbranch_scc1 Lsl_23
Lbk_24:
    ds_read_b128 v[20:23], v3 offset:18432
    ds_read_b32 v28, v14 offset:19456
    v_exp_f32 v72, v72
    v_exp_f32 v73, v73
    v_exp_f32 v74, v74
    v_exp_f32 v75, v75
    v_cvt_pk_bf16_f32 v84, v72, v73
    v_cvt_pk_bf16_f32 v85, v74, v75
    v_mfma_f32_32x32x16_bf16 v[88:103], v[40:43], v[80:83], v[88:103]
    s_mov_b64 exec, s[76:77]
    ds_read_b128 v[40:43], v15 offset:17280
    ds_read_b128 v[36:39], v15 offset:15552
    s_mov_b64 exec, -1
    v_exp_f32 v76, v76
    v_exp_f32 v77, v77
    v_exp_f32 v78, v78
    v_exp_f32 v79, v79
    v_cvt_pk_bf16_f32 v86, v76, v77
    v_cvt_pk_bf16_f32 v87, v78, v79
    s_waitcnt lgkmcnt(4)
    s_setprio 1
    v_mfma_f32_32x32x16_bf16 v[64:79], v[24:27], v[8:11], 0
    v_exp_f32 v48, v48
    v_exp_f32 v49, v49
    v_exp_f32 v50, v50
    v_exp_f32 v51, v51
    v_cvt_pk_bf16_f32 v80, v48, v49
    v_cvt_pk_bf16_f32 v81, v50, v51
    v_mfma_f32_32x32x16_bf16 v[88:103], v[44:47], v[84:87], v[88:103]
    v_exp_f32 v52, v52
    v_exp_f32 v53, v53
    v_exp_f32 v54, v54
    v_exp_f32 v55, v55
    v_cvt_pk_bf16_f32 v82, v52, v53
    v_cvt_pk_bf16_f32 v83, v54, v55
    v_mfma_f32_32x32x8_bf16 v[64:79], v[30:31], v[12:13], v[64:79]
    ds_read_b128 v[24:27], v3 offset:20736
    ds_read_b32 v30, v14 offset:21760
    v_exp_f32 v56, v56
    v_exp_f32 v57, v57
    v_exp_f32 v58, v58
    v_exp_f32 v59, v59
    v_cvt_pk_bf16_f32 v84, v56, v57
    v_cvt_pk_bf16_f32 v85, v58, v59
    v_mfma_f32_32x32x16_bf16 v[88:103], v[32:35], v[80:83], v[88:103]
    s_mov_b64 exec, s[76:77]
    ds_read_b128 v[32:35], v15 offset:19584
    ds_read_b128 v[44:47], v15 offset:17856
    s_mov_b64 exec, -1
    v_exp_f32 v60, v60
    v_exp_f32 v61, v61
    v_exp_f32 v62, v62
    v_exp_f32 v63, v63
    v_cvt_pk_bf16_f32 v86, v60, v61
    v_cvt_pk_bf16_f32 v87, v62, v63
    s_waitcnt lgkmcnt(4)
    s_setprio 0
    v_mfma_f32_32x32x16_bf16 v[48:63], v[20:23], v[8:11], 0
    v_exp_f32 v64, v64
    v_exp_f32 v65, v65
    v_exp_f32 v66, v66
    v_exp_f32 v67, v67
    v_cvt_pk_bf16_f32 v80, v64, v65
    v_cvt_pk_bf16_f32 v81, v66, v67
    v_mfma_f32_32x32x16_bf16 v[88:103], v[36:39], v[84:87], v[88:103]
    v_exp_f32 v68, v68
    v_exp_f32 v69, v69
    v_exp_f32 v70, v70
    v_exp_f32 v71, v71
    v_cvt_pk_bf16_f32 v82, v68, v69
    v_cvt_pk_bf16_f32 v83, v70, v71
    v_mfma_f32_32x32x8_bf16 v[48:63], v[28:29], v[12:13], v[48:63]
    ds_read_b128 v[20:23], v3 offset:23040
    ds_read_b32 v28, v14 offset:24064
    v_exp_f32 v72, v72
    v_exp_f32 v73, v73
    v_exp_f32 v74, v74
    v_exp_f32 v75, v75
    v_cvt_pk_bf16_f32 v84, v72, v73
    v_cvt_pk_bf16_f32 v85, v74, v75
    v_mfma_f32_32x32x16_bf16 v[88:103], v[40:43], v[80:83], v[88:103]
    s_mov_b64 exec, s[76:77]
    ds_read_b128 v[40:43], v15 offset:21888
    ds_read_b128 v[36:39], v15 offset:20160
    s_mov_b64 exec, -1
    v_exp_f32 v76, v76
    v_exp_f32 v77, v77
    v_exp_f32 v78, v78
    v_exp_f32 v79, v79
    v_cvt_pk_bf16_f32 v86, v76, v77
    v_cvt_pk_bf16_f32 v87, v78, v79
    s_waitcnt lgkmcnt(4)
    s_setprio 3
    v_mfma_f32_32x32x16_bf16 v[64:79], v[24:27], v[8:11], 0
    v_exp_f32 v48, v48
    v_exp_f32 v49, v49
    v_exp_f32 v50, v50
    v_exp_f32 v51, v51
    v_cvt_pk_bf16_f32 v80, v48, v49
    v_cvt_pk_bf16_f32 v81, v50, v51
    v_mfma_f32_32x32x16_bf16 v[88:103], v[44:47], v[84:87], v[88:103]
    s_mov_b64 exec, 1
    ds_add_u32 v16, v17 offset:44
    s_mov_b64 exec, -1
    v_exp_f32 v52, v52
    v_exp_f32 v53, v53
    v_exp_f32 v54, v54
    v_exp_f32 v55, v55
    v_cvt_pk_bf16_f32 v82, v52, v53
    v_cvt_pk_bf16_f32 v83, v54, v55
    v_mfma_f32_32x32x8_bf16 v[64:79], v[30:31], v[12:13], v[64:79]
    ds_read_b128 v[24:27], v3 offset:25344
    ds_read_b32 v30, v14 offset:26368
    v_exp_f32 v56, v56
    v_exp_f32 v57, v57
    v_exp_f32 v58, v58
    v_exp_f32 v59, v59
    v_cvt_pk_bf16_f32 v84, v56, v57
    v_cvt_pk_bf16_f32 v85, v58, v59
    v_mfma_f32_32x32x16_bf16 v[88:103], v[32:35], v[80:83], v[88:103]
    s_mov_b64 exec, s[76:77]
    ds_read_b128 v[32:35], v15 offset:24192
    ds_read_b128 v[44:47], v15 offset:22464
    s_mov_b64 exec, -1
    v_exp_f32 v60, v60
    v_exp_f32 v61, v61
    v_exp_f32 v62, v62
    v_exp_f32 v63, v63
    v_cvt_pk_bf16_f32 v86, v60, v61
    v_cvt_pk_bf16_f32 v87, v62, v63
    s_waitcnt lgkmcnt(4)
    s_setprio 2
    v_mfma_f32_32x32x16_bf16 v[48:63], v[20:23], v[8:11], 0
    v_exp_f32 v64, v64
    v_exp_f32 v65, v65
    v_exp_f32 v66, v66
    v_exp_f32 v67, v67
    v_cvt_pk_bf16_f32 v80, v64, v65
    v_cvt_pk_bf16_f32 v81, v66, v67
    v_mfma_f32_32x32x16_bf16 v[88:103], v[36:39], v[84:87], v[88:103]
    s_waitcnt vmcnt(0)
    s_mov_b64 exec, 1
    ds_add_u32 v16, v17 offset:20
    s_mov_b64 exec, -1
    v_exp_f32 v68, v68
    v_exp_f32 v69, v69
    v_exp_f32 v70, v70
    v_exp_f32 v71, v71
    v_cvt_pk_bf16_f32 v82, v68, v69
    v_cvt_pk_bf16_f32 v83, v70, v71
    v_mfma_f32_32x32x8_bf16 v[48:63], v[28:29], v[12:13], v[48:63]
    ds_read_b32 v18, v16 offset:44
    ds_read_b128 v[20:23], v3 offset:27648
    ds_read_b32 v28, v14 offset:28672
    v_exp_f32 v72, v72
    v_exp_f32 v73, v73
    v_exp_f32 v74, v74
    v_exp_f32 v75, v75
    v_cvt_pk_bf16_f32 v84, v72, v73
    v_cvt_pk_bf16_f32 v85, v74, v75
    v_mfma_f32_32x32x16_bf16 v[88:103], v[40:43], v[80:83], v[88:103]
    s_mov_b64 exec, s[76:77]
    ds_read_b128 v[40:43], v15 offset:26496
    ds_read_b128 v[36:39], v15 offset:24768
    s_mov_b64 exec, -1
    v_exp_f32 v76, v76
    v_exp_f32 v77, v77
    v_exp_f32 v78, v78
    v_exp_f32 v79, v79
    v_cvt_pk_bf16_f32 v86, v76, v77
    v_cvt_pk_bf16_f32 v87, v78, v79
    s_waitcnt lgkmcnt(4)
    s_setprio 1
    v_mfma_f32_32x32x16_bf16 v[64:79], v[24:27], v[8:11], 0
    v_exp_f32 v48, v48
    v_exp_f32 v49, v49
    v_exp_f32 v50, v50
    v_exp_f32 v51, v51
    v_cvt_pk_bf16_f32 v80, v48, v49
    v_cvt_pk_bf16_f32 v81, v50, v51
    v_mfma_f32_32x32x16_bf16 v[88:103], v[44:47], v[84:87], v[88:103]
    v_readfirstlane_b32 s7, v18
    s_cmp_lt_u32 s7, 8
    s_cbranch_scc1 Lsl_25
Lbk_26:
    s_add_u32 s6, s50, 6
    s_and_b32 s6, s6, 7
    s_mul_i32 s6, s6, 18432
    s_cmp_ge_u32 s5, 2
    s_cbranch_scc1 Lx_27
    s_add_u32 m0, s11, 0
    s_add_u32 s9, s6, s11
    buffer_load_dwordx4 v3, s[52:55], s9 offen lds
Lx_27:
    s_add_u32 m0, s10, 0
    s_add_u32 s9, s6, s10
    buffer_load_dwordx4 v3, s[52:55], s9 offen lds
    buffer_load_dwordx4 v3, s[52:55], s9 offen offset:1024 lds
    v_exp_f32 v52, v52
    v_exp_f32 v53, v53
    v_exp_f32 v54, v54
    v_exp_f32 v55, v55
    v_cvt_pk_bf16_f32 v82, v52, v53
    v_cvt_pk_bf16_f32 v83, v54, v55
    v_mfma_f32_32x32x8_bf16 v[64:79], v[30:31], v[12:13], v[64:79]
    ds_read_b128 v[24:27], v3 offset:29952
    ds_read_b32 v30, v14 offset:30976
    v_exp_f32 v56, v56
    v_exp_f32 v57, v57
    v_exp_f32 v58, v58
    v_exp_f32 v59, v59
    v_cvt_pk_bf16_f32 v84, v56, v57
    v_cvt_pk_bf16_f32 v85, v58, v59
    v_mfma_f32_32x32x16_bf16 v[88:103], v[32:35], v[80:83], v[88:103]
    s_mov_b64 exec, s[76:77]
    ds_read_b128 v[32:35], v15 offset:28800
    ds_read_b128 v[44:47], v15 offset:27072
    s_mov_b64 exec, -1
    v_exp_f32 v60, v60
    v_exp_f32 v61, v61
    v_exp_f32 v62, v62
    v_exp_f32 v63, v63
    v_cvt_pk_bf16_f32 v86, v60, v61
    v_cvt_pk_bf16_f32 v87, v62, v63
    s_waitcnt lgkmcnt(4)
    s_setprio 0
    v_mfma_f32_32x32x16_bf16 v[48:63], v[20:23], v[8:11], 0
    v_exp_f32 v64, v64
    v_exp_f32 v65, v65
    v_exp_f32 v66, v66
    v_exp_f32 v67, v67
    v_cvt_pk_bf16_f32 v80, v64, v65
    v_cvt_pk_bf16_f32 v81, v66, v67
    v_mfma_f32_32x32x16_bf16 v[88:103], v[36:39], v[84:87], v[88:103]
    v_exp_f32 v68, v68
    v_exp_f32 v69, v69
    v_exp_f32 v70, v70
    v_exp_f32 v71, v71
    v_cvt_pk_bf16_f32 v82, v68, v69
    v_cvt_pk_bf16_f32 v83, v70, v71
    v_mfma_f32_32x32x8_bf16 v[48:63], v[28:29], v[12:13], v[48:63]
    ds_read_b128 v[20:23], v3 offset:32256
    ds_read_b32 v28, v14 offset:33280
    v_exp_f32 v72, v72
    v_exp_f32 v73, v73
    v_exp_f32 v74, v74
    v_exp_f32 v75, v75
    v_cvt_pk_bf16_f32 v84, v72, v73
    v_cvt_pk_bf16_f32 v85, v74, v75
    v_mfma_f32_32x32x16_bf16 v[88:103], v[40:43], v[80:83], v[88:103]
    s_mov_b64 exec, s[76:77]
    ds_read_b128 v[40:43], v15 offset:31104
    ds_read_b128 v[36:39], v15 offset:29376
    s_mov_b64 exec, -1
    v_exp_f32 v76, v76
    v_exp_f32 v77, v77
    v_exp_f32 v78, v78
    v_exp_f32 v79, v79
    v_cvt_pk_bf16_f32 v86, v76, v77
    v_cvt_pk_bf16_f32 v87, v78, v79
    s_waitcnt lgkmcnt(4)
    s_setprio 3
    v_mfma_f32_32x32x16_bf16 v[64:79], v[24:27], v[8:11], 0
    v_exp_f32 v48, v48
    v_exp_f32 v49, v49
    v_exp_f32 v50, v50
    v_exp_f32 v51, v51
    v_cvt_pk_bf16_f32 v80, v48, v49
    v_cvt_pk_bf16_f32 v81, v50, v51
    v_mfma_f32_32x32x16_bf16 v[88:103], v[44:47], v[84:87], v[88:103]
    v_exp_f32 v52, v52
    v_exp_f32 v53, v53
    v_exp_f32 v54, v54
    v_exp_f32 v55, v55
    v_cvt_pk_bf16_f32 v82, v52, v53
    v_cvt_pk_bf16_f32 v83, v54, v55
    v_mfma_f32_32x32x8_bf16 v[64:79], v[30:31], v[12:13], v[64:79]
    ds_read_b32 v18, v16 offset:20
    ds_read_b128 v[24:27], v3 offset:34560
    ds_read_b32 v30, v14 offset:35584
    v_exp_f32 v56, v56
    v_exp_f32 v57, v57
    v_exp_f32 v58, v58
    v_exp_f32 v59, v59
    v_cvt_pk_bf16_f32 v84, v56, v57
    v_cvt_pk_bf16_f32 v85, v58, v59
    v_mfma_f32_32x32x16_bf16 v[88:103], v[32:35], v[80:83], v[88:103]
    s_mov_b64 exec, s[76:77]
    ds_read_b128 v[32:35], v15 offset:33408
    ds_read_b128 v[44:47], v15 offset:31680
    s_mov_b64 exec, -1
    v_exp_f32 v60, v60
    v_exp_f32 v61, v61
    v_exp_f32 v62, v62
    v_exp_f32 v63, v63
    v_cvt_pk_bf16_f32 v86, v60, v61
    v_cvt_pk_bf16_f32 v87, v62, v63
    s_waitcnt lgkmcnt(4)
    s_setprio 2
    v_mfma_f32_32x32x16_bf16 v[48:63], v[20:23], v[8:11], 0
    v_exp_f32 v64, v64
    v_exp_f32 v65, v65
    v_exp_f32 v66, v66
    v_exp_f32 v67, v67
    v_cvt_pk_bf16_f32 v80, v64, v65
    v_cvt_pk_bf16_f32 v81, v66, v67
    v_mfma_f32_32x32x16_bf16 v[88:103], v[36:39], v[84:87], v[88:103]
    v_exp_f32 v68, v68
    v_exp_f32 v69, v69
    v_exp_f32 v70, v70
    v_exp_f32 v71, v71
    v_cvt_pk_bf16_f32 v82, v68, v69
    v_cvt_pk_bf16_f32 v83, v70, v71
    v_mfma_f32_32x32x8_bf16 v[48:63], v[28:29], v[12:13], v[48:63]
    v_readfirstlane_b32 s7, v18
    s_cmp_lt_u32 s7, 8
    s_cbranch_scc1 Lsl_28
Lbk_29:
    ds_read_b128 v[20:23], v3 offset:36864
    ds_read_b32 v28, v14 offset:37888
    v_exp_f32 v72, v72
    v_exp_f32 v73, v73
    v_exp_f32 v74, v74
    v_exp_f32 v75, v75
    v_cvt_pk_bf16_f32 v84, v72, v73
    v_cvt_pk_bf16_f32 v85, v74, v75
    v_mfma_f32_32x32x16_bf16 v[88:103], v[40:43], v[80:83], v[88:103]
    s_mov_b64 exec, s[76:77]
    ds_read_b128 v[40:43], v15 offset:35712
    ds_read_b128 v[36:39], v15 offset:33984
    s_mov_b64 exec, -1
    v_exp_f32 v76, v76
    v_exp_f32 v77, v77
    v_exp_f32 v78, v78
    v_exp_f32 v79, v79
    v_cvt_pk_bf16_f32 v86, v76, v77
    v_cvt_pk_bf16_f32 v87, v78, v79
    s_waitcnt lgkmcnt(4)
    s_setprio 1
    v_mfma_f32_32x32x16_bf16 v[64:79], v[24:27], v[8:11], 0
    v_exp_f32 v48, v48
    v_exp_f32 v49, v49
    v_exp_f32 v50, v50
    v_exp_f32 v51, v51
    v_cvt_pk_bf16_f32 v80, v48, v49
    v_cvt_pk_bf16_f32 v81, v50, v51
    v_mfma_f32_32x32x16_bf16 v[88:103], v[44:47], v[84:87], v[88:103]
    v_exp_f32 v52, v52
    v_exp_f32 v53, v53
    v_exp_f32 v54, v54
    v_exp_f32 v55, v55
    v_cvt_pk_bf16_f32 v82, v52, v53
    v_cvt_pk_bf16_f32 v83, v54, v55
    v_mfma_f32_32x32x8_bf16 v[64:79], v[30:31], v[12:13], v[64:79]
    ds_read_b128 v[24:27], v3 offset:39168
    ds_read_b32 v30, v14 offset:40192
    v_exp_f32 v56, v56
    v_exp_f32 v57, v57
    v_exp_f32 v58, v58
    v_exp_f32 v59, v59
    v_cvt_pk_bf16_f32 v84, v56, v57
    v_cvt_pk_bf16_f32 v85, v58, v59
    v_mfma_f32_32x32x16_bf16 v[88:103], v[32:35], v[80:83], v[88:103]
    s_mov_b64 exec, s[76:77]
    ds_read_b128 v[32:35], v15 offset:38016
    ds_read_b128 v[44:47], v15 offset:36288
    s_mov_b64 exec, -1
    v_exp_f32 v60, v60
    v_exp_f32 v61, v61
    v_exp_f32 v62, v62
    v_exp_f32 v63, v63
    v_cvt_pk_bf16_f32 v86, v60, v61
    v_cvt_pk_bf16_f32 v87, v62, v63
    s_waitcnt lgkmcnt(4)
    s_setprio 0
    v_mfma_f32_32x32x16_bf16 v[48:63], v[20:23], v[8:11], 0
    v_exp_f32 v64, v64
    v_exp_f32 v65, v65
    v_exp_f32 v66, v66
    v_exp_f32 v67, v67
    v_cvt_pk_bf16_f32 v80, v64, v65
    v_cvt_pk_bf16_f32 v81, v66, v67
    v_mfma_f32_32x32x16_bf16 v[88:103], v[36:39], v[84:87], v[88:103]
    v_exp_f32 v68, v68
    v_exp_f32 v69, v69
    v_exp_f32 v70, v70
    v_exp_f32 v71, v71
    v_cvt_pk_bf16_f32 v82, v68, v69
    v_cvt_pk_bf16_f32 v83, v70, v71
    v_mfma_f32_32x32x8_bf16 v[48:63], v[28:29], v[12:13], v[48:63]
    ds_read_b128 v[20:23], v3 offset:41472
    ds_read_b32 v28, v14 offset:42496
    v_exp_f32 v72, v72
    v_exp_f32 v73, v73
    v_exp_f32 v74, v74
    v_exp_f32 v75, v75
    v_cvt_pk_bf16_f32 v84, v72, v73
    v_cvt_pk_bf16_f32 v85, v74, v75
    v_mfma_f32_32x32x16_bf16 v[88:103], v[40:43], v[80:83], v[88:103]
    s_mov_b64 exec, s[76:77]
    ds_read_b128 v[40:43], v15 offset:40320
    ds_read_b128 v[36:39], v15 offset:38592
    s_mov_b64 exec, -1
    v_exp_f32 v76, v76
    v_exp_f32 v77, v77
    v_exp_f32 v78, v78
    v_exp_f32 v79, v79
    v_cvt_pk_bf16_f32 v86, v76, v77
    v_cvt_pk_bf16_f32 v87, v78, v79
    s_waitcnt lgkmcnt(4)
    s_setprio 3
    v_mfma_f32_32x32x16_bf16 v[64:79], v[24:27], v[8:11], 0
    v_exp_f32 v48, v48
    v_exp_f32 v49, v49
    v_exp_f32 v50, v50
    v_exp_f32 v51, v51
    v_cvt_pk_bf16_f32 v80, v48, v49
    v_cvt_pk_bf16_f32 v81, v50, v51
    v_mfma_f32_32x32x16_bf16 v[88:103], v[44:47], v[84:87], v[88:103]
    s_mov_b64 exec, 1
    ds_add_u32 v16, v17 offset:48
    s_mov_b64 exec, -1
    v_exp_f32 v52, v52
    v_exp_f32 v53, v53
    v_exp_f32 v54, v54
    v_exp_f32 v55, v55
    v_cvt_pk_bf16_f32 v82, v52, v53
    v_cvt_pk_bf16_f32 v83, v54, v55
    v_mfma_f32_32x32x8_bf16 v[64:79], v[30:31], v[12:13], v[64:79]
    ds_read_b128 v[24:27], v3 offset:43776
    ds_read_b32 v30, v14 offset:44800
    v_exp_f32 v56, v56
    v_exp_f32 v57, v57
    v_exp_f32 v58, v58
    v_exp_f32 v59, v59
    v_cvt_pk_bf16_f32 v84, v56, v57
    v_cvt_pk_bf16_f32 v85, v58, v59
    v_mfma_f32_32x32x16_bf16 v[88:103], v[32:35], v[80:83], v[88:103]
    s_mov_b64 exec, s[76:77]
    ds_read_b128 v[32:35], v15 offset:42624
    ds_read_b128 v[44:47], v15 offset:40896
    s_mov_b64 exec, -1
    v_exp_f32 v60, v60
    v_exp_f32 v61, v61
    v_exp_f32 v62, v62
    v_exp_f32 v63, v63
    v_cvt_pk_bf16_f32 v86, v60, v61
    v_cvt_pk_bf16_f32 v87, v62, v63
    s_waitcnt lgkmcnt(4)
    s_setprio 2
    v_mfma_f32_32x32x16_bf16 v[48:63], v[20:23], v[8:11], 0
    v_exp_f32 v64, v64
    v_exp_f32 v65, v65
    v_exp_f32 v66, v66
    v_exp_f32 v67, v67
    v_cvt_pk_bf16_f32 v80, v64, v65
    v_cvt_pk_bf16_f32 v81, v66, v67
    v_mfma_f32_32x32x16_bf16 v[88:103], v[36:39], v[84:87], v[88:103]
    s_waitcnt vmcnt(0)
    s_mov_b64 exec, 1
    ds_add_u32 v16, v17 offset:24
    s_mov_b64 exec, -1
    v_exp_f32 v68, v68
    v_exp_f32 v69, v69
    v_exp_f32 v70, v70
    v_exp_f32 v71, v71
    v_cvt_pk_bf16_f32 v82, v68, v69
    v_cvt_pk_bf16_f32 v83, v70, v71
    v_mfma_f32_32x32x8_bf16 v[48:63], v[28:29], v[12:13], v[48:63]
    ds_read_b32 v18, v16 offset:48
    ds_read_b128 v[20:23], v3 offset:46080
    ds_read_b32 v28, v14 offset:47104
    v_exp_f32 v72, v72
    v_exp_f32 v73, v73
    v_exp_f32 v74, v74
    v_exp_f32 v75, v75
    v_cvt_pk_bf16_f32 v84, v72, v73
    v_cvt_pk_bf16_f32 v85, v74, v75
    v_mfma_f32_32x32x16_bf16 v[88:103], v[40:43], v[80:83], v[88:103]
    s_mov_b64 exec, s[76:77]
    ds_read_b128 v[40:43], v15 offset:44928
    ds_read_b128 v[36:39], v15 offset:43200
    s_mov_b64 exec, -1
    v_exp_f32 v76, v76
    v_exp_f32 v77, v77
    v_exp_f32 v78, v78
    v_exp_f32 v79, v79
    v_cvt_pk_bf16_f32 v86, v76, v77
    v_cvt_pk_bf16_f32 v87, v78, v79
    s_waitcnt lgkmcnt(4)
    s_setprio 1
    v_mfma_f32_32x32x16_bf16 v[64:79], v[24:27], v[8:11], 0
    v_exp_f32 v48, v48
    v_exp_f32 v49, v49
    v_exp_f32 v50, v50
    v_exp_f32 v51, v51
    v_cvt_pk_bf16_f32 v80, v48, v49
    v_cvt_pk_bf16_f32 v81, v50, v51
    v_mfma_f32_32x32x16_bf16 v[88:103], v[44:47], v[84:87], v[88:103]
    v_readfirstlane_b32 s7, v18
    s_cmp_lt_u32 s7, 8
    s_cbranch_scc1 Lsl_30
Lbk_31:
    s_add_u32 s6, s50, 7
    s_and_b32 s6, s6, 7
    s_mul_i32 s6, s6, 18432
    s_cmp_ge_u32 s5, 2
    s_cbranch_scc1 Lx_32
    s_add_u32 m0, s11, 18432
    s_add_u32 s9, s6, s11
    buffer_load_dwordx4 v3, s[52:55], s9 offen lds
Lx_32:
    s_add_u32 m0, s10, 18432
    s_add_u32 s9, s6, s10
    buffer_load_dwordx4 v3, s[52:55], s9 offen lds
    buffer_load_dwordx4 v3, s[52:55], s9 offen offset:1024 lds
    v_exp_f32 v52, v52
    v_exp_f32 v53, v53
    v_exp_f32 v54, v54
    v_exp_f32 v55, v55
    v_cvt_pk_bf16_f32 v82, v52, v53
    v_cvt_pk_bf16_f32 v83, v54, v55
    v_mfma_f32_32x32x8_bf16 v[64:79], v[30:31], v[12:13], v[64:79]
    ds_read_b128 v[24:27], v3 offset:48384
    ds_read_b32 v30, v14 offset:49408
    v_exp_f32 v56, v56
    v_exp_f32 v57, v57
    v_exp_f32 v58, v58
    v_exp_f32 v59, v59
    v_cvt_pk_bf16_f32 v84, v56, v57
    v_cvt_pk_bf16_f32 v85, v58, v59
    v_mfma_f32_32x32x16_bf16 v[88:103], v[32:35], v[80:83], v[88:103]
    s_mov_b64 exec, s[76:77]
    ds_read_b128 v[32:35], v15 offset:47232
    ds_read_b128 v[44:47], v15 offset:45504
    s_mov_b64 exec, -1
    v_exp_f32 v60, v60
    v_exp_f32 v61, v61
    v_exp_f32 v62, v62
    v_exp_f32 v63, v63
    v_cvt_pk_bf16_f32 v86, v60, v61
    v_cvt_pk_bf16_f32 v87, v62, v63
    s_waitcnt lgkmcnt(4)
    s_setprio 0
    v_mfma_f32_32x32x16_bf16 v[48:63], v[20:23], v[8:11], 0
    v_exp_f32 v64, v64
    v_exp_f32 v65, v65
    v_exp_f32 v66, v66
    v_exp_f32 v67, v67
    v_cvt_pk_bf16_f32 v80, v64, v65
    v_cvt_pk_bf16_f32 v81, v66, v67
    v_mfma_f32_32x32x16_bf16 v[88:103], v[36:39], v[84:87], v[88:103]
    v_exp_f32 v68, v68
    v_exp_f32 v69, v69
    v_exp_f32 v70, v70
    v_exp_f32 v71, v71
    v_cvt_pk_bf16_f32 v82, v68, v69
    v_cvt_pk_bf16_f32 v83, v70, v71
    v_mfma_f32_32x32x8_bf16 v[48:63], v[28:29], v[12:13], v[48:63]
    ds_read_b128 v[20:23], v3 offset:50688
    ds_read_b32 v28, v14 offset:51712
    v_exp_f32 v72, v72
    v_exp_f32 v73, v73
    v_exp_f32 v74, v74
    v_exp_f32 v75, v75
    v_cvt_pk_bf16_f32 v84, v72, v73
    v_cvt_pk_bf16_f32 v85, v74, v75
    v_mfma_f32_32x32x16_bf16 v[88:103], v[40:43], v[80:83], v[88:103]
    s_mov_b64 exec, s[76:77]
    ds_read_b128 v[40:43], v15 offset:49536
    ds_read_b128 v[36:39], v15 offset:47808
    s_mov_b64 exec, -1
    v_exp_f32 v76, v76
    v_exp_f32 v77, v77
    v_exp_f32 v78, v78
    v_exp_f32 v79, v79
    v_cvt_pk_bf16_f32 v86, v76, v77
    v_cvt_pk_bf16_f32 v87, v78, v79
    s_waitcnt lgkmcnt(4)
    s_setprio 3
    v_mfma_f32_32x32x16_bf16 v[64:79], v[24:27], v[8:11], 0
    v_exp_f32 v48, v48
    v_exp_f32 v49, v49
    v_exp_f32 v50, v50
    v_exp_f32 v51, v51
    v_cvt_pk_bf16_f32 v80, v48, v49
    v_cvt_pk_bf16_f32 v81, v50, v51
    v_mfma_f32_32x32x16_bf16 v[88:103], v[44:47], v[84:87], v[88:103]
    v_exp_f32 v52, v52
    v_exp_f32 v53, v53
    v_exp_f32 v54, v54
    v_exp_f32 v55, v55
    v_cvt_pk_bf16_f32 v82, v52, v53
    v_cvt_pk_bf16_f32 v83, v54, v55
    v_mfma_f32_32x32x8_bf16 v[64:79], v[30:31], v[12:13], v[64:79]
    ds_read_b32 v18, v16 offset:24
    ds_read_b128 v[24:27], v3 offset:52992
    ds_read_b32 v30, v14 offset:54016
    v_exp_f32 v56, v56
    v_exp_f32 v57, v57
    v_exp_f32 v58, v58
    v_exp_f32 v59, v59
    v_cvt_pk_bf16_f32 v84, v56, v57
    v_cvt_pk_bf16_f32 v85, v58, v59
    v_mfma_f32_32x32x16_bf16 v[88:103], v[32:35], v[80:83], v[88:103]
    s_mov_b64 exec, s[76:77]
    ds_read_b128 v[32:35], v15 offset:51840
    ds_read_b128 v[44:47], v15 offset:50112
    s_mov_b64 exec, -1
    v_exp_f32 v60, v60
    v_exp_f32 v61, v61
    v_exp_f32 v62, v62
    v_exp_f32 v63, v63
    v_cvt_pk_bf16_f32 v86, v60, v61
    v_cvt_pk_bf16_f32 v87, v62, v63
    s_waitcnt lgkmcnt(4)
    s_setprio 2
    v_mfma_f32_32x32x16_bf16 v[48:63], v[20:23], v[8:11], 0
    v_exp_f32 v64, v64
    v_exp_f32 v65, v65
    v_exp_f32 v66, v66
    v_exp_f32 v67, v67
    v_cvt_pk_bf16_f32 v80, v64, v65
    v_cvt_pk_bf16_f32 v81, v66, v67
    v_mfma_f32_32x32x16_bf16 v[88:103], v[36:39], v[84:87], v[88:103]
    v_exp_f32 v68, v68
    v_exp_f32 v69, v69
    v_exp_f32 v70, v70
    v_exp_f32 v71, v71
    v_cvt_pk_bf16_f32 v82, v68, v69
    v_cvt_pk_bf16_f32 v83, v70, v71
    v_mfma_f32_32x32x8_bf16 v[48:63], v[28:29], v[12:13], v[48:63]
    v_readfirstlane_b32 s7, v18
    s_cmp_lt_u32 s7, 8
    s_cbranch_scc1 Lsl_33
Lbk_34:
    ds_read_b128 v[20:23], v3 offset:0
    ds_read_b32 v28, v14 offset:1024
    v_exp_f32 v72, v72
    v_exp_f32 v73, v73
    v_exp_f32 v74, v74
    v_exp_f32 v75, v75
    v_cvt_pk_bf16_f32 v84, v72, v73
    v_cvt_pk_bf16_f32 v85, v74, v75
    v_mfma_f32_32x32x16_bf16 v[88:103], v[40:43], v[80:83], v[88:103]
    s_mov_b64 exec, s[76:77]
    ds_read_b128 v[40:43], v15 offset:54144
    ds_read_b128 v[36:39], v15 offset:52416
    s_mov_b64 exec, -1
    v_exp_f32 v76, v76
    v_exp_f32 v77, v77
    v_exp_f32 v78, v78
    v_exp_f32 v79, v79
    v_cvt_pk_bf16_f32 v86, v76, v77
    v_cvt_pk_bf16_f32 v87, v78, v79
    s_waitcnt lgkmcnt(4)
    s_setprio 1
    v_mfma_f32_32x32x16_bf16 v[64:79], v[24:27], v[8:11], 0
    v_exp_f32 v48, v48
    v_exp_f32 v49, v49
    v_exp_f32 v50, v50
    v_exp_f32 v51, v51
    v_cvt_pk_bf16_f32 v80, v48, v49
    v_cvt_pk_bf16_f32 v81, v50, v51
    v_mfma_f32_32x32x16_bf16 v[88:103], v[44:47], v[84:87], v[88:103]
    v_exp_f32 v52, v52
    v_exp_f32 v53, v53
    v_exp_f32 v54, v54
    v_exp_f32 v55, v55
    v_cvt_pk_bf16_f32 v82, v52, v53
    v_cvt_pk_bf16_f32 v83, v54, v55
    v_mfma_f32_32x32x8_bf16 v[64:79], v[30:31], v[12:13], v[64:79]
    ds_read_b128 v[24:27], v3 offset:2304
    ds_read_b32 v30, v14 offset:3328
    v_exp_f32 v56, v56
    v_exp_f32 v57, v57
    v_exp_f32 v58, v58
    v_exp_f32 v59, v59
    v_cvt_pk_bf16_f32 v84, v56, v57
    v_cvt_pk_bf16_f32 v85, v58, v59
    v_mfma_f32_32x32x16_bf16 v[88:103], v[32:35], v[80:83], v[88:103]
    s_mov_b64 exec, s[76:77]
    ds_read_b128 v[32:35], v15 offset:1152
    ds_read_b128 v[44:47], v15 offset:54720
    s_mov_b64 exec, -1
    v_exp_f32 v60, v60
    v_exp_f32 v61, v61
    v_exp_f32 v62, v62
    v_exp_f32 v63, v63
    v_cvt_pk_bf16_f32 v86, v60, v61
    v_cvt_pk_bf16_f32 v87, v62, v63
    s_waitcnt lgkmcnt(4)
    s_setprio 0
    v_mfma_f32_32x32x16_bf16 v[48:63], v[20:23], v[8:11], 0
    v_exp_f32 v64, v64
    v_exp_f32 v65, v65
    v_exp_f32 v66, v66
    v_exp_f32 v67, v67
    v_cvt_pk_bf16_f32 v80, v64, v65
    v_cvt_pk_bf16_f32 v81, v66, v67
    v_mfma_f32_32x32x16_bf16 v[88:103], v[36:39], v[84:87], v[88:103]
    v_exp_f32 v68, v68
    v_exp_f32 v69, v69
    v_exp_f32 v70, v70
    v_exp_f32 v71, v71
    v_cvt_pk_bf16_f32 v82, v68, v69
    v_cvt_pk_bf16_f32 v83, v70, v71
    v_mfma_f32_32x32x8_bf16 v[48:63], v[28:29], v[12:13], v[48:63]
    ds_read_b128 v[20:23], v3 offset:4608
    ds_read_b32 v28, v14 offset:5632
    v_exp_f32 v72, v72
    v_exp_f32 v73, v73
    v_exp_f32 v74, v74
    v_exp_f32 v75, v75
    v_cvt_pk_bf16_f32 v84, v72, v73
    v_cvt_pk_bf16_f32 v85, v74, v75
    v_mfma_f32_32x32x16_bf16 v[88:103], v[40:43], v[80:83], v[88:103]
    s_mov_b64 exec, s[76:77]
    ds_read_b128 v[40:43], v15 offset:3456
    ds_read_b128 v[36:39], v15 offset:1728
    s_mov_b64 exec, -1
    v_exp_f32 v76, v76
    v_exp_f32 v77, v77
    v_exp_f32 v78, v78
    v_exp_f32 v79, v79
    v_cvt_pk_bf16_f32 v86, v76, v77
    v_cvt_pk_bf16_f32 v87, v78, v79
    s_waitcnt lgkmcnt(4)
    s_setprio 3
    v_mfma_f32_32x32x16_bf16 v[64:79], v[24:27], v[8:11], 0
    v_exp_f32 v48, v48
    v_exp_f32 v49, v49
    v_exp_f32 v50, v50
    v_exp_f32 v51, v51
    v_cvt_pk_bf16_f32 v80, v48, v49
    v_cvt_pk_bf16_f32 v81, v50, v51
    v_mfma_f32_32x32x16_bf16 v[88:103], v[44:47], v[84:87], v[88:103]
    v_exp_f32 v52, v52
    v_exp_f32 v53, v53
    v_exp_f32 v54, v54
    v_exp_f32 v55, v55
    v_cvt_pk_bf16_f32 v82, v52, v53
    v_cvt_pk_bf16_f32 v83, v54, v55
    v_mfma_f32_32x32x8_bf16 v[64:79], v[30:31], v[12:13], v[64:79]
    ds_read_b128 v[24:27], v3 offset:6912
    ds_read_b32 v30, v14 offset:7936
    v_exp_f32 v56, v56
    v_exp_f32 v57, v57
    v_exp_f32 v58, v58
    v_exp_f32 v59, v59
    v_cvt_pk_bf16_f32 v84, v56, v57
    v_cvt_pk_bf16_f32 v85, v58, v59
    v_mfma_f32_32x32x16_bf16 v[88:103], v[32:35], v[80:83], v[88:103]
    s_mov_b64 exec, s[76:77]
    ds_read_b128 v[32:35], v15 offset:5760
    ds_read_b128 v[44:47], v15 offset:4032
    s_mov_b64 exec, -1
    v_exp_f32 v60, v60
    v_exp_f32 v61, v61
    v_exp_f32 v62, v62
    v_exp_f32 v63, v63
    v_cvt_pk_bf16_f32 v86, v60, v61
    v_cvt_pk_bf16_f32 v87, v62, v63
    s_waitcnt lgkmcnt(4)
    s_setprio 2
    v_mfma_f32_32x32x16_bf16 v[48:63], v[20:23], v[8:11], 0
    v_exp_f32 v64, v64
    v_exp_f32 v65, v65
    v_exp_f32 v66, v66
    v_exp_f32 v67, v67
    v_cvt_pk_bf16_f32 v80, v64, v65
    v_cvt_pk_bf16_f32 v81, v66, v67
    v_mfma_f32_32x32x16_bf16 v[88:103], v[36:39], v[84:87], v[88:103]
    s_waitcnt vmcnt(0)
    s_mov_b64 exec, 1
    ds_add_u32 v16, v17 offset:28
    s_mov_b64 exec, -1
    v_exp_f32 v68, v68
    v_exp_f32 v69, v69
    v_exp_f32 v70, v70
    v_exp_f32 v71, v71
    v_cvt_pk_bf16_f32 v82, v68, v69
    v_cvt_pk_bf16_f32 v83, v70, v71
    v_mfma_f32_32x32x8_bf16 v[48:63], v[28:29], v[12:13], v[48:63]
    ds_read_b128 v[20:23], v3 offset:9216
    ds_read_b32 v28, v14 offset:10240
    v_exp_f32 v72, v72
    v_exp_f32 v73, v73
    v_exp_f32 v74, v74
    v_exp_f32 v75, v75
    v_cvt_pk_bf16_f32 v84, v72, v73
    v_cvt_pk_bf16_f32 v85, v74, v75
    v_mfma_f32_32x32x16_bf16 v[88:103], v[40:43], v[80:83], v[88:103]
    s_mov_b64 exec, s[76:77]
    ds_read_b128 v[40:43], v15 offset:8064
    ds_read_b128 v[36:39], v15 offset:6336
    s_mov_b64 exec, -1
    v_exp_f32 v76, v76
    v_exp_f32 v77, v77
    v_exp_f32 v78, v78
    v_exp_f32 v79, v79
    v_cvt_pk_bf16_f32 v86, v76, v77
    v_cvt_pk_bf16_f32 v87, v78, v79
    s_waitcnt lgkmcnt(4)
    s_setprio 1
    v_mfma_f32_32x32x16_bf16 v[64:79], v[24:27], v[8:11], 0
    v_exp_f32 v48, v48
    v_exp_f32 v49, v49
    v_exp_f32 v50, v50
    v_exp_f32 v51, v51
    v_cvt_pk_bf16_f32 v80, v48, v49
    v_cvt_pk_bf16_f32 v81, v50, v51
    v_mfma_f32_32x32x16_bf16 v[88:103], v[44:47], v[84:87], v[88:103]
    v_exp_f32 v52, v52
    v_exp_f32 v53, v53
    v_exp_f32 v54, v54
    v_exp_f32 v55, v55
    v_cvt_pk_bf16_f32 v82, v52, v53
    v_cvt_pk_bf16_f32 v83, v54, v55
    v_mfma_f32_32x32x8_bf16 v[64:79], v[30:31], v[12:13], v[64:79]
    ds_read_b128 v[24:27], v3 offset:11520
    ds_read_b32 v30, v14 offset:12544
    v_exp_f32 v56, v56
    v_exp_f32 v57, v57
    v_exp_f32 v58, v58
    v_exp_f32 v59, v59
    v_cvt_pk_bf16_f32 v84, v56, v57
    v_cvt_pk_bf16_f32 v85, v58, v59
    v_mfma_f32_32x32x16_bf16 v[88:103], v[32:35], v[80:83], v[88:103]
    s_mov_b64 exec, s[76:77]
    ds_read_b128 v[32:35], v15 offset:10368
    ds_read_b128 v[44:47], v15 offset:8640
    s_mov_b64 exec, -1
    v_exp_f32 v60, v60
    v_exp_f32 v61, v61
    v_exp_f32 v62, v62
    v_exp_f32 v63, v63
    v_cvt_pk_bf16_f32 v86, v60, v61
    v_cvt_pk_bf16_f32 v87, v62, v63
    s_waitcnt lgkmcnt(4)
    s_setprio 0
    v_mfma_f32_32x32x16_bf16 v[48:63], v[20:23], v[8:11], 0
    v_exp_f32 v64, v64
    v_exp_f32 v65, v65
    v_exp_f32 v66, v66
    v_exp_f32 v67, v67
    v_cvt_pk_bf16_f32 v80, v64, v65
    v_cvt_pk_bf16_f32 v81, v66, v67
    v_mfma_f32_32x32x16_bf16 v[88:103], v[36:39], v[84:87], v[88:103]
    v_exp_f32 v68, v68
    v_exp_f32 v69, v69
    v_exp_f32 v70, v70
    v_exp_f32 v71, v71
    v_cvt_pk_bf16_f32 v82, v68, v69
    v_cvt_pk_bf16_f32 v83, v70, v71
    v_mfma_f32_32x32x8_bf16 v[48:63], v[28:29], v[12:13], v[48:63]
    ds_read_b128 v[20:23], v3 offset:13824
    ds_read_b32 v28, v14 offset:14848
    v_exp_f32 v72, v72
    v_exp_f32 v73, v73
    v_exp_f32 v74, v74
    v_exp_f32 v75, v75
    v_cvt_pk_bf16_f32 v84, v72, v73
    v_cvt_pk_bf16_f32 v85, v74, v75
    v_mfma_f32_32x32x16_bf16 v[88:103], v[40:43], v[80:83], v[88:103]
    s_mov_b64 exec, s[76:77]
    ds_read_b128 v[40:43], v15 offset:12672
    ds_read_b128 v[36:39], v15 offset:10944
    s_mov_b64 exec, -1
    v_exp_f32 v76, v76
    v_exp_f32 v77, v77
    v_exp_f32 v78, v78
    v_exp_f32 v79, v79
    v_cvt_pk_bf16_f32 v86, v76, v77
    v_cvt_pk_bf16_f32 v87, v78, v79
    s_waitcnt lgkmcnt(4)
    s_setprio 3
    v_mfma_f32_32x32x16_bf16 v[64:79], v[24:27], v[8:11], 0
    v_exp_f32 v48, v48
    v_exp_f32 v49, v49
    v_exp_f32 v50, v50
    v_exp_f32 v51, v51
    v_cvt_pk_bf16_f32 v80, v48, v49
    v_cvt_pk_bf16_f32 v81, v50, v51
    v_mfma_f32_32x32x16_bf16 v[88:103], v[44:47], v[84:87], v[88:103]
    v_exp_f32 v52, v52
    v_exp_f32 v53, v53
    v_exp_f32 v54, v54
    v_exp_f32 v55, v55
    v_cvt_pk_bf16_f32 v82, v52, v53
    v_cvt_pk_bf16_f32 v83, v54, v55
    v_mfma_f32_32x32x8_bf16 v[64:79], v[30:31], v[12:13], v[64:79]
    ds_read_b32 v18, v16 offset:28
    ds_read_b128 v[24:27], v3 offset:16128
    ds_read_b32 v30, v14 offset:17152
    v_exp_f32 v56, v56
    v_exp_f32 v57, v57
    v_exp_f32 v58, v58
    v_exp_f32 v59, v59
    v_cvt_pk_bf16_f32 v84, v56, v57
    v_cvt_pk_bf16_f32 v85, v58, v59
    v_mfma_f32_32x32x16_bf16 v[88:103], v[32:35], v[80:83], v[88:103]
    s_mov_b64 exec, s[76:77]
    ds_read_b128 v[32:35], v15 offset:14976
    ds_read_b128 v[44:47], v15 offset:13248
    s_mov_b64 exec, -1
    v_exp_f32 v60, v60
    v_exp_f32 v61, v61
    v_exp_f32 v62, v62
    v_exp_f32 v63, v63
    v_cvt_pk_bf16_f32 v86, v60, v61
    v_cvt_pk_bf16_f32 v87, v62, v63
    s_waitcnt lgkmcnt(4)
    s_setprio 2
    v_mfma_f32_32x32x16_bf16 v[48:63], v[20:23], v[8:11], 0
    v_exp_f32 v64, v64
    v_exp_f32 v65, v65
    v_exp_f32 v66, v66
    v_exp_f32 v67, v67
    v_cvt_pk_bf16_f32 v80, v64, v65
    v_cvt_pk_bf16_f32 v81, v66, v67
    v_mfma_f32_32x32x16_bf16 v[88:103], v[36:39], v[84:87], v[88:103]
    v_exp_f32 v68, v68
    v_exp_f32 v69, v69
    v_exp_f32 v70, v70
    v_exp_f32 v71, v71
    v_cvt_pk_bf16_f32 v82, v68, v69
    v_cvt_pk_bf16_f32 v83, v70, v71
    v_mfma_f32_32x32x8_bf16 v[48:63], v[28:29], v[12:13], v[48:63]
    v_readfirstlane_b32 s7, v18
    s_cmp_lt_u32 s7, 8
    s_cbranch_scc1 Lsl_35
Lbk_36:
    ds_read_b128 v[20:23], v3 offset:18432
    ds_read_b32 v28, v14 offset:19456
    v_exp_f32 v72, v72
    v_exp_f32 v73, v73
    v_exp_f32 v74, v74
    v_exp_f32 v75, v75
    v_cvt_pk_bf16_f32 v84, v72, v73
    v_cvt_pk_bf16_f32 v85, v74, v75
    v_mfma_f32_32x32x16_bf16 v[88:103], v[40:43], v[80:83], v[88:103]
    s_mov_b64 exec, s[76:77]
    ds_read_b128 v[40:43], v15 offset:17280
    ds_read_b128 v[36:39], v15 offset:15552
    s_mov_b64 exec, -1
    v_exp_f32 v76, v76
    v_exp_f32 v77, v77
    v_exp_f32 v78, v78
    v_exp_f32 v79, v79
    v_cvt_pk_bf16_f32 v86, v76, v77
    v_cvt_pk_bf16_f32 v87, v78, v79
    s_waitcnt lgkmcnt(4)
    s_setprio 1
    v_mfma_f32_32x32x16_bf16 v[64:79], v[24:27], v[8:11], 0
    v_exp_f32 v48, v48
    v_exp_f32 v49, v49
    v_exp_f32 v50, v50
    v_exp_f32 v51, v51
    v_cvt_pk_bf16_f32 v80, v48, v49
    v_cvt_pk_bf16_f32 v81, v50, v51
    v_mfma_f32_32x32x16_bf16 v[88:103], v[44:47], v[84:87], v[88:103]
    v_exp_f32 v52, v52
    v_exp_f32 v53, v53
    v_exp_f32 v54, v54
    v_exp_f32 v55, v55
    v_cvt_pk_bf16_f32 v82, v52, v53
    v_cvt_pk_bf16_f32 v83, v54, v55
    v_mfma_f32_32x32x8_bf16 v[64:79], v[30:31], v[12:13], v[64:79]
    ds_read_b128 v[24:27], v3 offset:20736
    ds_read_b32 v30, v14 offset:21760
    v_exp_f32 v56, v56
    v_exp_f32 v57, v57
    v_exp_f32 v58, v58
    v_exp_f32 v59, v59
    v_cvt_pk_bf16_f32 v84, v56, v57
    v_cvt_pk_bf16_f32 v85, v58, v59
    v_mfma_f32_32x32x16_bf16 v[88:103], v[32:35], v[80:83], v[88:103]
    s_mov_b64 exec, s[76:77]
    ds_read_b128 v[32:35], v15 offset:19584
    ds_read_b128 v[44:47], v15 offset:17856
    s_mov_b64 exec, -1
    v_exp_f32 v60, v60
    v_exp_f32 v61, v61
    v_exp_f32 v62, v62
    v_exp_f32 v63, v63
    v_cvt_pk_bf16_f32 v86, v60, v61
    v_cvt_pk_bf16_f32 v87, v62, v63
    s_waitcnt lgkmcnt(4)
    s_setprio 0
    v_mfma_f32_32x32x16_bf16 v[48:63], v[20:23], v[8:11], 0
    v_exp_f32 v64, v64
    v_exp_f32 v65, v65
    v_exp_f32 v66, v66
    v_exp_f32 v67, v67
    v_cvt_pk_bf16_f32 v80, v64, v65
    v_cvt_pk_bf16_f32 v81, v66, v67
    v_mfma_f32_32x32x16_bf16 v[88:103], v[36:39], v[84:87], v[88:103]
    v_exp_f32 v68, v68
    v_exp_f32 v69, v69
    v_exp_f32 v70, v70
    v_exp_f32 v71, v71
    v_cvt_pk_bf16_f32 v82, v68, v69
    v_cvt_pk_bf16_f32 v83, v70, v71
    v_mfma_f32_32x32x8_bf16 v[48:63], v[28:29], v[12:13], v[48:63]
    ds_read_b128 v[20:23], v3 offset:23040
    ds_read_b32 v28, v14 offset:24064
    v_exp_f32 v72, v72
    v_exp_f32 v73, v73
    v_exp_f32 v74, v74
    v_exp_f32 v75, v75
    v_cvt_pk_bf16_f32 v84, v72, v73
    v_cvt_pk_bf16_f32 v85, v74, v75
    v_mfma_f32_32x32x16_bf16 v[88:103], v[40:43], v[80:83], v[88:103]
    s_mov_b64 exec, s[76:77]
    ds_read_b128 v[40:43], v15 offset:21888
    ds_read_b128 v[36:39], v15 offset:20160
    s_mov_b64 exec, -1
    v_exp_f32 v76, v76
    v_exp_f32 v77, v77
    v_exp_f32 v78, v78
    v_exp_f32 v79, v79
    v_cvt_pk_bf16_f32 v86, v76, v77
    v_cvt_pk_bf16_f32 v87, v78, v79
    s_waitcnt lgkmcnt(4)
    s_setprio 3
    v_mfma_f32_32x32x16_bf16 v[64:79], v[24:27], v[8:11], 0
    v_exp_f32 v48, v48
    v_exp_f32 v49, v49
    v_exp_f32 v50, v50
    v_exp_f32 v51, v51
    v_cvt_pk_bf16_f32 v80, v48, v49
    v_cvt_pk_bf16_f32 v81, v50, v51
    v_mfma_f32_32x32x16_bf16 v[88:103], v[44:47], v[84:87], v[88:103]
    v_exp_f32 v52, v52
    v_exp_f32 v53, v53
    v_exp_f32 v54, v54
    v_exp_f32 v55, v55
    v_cvt_pk_bf16_f32 v82, v52, v53
    v_cvt_pk_bf16_f32 v83, v54, v55
    v_mfma_f32_32x32x8_bf16 v[64:79], v[30:31], v[12:13], v[64:79]
    ds_read_b128 v[24:27], v3 offset:25344
    ds_read_b32 v30, v14 offset:26368
    v_exp_f32 v56, v56
    v_exp_f32 v57, v57
    v_exp_f32 v58, v58
    v_exp_f32 v59, v59
    v_cvt_pk_bf16_f32 v84, v56, v57
    v_cvt_pk_bf16_f32 v85, v58, v59
    v_mfma_f32_32x32x16_bf16 v[88:103], v[32:35], v[80:83], v[88:103]
    s_mov_b64 exec, s[76:77]
    ds_read_b128 v[32:35], v15 offset:24192
    ds_read_b128 v[44:47], v15 offset:22464
    s_mov_b64 exec, -1
    v_exp_f32 v60, v60
    v_exp_f32 v61, v61
    v_exp_f32 v62, v62
    v_exp_f32 v63, v63
    v_cvt_pk_bf16_f32 v86, v60, v61
    v_cvt_pk_bf16_f32 v87, v62, v63
    s_waitcnt lgkmcnt(4)
    s_setprio 2
    v_mfma_f32_32x32x16_bf16 v[48:63], v[20:23], v[8:11], 0
    v_exp_f32 v64, v64
    v_exp_f32 v65, v65
    v_exp_f32 v66, v66
    v_exp_f32 v67, v67
    v_cvt_pk_bf16_f32 v80, v64, v65
    v_cvt_pk_bf16_f32 v81, v66, v67
    v_mfma_f32_32x32x16_bf16 v[88:103], v[36:39], v[84:87], v[88:103]
    v_exp_f32 v68, v68
    v_exp_f32 v69, v69
    v_exp_f32 v70, v70
    v_exp_f32 v71, v71
    v_cvt_pk_bf16_f32 v82, v68, v69
    v_cvt_pk_bf16_f32 v83, v70, v71
    v_mfma_f32_32x32x8_bf16 v[48:63], v[28:29], v[12:13], v[48:63]
    ds_read_b128 v[20:23], v3 offset:27648
    ds_read_b32 v28, v14 offset:28672
    v_exp_f32 v72, v72
    v_exp_f32 v73, v73
    v_exp_f32 v74, v74
    v_exp_f32 v75, v75
    v_cvt_pk_bf16_f32 v84, v72, v73
    v_cvt_pk_bf16_f32 v85, v74, v75
    v_mfma_f32_32x32x16_bf16 v[88:103], v[40:43], v[80:83], v[88:103]
    s_mov_b64 exec, s[76:77]
    ds_read_b128 v[40:43], v15 offset:26496
    ds_read_b128 v[36:39], v15 offset:24768
    s_mov_b64 exec, -1
    v_exp_f32 v76, v76
    v_exp_f32 v77, v77
    v_exp_f32 v78, v78
    v_exp_f32 v79, v79
    v_cvt_pk_bf16_f32 v86, v76, v77
    v_cvt_pk_bf16_f32 v87, v78, v79
    s_waitcnt lgkmcnt(4)
    s_setprio 1
    v_mfma_f32_32x32x16_bf16 v[64:79], v[24:27], v[8:11], 0
    v_exp_f32 v48, v48
    v_exp_f32 v49, v49
    v_exp_f32 v50, v50
    v_exp_f32 v51, v51
    v_cvt_pk_bf16_f32 v80, v48, v49
    v_cvt_pk_bf16_f32 v81, v50, v51
    v_mfma_f32_32x32x16_bf16 v[88:103], v[44:47], v[84:87], v[88:103]
    v_exp_f32 v52, v52
    v_exp_f32 v53, v53
    v_exp_f32 v54, v54
    v_exp_f32 v55, v55
    v_cvt_pk_bf16_f32 v82, v52, v53
    v_cvt_pk_bf16_f32 v83, v54, v55
    v_mfma_f32_32x32x8_bf16 v[64:79], v[30:31], v[12:13], v[64:79]
    ds_read_b128 v[24:27], v3 offset:29952
    ds_read_b32 v30, v14 offset:30976
    v_exp_f32 v56, v56
    v_exp_f32 v57, v57
    v_exp_f32 v58, v58
    v_exp_f32 v59, v59
    v_cvt_pk_bf16_f32 v84, v56, v57
    v_cvt_pk_bf16_f32 v85, v58, v59
    v_mfma_f32_32x32x16_bf16 v[88:103], v[32:35], v[80:83], v[88:103]
    s_mov_b64 exec, s[76:77]
    ds_read_b128 v[32:35], v15 offset:28800
    ds_read_b128 v[44:47], v15 offset:27072
    s_mov_b64 exec, -1
    v_exp_f32 v60, v60
    v_exp_f32 v61, v61
    v_exp_f32 v62, v62
    v_exp_f32 v63, v63
    v_cvt_pk_bf16_f32 v86, v60, v61
    v_cvt_pk_bf16_f32 v87, v62, v63
    s_waitcnt lgkmcnt(4)
    s_setprio 0
    v_mfma_f32_32x32x16_bf16 v[48:63], v[20:23], v[8:11], 0
    v_exp_f32 v64, v64
    v_exp_f32 v65, v65
    v_exp_f32 v66, v66
    v_exp_f32 v67, v67
    v_cvt_pk_bf16_f32 v80, v64, v65
    v_cvt_pk_bf16_f32 v81, v66, v67
    v_mfma_f32_32x32x16_bf16 v[88:103], v[36:39], v[84:87], v[88:103]
    v_exp_f32 v68, v68
    v_exp_f32 v69, v69
    v_exp_f32 v70, v70
    v_exp_f32 v71, v71
    v_cvt_pk_bf16_f32 v82, v68, v69
    v_cvt_pk_bf16_f32 v83, v70, v71
    v_mfma_f32_32x32x8_bf16 v[48:63], v[28:29], v[12:13], v[48:63]
    ds_read_b128 v[20:23], v3 offset:32256
    ds_read_b32 v28, v14 offset:33280
    v_exp_f32 v72, v72
    v_exp_f32 v73, v73
    v_exp_f32 v74, v74
    v_exp_f32 v75, v75
    v_cvt_pk_bf16_f32 v84, v72, v73
    v_cvt_pk_bf16_f32 v85, v74, v75
    v_mfma_f32_32x32x16_bf16 v[88:103], v[40:43], v[80:83], v[88:103]
    s_mov_b64 exec, s[76:77]
    ds_read_b128 v[40:43], v15 offset:31104
    ds_read_b128 v[36:39], v15 offset:29376
    s_mov_b64 exec, -1
    v_exp_f32 v76, v76
    v_exp_f32 v77, v77
    v_exp_f32 v78, v78
    v_exp_f32 v79, v79
    v_cvt_pk_bf16_f32 v86, v76, v77
    v_cvt_pk_bf16_f32 v87, v78, v79
    s_waitcnt lgkmcnt(4)
    s_setprio 3
    v_mfma_f32_32x32x16_bf16 v[64:79], v[24:27], v[8:11], 0
    v_exp_f32 v48, v48
    v_exp_f32 v49, v49
    v_exp_f32 v50, v50
    v_exp_f32 v51, v51
    v_cvt_pk_bf16_f32 v80, v48, v49
    v_cvt_pk_bf16_f32 v81, v50, v51
    v_mfma_f32_32x32x16_bf16 v[88:103], v[44:47], v[84:87], v[88:103]
    v_exp_f32 v52, v52
    v_exp_f32 v53, v53
    v_exp_f32 v54, v54
    v_exp_f32 v55, v55
    v_cvt_pk_bf16_f32 v82, v52, v53
    v_cvt_pk_bf16_f32 v83, v54, v55
    v_mfma_f32_32x32x8_bf16 v[64:79], v[30:31], v[12:13], v[64:79]
    ds_read_b128 v[24:27], v3 offset:34560
    ds_read_b32 v30, v14 offset:35584
    v_exp_f32 v56, v56
    v_exp_f32 v57, v57
    v_exp_f32 v58, v58
    v_exp_f32 v59, v59
    v_cvt_pk_bf16_f32 v84, v56, v57
    v_cvt_pk_bf16_f32 v85, v58, v59
    v_mfma_f32_32x32x16_bf16 v[88:103], v[32:35], v[80:83], v[88:103]
    s_mov_b64 exec, s[76:77]
    ds_read_b128 v[32:35], v15 offset:33408
    ds_read_b128 v[44:47], v15 offset:31680
    s_mov_b64 exec, -1
    v_exp_f32 v60, v60
    v_exp_f32 v61, v61
    v_exp_f32 v62, v62
    v_exp_f32 v63, v63
    v_cvt_pk_bf16_f32 v86, v60, v61
    v_cvt_pk_bf16_f32 v87, v62, v63
    s_waitcnt lgkmcnt(4)
    s_setprio 2
    v_mfma_f32_32x32x16_bf16 v[48:63], v[20:23], v[8:11], 0
    v_exp_f32 v64, v64
    v_exp_f32 v65, v65
    v_exp_f32 v66, v66
    v_exp_f32 v67, v67
    v_cvt_pk_bf16_f32 v80, v64, v65
    v_cvt_pk_bf16_f32 v81, v66, v67
    v_mfma_f32_32x32x16_bf16 v[88:103], v[36:39], v[84:87], v[88:103]
    v_exp_f32 v68, v68
    v_exp_f32 v69, v69
    v_exp_f32 v70, v70
    v_exp_f32 v71, v71
    v_cvt_pk_bf16_f32 v82, v68, v69
    v_cvt_pk_bf16_f32 v83, v70, v71
    v_mfma_f32_32x32x8_bf16 v[48:63], v[28:29], v[12:13], v[48:63]
    v_exp_f32 v72, v72
    v_exp_f32 v73, v73
    v_exp_f32 v74, v74
    v_exp_f32 v75, v75
    v_cvt_pk_bf16_f32 v84, v72, v73
    v_cvt_pk_bf16_f32 v85, v74, v75
    v_mfma_f32_32x32x16_bf16 v[88:103], v[40:43], v[80:83], v[88:103]
    s_mov_b64 exec, s[76:77]
    ds_read_b128 v[40:43], v15 offset:35712
    ds_read_b128 v[36:39], v15 offset:33984
    s_mov_b64 exec, -1
    v_exp_f32 v76, v76
    v_exp_f32 v77, v77
    v_exp_f32 v78, v78
    v_exp_f32 v79, v79
    v_cvt_pk_bf16_f32 v86, v76, v77
    v_cvt_pk_bf16_f32 v87, v78, v79
    s_waitcnt lgkmcnt(2)
    s_setprio 1
    v_mfma_f32_32x32x16_bf16 v[64:79], v[24:27], v[8:11], 0
    v_exp_f32 v48, v48
    v_exp_f32 v49, v49
    v_exp_f32 v50, v50
    v_exp_f32 v51, v51
    v_cvt_pk_bf16_f32 v80, v48, v49
    v_cvt_pk_bf16_f32 v81, v50, v51
    v_mfma_f32_32x32x16_bf16 v[88:103], v[44:47], v[84:87], v[88:103]
    v_exp_f32 v52, v52
    v_exp_f32 v53, v53
    v_exp_f32 v54, v54
    v_exp_f32 v55, v55
    v_cvt_pk_bf16_f32 v82, v52, v53
    v_cvt_pk_bf16_f32 v83, v54, v55
    v_mfma_f32_32x32x8_bf16 v[64:79], v[30:31], v[12:13], v[64:79]
    v_exp_f32 v56, v56
    v_exp_f32 v57, v57
    v_exp_f32 v58, v58
    v_exp_f32 v59, v59
    v_cvt_pk_bf16_f32 v84, v56, v57
    v_cvt_pk_bf16_f32 v85, v58, v59
    v_mfma_f32_32x32x16_bf16 v[88:103], v[32:35], v[80:83], v[88:103]
    s_mov_b64 exec, s[76:77]
    ds_read_b128 v[44:47], v15 offset:36288
    s_mov_b64 exec, -1
    v_exp_f32 v60, v60
    v_exp_f32 v61, v61
    v_exp_f32 v62, v62
    v_exp_f32 v63, v63
    v_cvt_pk_bf16_f32 v86, v60, v61
    v_cvt_pk_bf16_f32 v87, v62, v63
    s_waitcnt lgkmcnt(1)
    s_setprio 0
    v_exp_f32 v64, v64
    v_exp_f32 v65, v65
    v_exp_f32 v66, v66
    v_exp_f32 v67, v67
    v_cvt_pk_bf16_f32 v80, v64, v65
    v_cvt_pk_bf16_f32 v81, v66, v67
    v_mfma_f32_32x32x16_bf16 v[88:103], v[36:39], v[84:87], v[88:103]
    v_exp_f32 v68, v68
    v_exp_f32 v69, v69
    v_exp_f32 v70, v70
    v_exp_f32 v71, v71
    v_cvt_pk_bf16_f32 v82, v68, v69
    v_cvt_pk_bf16_f32 v83, v70, v71
    v_exp_f32 v72, v72
    v_exp_f32 v73, v73
    v_exp_f32 v74, v74
    v_exp_f32 v75, v75
    v_cvt_pk_bf16_f32 v84, v72, v73
    v_cvt_pk_bf16_f32 v85, v74, v75
    v_mfma_f32_32x32x16_bf16 v[88:103], v[40:43], v[80:83], v[88:103]
    v_exp_f32 v76, v76
    v_exp_f32 v77, v77
    v_exp_f32 v78, v78
    v_exp_f32 v79, v79
    v_cvt_pk_bf16_f32 v86, v76, v77
    v_cvt_pk_bf16_f32 v87, v78, v79
    s_waitcnt lgkmcnt(0)
    s_nop 0
    v_mfma_f32_32x32x16_bf16 v[88:103], v[44:47], v[84:87], v[88:103]
    s_nop 7
    s_nop 7
    v_mov_b32 v105, 0x53800000
    v_cmp_nlt_f32 vcc, v98, v105
    s_nop 4
    s_cbranch_vccnz L_att_fallback
L_att_fin:
    v_rcp_f32 v105, v98
    s_nop 0
    v_mul_f32 v88, v88, v105
    v_mul_f32 v89, v89, v105
    v_mul_f32 v90, v90, v105
    v_mul_f32 v91, v91, v105
    v_mul_f32 v92, v92, v105
    v_mul_f32 v93, v93, v105
    v_mul_f32 v94, v94, v105
    v_mul_f32 v95, v95, v105
    v_mul_f32 v96, v96, v105
    v_mul_f32 v97, v97, v105
    v_cvt_pk_bf16_f32 v80, v88, v89
    v_cvt_pk_bf16_f32 v81, v90, v91
    v_cvt_pk_bf16_f32 v82, v92, v93
    v_cvt_pk_bf16_f32 v83, v94, v95
    v_cvt_pk_bf16_f32 v84, v96, v97
    buffer_store_dwordx4 v[80:83], v4, s[60:63], 0 offen
    s_mov_b32 exec_hi, 0
    buffer_store_dword v84, v7, s[60:63], 0 offen offset:32
L_att_end:
    s_endpgm
Lsl_8:
    s_sleep 1
    ds_read_b32 v18, v16 offset:4
    s_waitcnt lgkmcnt(0)
    v_readfirstlane_b32 s7, v18
    s_cmp_lt_u32 s7, 8
    s_cbranch_scc1 Lsl_8
    s_branch Lbk_9
Lsl_10:
    s_sleep 1
    ds_read_b32 v18, v16 offset:32
    s_waitcnt lgkmcnt(0)
    v_readfirstlane_b32 s7, v18
    s_cmp_lt_u32 s7, 8
    s_cbranch_scc1 Lsl_10
    s_branch Lbk_11
Lsl_13:
    s_sleep 1
    ds_read_b32 v18, v16 offset:8
    s_waitcnt lgkmcnt(0)
    v_readfirstlane_b32 s7, v18
    s_cmp_lt_u32 s7, 8
    s_cbranch_scc1 Lsl_13
    s_branch Lbk_14
Lsl_15:
    s_sleep 1
    ds_read_b32 v18, v16 offset:36
    s_waitcnt lgkmcnt(0)
    v_readfirstlane_b32 s7, v18
    s_cmp_lt_u32 s7, 8
    s_cbranch_scc1 Lsl_15
    s_branch Lbk_16
Lsl_18:
    s_sleep 1
    ds_read_b32 v18, v16 offset:12
    s_waitcnt lgkmcnt(0)
    v_readfirstlane_b32 s7, v18
    s_cmp_lt_u32 s7, 8
    s_cbranch_scc1 Lsl_18
    s_branch Lbk_19
Lsl_20:
    s_sleep 1
    ds_read_b32 v18, v16 offset:40
    s_waitcnt lgkmcnt(0)
    v_readfirstlane_b32 s7, v18
    s_cmp_lt_u32 s7, 8
    s_cbranch_scc1 Lsl_20
    s_branch Lbk_21
Lsl_23:
    s_sleep 1
    ds_read_b32 v18, v16 offset:16
    s_waitcnt lgkmcnt(0)
    v_readfirstlane_b32 s7, v18
    s_cmp_lt_u32 s7, 8
    s_cbranch_scc1 Lsl_23
    s_branch Lbk_24
Lsl_25:
    s_sleep 1
    ds_read_b32 v18, v16 offset:44
    s_waitcnt lgkmcnt(0)
    v_readfirstlane_b32 s7, v18
    s_cmp_lt_u32 s7, 8
    s_cbranch_scc1 Lsl_25
    s_branch Lbk_26
Lsl_28:
    s_sleep 1
    ds_read_b32 v18, v16 offset:20
    s_waitcnt lgkmcnt(0)
    v_readfirstlane_b32 s7, v18
    s_cmp_lt_u32 s7, 8
    s_cbranch_scc1 Lsl_28
    s_branch Lbk_29
Lsl_30:
    s_sleep 1
    ds_read_b32 v18, v16 offset:48
    s_waitcnt lgkmcnt(0)
    v_readfirstlane_b32 s7, v18
    s_cmp_lt_u32 s7, 8
    s_cbranch_scc1 Lsl_30
    s_branch Lbk_31
Lsl_33:
    s_sleep 1
    ds_read_b32 v18, v16 offset:24
    s_waitcnt lgkmcnt(0)
    v_readfirstlane_b32 s7, v18
    s_cmp_lt_u32 s7, 8
    s_cbranch_scc1 Lsl_33
    s_branch Lbk_34
Lsl_35:
    s_sleep 1
    ds_read_b32 v18, v16 offset:28
    s_waitcnt lgkmcnt(0)
    v_readfirstlane_b32 s7, v18
    s_cmp_lt_u32 s7, 8
    s_cbranch_scc1 Lsl_35
    s_branch Lbk_36
L_att_fallback:
    v_mov_b32 v13, 0
    v_mov_b32 v104, 0xff800000
    s_mov_b32 s9, 0
L_att_fm:
    buffer_load_dwordx4 v[20:23], v3, s[52:55], s9 offen
    buffer_load_dword v28, v14, s[52:55], s9 offen offset:1024
    s_add_u32 s9, s9, 2304
    s_waitcnt vmcnt(0)
    v_mfma_f32_32x32x16_bf16 v[48:63], v[20:23], v[8:11], 0
    s_nop 7
    s_nop 2
    v_mfma_f32_32x32x8_bf16 v[48:63], v[28:29], v[12:13], v[48:63]
    s_nop 7
    s_nop 3
    v_max3_f32 v104, v48, v49, v104
    v_max3_f32 v104, v50, v51, v104
    v_max3_f32 v104, v52, v53, v104
    v_max3_f32 v104, v54, v55, v104
    v_max3_f32 v104, v56, v57, v104
    v_max3_f32 v104, v58, v59, v104
    v_max3_f32 v104, v60, v61, v104
    v_max3_f32 v104, v62, v63, v104
    s_cmp_lt_u32 s9, 147456
    s_cbranch_scc1 L_att_fm
    v_mov_b32 v105, v104
    s_nop 1
    v_permlane32_swap_b32 v105, v104
    s_nop 1
    v_max_f32 v104, v104, v105
    v_and_b32 v105, 0xffff0000, v104
    v_sub_f32 v104, v104, v105
    v_cvt_pk_bf16_f32 v105, -v105, -v104
    v_cndmask_b32 v13, 0, v105, s[64:65]
    v_mov_b32 v88, 0
    v_mov_b32 v89, 0
    v_mov_b32 v90, 0
    v_mov_b32 v91, 0
    v_mov_b32 v92, 0
    v_mov_b32 v93, 0
    v_mov_b32 v94, 0
    v_mov_b32 v95, 0
    v_mov_b32 v96, 0
    v_mov_b32 v97, 0
    v_mov_b32 v98, 0
    v_mov_b32 v99, 0
    v_mov_b32 v100, 0
    v_mov_b32 v101, 0
    v_mov_b32 v102, 0
    v_mov_b32 v103, 0
    s_mov_b32 s9, 0
L_att_fl:
    buffer_load_dwordx4 v[20:23], v3, s[52:55], s9 offen
    buffer_load_dword v28, v14, s[52:55], s9 offen offset:1024
    s_mov_b64 exec, s[76:77]
    buffer_load_dwordx4 v[32:35], v15, s[52:55], s9 offen offset:1152
    buffer_load_dwordx4 v[36:39], v15, s[52:55], s9 offen offset:1728
    s_mov_b64 exec, -1
    s_add_u32 s9, s9, 2304
    s_waitcnt vmcnt(0)
    v_mfma_f32_32x32x16_bf16 v[48:63], v[20:23], v[8:11], 0
    s_nop 7
    s_nop 2
    v_mfma_f32_32x32x8_bf16 v[48:63], v[28:29], v[12:13], v[48:63]
    s_nop 7
    s_nop 3
    v_exp_f32 v48, v48
    v_exp_f32 v49, v49
    v_exp_f32 v50, v50
    v_exp_f32 v51, v51
    v_exp_f32 v52, v52
    v_exp_f32 v53, v53
    v_exp_f32 v54, v54
    v_exp_f32 v55, v55
    v_exp_f32 v56, v56
    v_exp_f32 v57, v57
    v_exp_f32 v58, v58
    v_exp_f32 v59, v59
    v_exp_f32 v60, v60
    v_exp_f32 v61, v61
    v_exp_f32 v62, v62
    v_exp_f32 v63, v63
    s_nop 0
    v_cvt_pk_bf16_f32 v80, v48, v49
    v_cvt_pk_bf16_f32 v81, v50, v51
    v_cvt_pk_bf16_f32 v82, v52, v53
    v_cvt_pk_bf16_f32 v83, v54, v55
    v_cvt_pk_bf16_f32 v84, v56, v57
    v_cvt_pk_bf16_f32 v85, v58, v59
    v_cvt_pk_bf16_f32 v86, v60, v61
    v_cvt_pk_bf16_f32 v87, v62, v63
    s_nop 1
    v_mfma_f32_32x32x16_bf16 v[88:103], v[32:35], v[80:83], v[88:103]
    v_mfma_f32_32x32x16_bf16 v[88:103], v[36:39], v[84:87], v[88:103]
    s_cmp_lt_u32 s9, 147456
    s_nop 7
    s_cbranch_scc1 L_att_fl
    s_nop 7
    s_nop 7
    s_branch L_att_fin
L_att_g:
    s_waitcnt lgkmcnt(0)
    s_barrier
    s_cmp_ge_u32 s7, 18
    s_cbranch_scc1 L_att_pf
    s_sub_u32 s5, s5, 8
    s_and_b32 s8, s7, 1
    s_lshl_b32 s3, s6, 1
    s_add_u32 s3, s3, s8
    s_lshr_b32 s4, s7, 1
    s_setprio 0
    s_sleep 5
    s_add_u32 s52, s48, 0xe00000
    s_addc_u32 s53, s49, 0
    s_mov_b32 s54, 0x480000
    s_mov_b32 s55, 0x00020000
    s_add_u32 s56, s48, 0xb00000
    s_addc_u32 s57, s49, 0
    s_mov_b32 s58, 0xc2000
    s_mov_b32 s59, 0x00020000
    s_lshr_b32 s12, s5, 1
    s_and_b32 s13, s5, 1
    s_lshl_b32 s14, s4, 6
    s_lshl_b32 s6, s13, 5
    v_and_b32 v4, 31, v1
    v_add_u32 v4, s6, v4
    v_lshlrev_b32 v6, 4, v1
    s_mul_i32 s6, s3, 9
    s_add_u32 s6, s6, s4
    s_lshl_b32 s6, s6, 2
    s_add_u32 s6, s6, s5
    s_lshl_b32 s8, s6, 10
    s_add_u32 s8, s8, 131072
    s_lshl_b32 s6, s6, 13
    s_add_u32 s7, s6, 4096
    s_lshl_b32 s9, s4, 2
    s_add_u32 s9, s9, s5
    s_lshl_b32 s9, s9, 11
    s_add_u32 s9, s9, 720896
    buffer_load_dwordx4 v[44:47], v6, s[56:59], s9 offen
    buffer_load_dwordx4 v[48:51], v6, s[56:59], s9 offen offset:1024
    buffer_load_dwordx4 v[40:43], v6, s[56:59], s8 offen
    buffer_load_dwordx4 v[8:11], v6, s[52:55], s6 offen offset:0
    buffer_load_dwordx4 v[12:15], v6, s[52:55], s6 offen offset:1024
    buffer_load_dwordx4 v[16:19], v6, s[52:55], s6 offen offset:2048
    buffer_load_dwordx4 v[20:23], v6, s[52:55], s6 offen offset:3072
    buffer_load_dwordx4 v[24:27], v6, s[52:55], s7 offen offset:0
    buffer_load_dwordx4 v[28:31], v6, s[52:55], s7 offen offset:1024
    buffer_load_dwordx4 v[32:35], v6, s[52:55], s7 offen offset:2048
    buffer_load_dwordx4 v[36:39], v6, s[52:55], s7 offen offset:3072
    v_lshlrev_b32 v4, 3, v4
    s_lshl_b32 s7, s4, 13
    v_add_u32 v4, s7, v4
    s_movk_i32 s8, 4096
    buffer_load_dwordx2 v[52:53], v4, s[56:59], 0 offen offset:0
    buffer_load_dwordx2 v[54:55], v4, s[56:59], 0 offen offset:512
    buffer_load_dwordx2 v[56:57], v4, s[56:59], 0 offen offset:1024
    buffer_load_dwordx2 v[58:59], v4, s[56:59], 0 offen offset:1536
    buffer_load_dwordx2 v[60:61], v4, s[56:59], 0 offen offset:2048
    buffer_load_dwordx2 v[62:63], v4, s[56:59], 0 offen offset:2560
    buffer_load_dwordx2 v[64:65], v4, s[56:59], 0 offen offset:3072
    buffer_load_dwordx2 v[66:67], v4, s[56:59], 0 offen offset:3584
    buffer_load_dwordx2 v[68:69], v4, s[56:59], s8 offen offset:0
    buffer_load_dwordx2 v[70:71], v4, s[56:59], s8 offen offset:512
    buffer_load_dwordx2 v[72:73], v4, s[56:59], s8 offen offset:1024
    buffer_load_dwordx2 v[74:75], v4, s[56:59], s8 offen offset:1536
    buffer_load_dwordx2 v[76:77], v4, s[56:59], s8 offen offset:2048
    buffer_load_dwordx2 v[78:79], v4, s[56:59], s8 offen offset:2560
    buffer_load_dwordx2 v[80:81], v4, s[56:59], s8 offen offset:3072
    s_add_u32 s60, s48, 0x300000
    s_addc_u32 s61, s49, 0
    s_mov_b32 s62, 0x480000
    s_mov_b32 s63, 0x00020000
    v_lshrrev_b32 v5, 5, v1
    v_mov_b32 v82, 0
    v_mov_b32 v83, 0
    s_lshl_b32 s6, s5, 13
    s_add_u32 s6, s6, 55296
    v_and_b32 v3, 7, v1
    v_lshlrev_b32 v86, 2, v5
    v_xor_b32 v86, v86, v3
    v_lshlrev_b32 v86, 4, v86
    v_and_b32 v87, 31, v1
    v_lshl_add_u32 v86, v87, 7, v86
    v_add_u32 v86, s6, v86
    v_lshrrev_b32 v87, 3, v1
    v_xor_b32 v6, v87, v3
    v_lshlrev_b32 v6, 4, v6
    v_lshl_add_u32 v6, v87, 7, v6
    s_lshl_b32 s7, s13, 5
    s_add_u32 s7, s7, s14
    v_add_u32 v87, s7, v87
    v_lshlrev_b32 v87, 8, v87
    v_lshl_add_u32 v3, v3, 4, v87
    v_add_u32 v87, s6, v6
    v_mov_b32 v6, v3
    v_xor_b32 v88, 16, v86
    v_xor_b32 v89, 32, v86
    v_xor_b32 v90, 48, v86
    v_mov_b32 v91, 88064
    ds_read_b32 v92, v91 offset:24
    s_waitcnt vmcnt(0)
    s_cmp_le_u32 s3, 0
    s_cbranch_scc1 Lgdone_37
    v_fma_f32 v84, v50, v82, v52
    v_fma_f32 v85, v50, v83, v53
    v_fma_f32 v84, -v51, v83, v84
    v_fma_f32 v85, v51, v82, v85
    s_cmp_le_u32 s3, 1
    s_cbranch_scc1 Lgodd_38
    v_fma_f32 v82, v50, v84, v54
    v_fma_f32 v83, v50, v85, v55
    v_fma_f32 v82, -v51, v85, v82
    v_fma_f32 v83, v51, v84, v83
    s_cmp_le_u32 s3, 2
    s_cbranch_scc1 Lgdone_37
    v_fma_f32 v84, v50, v82, v56
    v_fma_f32 v85, v50, v83, v57
    v_fma_f32 v84, -v51, v83, v84
    v_fma_f32 v85, v51, v82, v85
    s_cmp_le_u32 s3, 3
    s_cbranch_scc1 Lgodd_38
    v_fma_f32 v82, v50, v84, v58
    v_fma_f32 v83, v50, v85, v59
    v_fma_f32 v82, -v51, v85, v82
    v_fma_f32 v83, v51, v84, v83
    s_cmp_le_u32 s3, 4
    s_cbranch_scc1 Lgdone_37
    v_fma_f32 v84, v50, v82, v60
    v_fma_f32 v85, v50, v83, v61
    v_fma_f32 v84, -v51, v83, v84
    v_fma_f32 v85, v51, v82, v85
    s_cmp_le_u32 s3, 5
    s_cbranch_scc1 Lgodd_38
    v_fma_f32 v82, v50, v84, v62
    v_fma_f32 v83, v50, v85, v63
    v_fma_f32 v82, -v51, v85, v82
    v_fma_f32 v83, v51, v84, v83
    s_cmp_le_u32 s3, 6
    s_cbranch_scc1 Lgdone_37
    v_fma_f32 v84, v50, v82, v64
    v_fma_f32 v85, v50, v83, v65
    v_fma_f32 v84, -v51, v83, v84
    v_fma_f32 v85, v51, v82, v85
    s_cmp_le_u32 s3, 7
    s_cbranch_scc1 Lgodd_38
    v_fma_f32 v82, v50, v84, v66
    v_fma_f32 v83, v50, v85, v67
    v_fma_f32 v82, -v51, v85, v82
    v_fma_f32 v83, v51, v84, v83
    s_cmp_le_u32 s3, 8
    s_cbranch_scc1 Lgdone_37
    v_fma_f32 v84, v50, v82, v68
    v_fma_f32 v85, v50, v83, v69
    v_fma_f32 v84, -v51, v83, v84
    v_fma_f32 v85, v51, v82, v85
    s_cmp_le_u32 s3, 9
    s_cbranch_scc1 Lgodd_38
    v_fma_f32 v82, v50, v84, v70
    v_fma_f32 v83, v50, v85, v71
    v_fma_f32 v82, -v51, v85, v82
    v_fma_f32 v83, v51, v84, v83
    s_cmp_le_u32 s3, 10
    s_cbranch_scc1 Lgdone_37
    v_fma_f32 v84, v50, v82, v72
    v_fma_f32 v85, v50, v83, v73
    v_fma_f32 v84, -v51, v83, v84
    v_fma_f32 v85, v51, v82, v85
    s_cmp_le_u32 s3, 11
    s_cbranch_scc1 Lgodd_38
    v_fma_f32 v82, v50, v84, v74
    v_fma_f32 v83, v50, v85, v75
    v_fma_f32 v82, -v51, v85, v82
    v_fma_f32 v83, v51, v84, v83
    s_cmp_le_u32 s3, 12
    s_cbranch_scc1 Lgdone_37
    v_fma_f32 v84, v50, v82, v76
    v_fma_f32 v85, v50, v83, v77
    v_fma_f32 v84, -v51, v83, v84
    v_fma_f32 v85, v51, v82, v85
    s_cmp_le_u32 s3, 13
    s_cbranch_scc1 Lgodd_38
    v_fma_f32 v82, v50, v84, v78
    v_fma_f32 v83, v50, v85, v79
    v_fma_f32 v82, -v51, v85, v82
    v_fma_f32 v83, v51, v84, v83
    s_cmp_le_u32 s3, 14
    s_cbranch_scc1 Lgdone_37
    v_fma_f32 v84, v50, v82, v80
    v_fma_f32 v85, v50, v83, v81
    v_fma_f32 v84, -v51, v83, v84
    v_fma_f32 v85, v51, v82, v85
Lgodd_38:
    v_mov_b32 v82, v84
    v_mov_b32 v83, v85
Lgdone_37:
    v_mul_f32 v94, v44, v82
    v_mul_f32 v96, v44, v83
    v_fma_f32 v94, -v45, v83, v94
    v_fma_f32 v96, v45, v82, v96
    v_fma_f32 v95, v48, v94, v41
    v_fma_f32 v97, v48, v96, v43
    v_fma_f32 v95, -v49, v96, v95
    v_fma_f32 v97, v49, v94, v97
    v_add_f32 v94, v94, v40
    v_add_f32 v96, v96, v42
    s_mul_i32 s6, s3, 294912
    s_lshl_b32 s7, s12, 7
    s_add_u32 s6, s6, s7
    s_add_u32 s7, s6, 147456
    s_waitcnt lgkmcnt(0)
    v_readfirstlane_b32 s9, v92
    ds_read_b32 v92, v91 offset:24
    s_cmp_lt_u32 s9, 8
    s_cbranch_scc1 Lbo_39
    s_setprio 3
Lbo_39:
    v_mul_f32 v98, v46, v94
    v_mul_f32 v100, v46, v96
    v_mul_f32 v99, v46, v95
    v_mul_f32 v101, v46, v97
    v_lshlrev_b32 v102, 16, v8
    v_lshlrev_b32 v104, 16, v24
    v_lshlrev_b32 v103, 16, v16
    v_lshlrev_b32 v105, 16, v32
    v_fma_f32 v98, -v47, v96, v98
    v_fmac_f32 v100, v47, v94
    v_fma_f32 v99, -v47, v97, v99
    v_fmac_f32 v101, v47, v95
    v_add_f32 v102, v102, v98
    v_sub_f32 v104, v104, v100
    v_add_f32 v103, v103, v99
    v_sub_f32 v105, v105, v101
    s_waitcnt lgkmcnt(0)
    v_readfirstlane_b32 s9, v92
    ds_read_b32 v92, v91 offset:24
    s_cmp_lt_u32 s9, 8
    s_cbranch_scc1 Lbo_40
    s_setprio 3
Lbo_40:
    v_mul_f32 v94, v46, v98
    v_mul_f32 v96, v46, v100
    v_mul_f32 v95, v46, v99
    v_mul_f32 v97, v46, v101
    v_and_b32 v106, 0xffff0000, v8
    v_and_b32 v108, 0xffff0000, v24
    v_and_b32 v107, 0xffff0000, v16
    v_and_b32 v109, 0xffff0000, v32
    v_fma_f32 v94, -v47, v100, v94
    v_fmac_f32 v96, v47, v98
    v_fma_f32 v95, -v47, v101, v95
    v_fmac_f32 v97, v47, v99
    v_add_f32 v106, v106, v94
    v_sub_f32 v108, v108, v96
    v_add_f32 v107, v107, v95
    v_sub_f32 v109, v109, v97
    v_cvt_pk_bf16_f32 v8, v102, v106
    v_cvt_pk_bf16_f32 v24, v104, v108
    v_cvt_pk_bf16_f32 v16, v103, v107
    v_cvt_pk_bf16_f32 v32, v105, v109
    s_waitcnt lgkmcnt(0)
    v_readfirstlane_b32 s9, v92
    ds_read_b32 v92, v91 offset:24
    s_cmp_lt_u32 s9, 8
    s_cbranch_scc1 Lbo_41
    s_setprio 3
Lbo_41:
    v_mul_f32 v98, v46, v94
    v_mul_f32 v100, v46, v96
    v_mul_f32 v99, v46, v95
    v_mul_f32 v101, v46, v97
    v_lshlrev_b32 v102, 16, v9
    v_lshlrev_b32 v104, 16, v25
    v_lshlrev_b32 v103, 16, v17
    v_lshlrev_b32 v105, 16, v33
    v_fma_f32 v98, -v47, v96, v98
    v_fmac_f32 v100, v47, v94
    v_fma_f32 v99, -v47, v97, v99
    v_fmac_f32 v101, v47, v95
    v_add_f32 v102, v102, v98
    v_sub_f32 v104, v104, v100
    v_add_f32 v103, v103, v99
    v_sub_f32 v105, v105, v101
    s_waitcnt lgkmcnt(0)
    v_readfirstlane_b32 s9, v92
    ds_read_b32 v92, v91 offset:24
    s_cmp_lt_u32 s9, 8
    s_cbranch_scc1 Lbo_42
    s_setprio 3
Lbo_42:
    v_mul_f32 v94, v46, v98
    v_mul_f32 v96, v46, v100
    v_mul_f32 v95, v46, v99
    v_mul_f32 v97, v46, v101
    v_and_b32 v106, 0xffff0000, v9
    v_and_b32 v108, 0xffff0000, v25
    v_and_b32 v107, 0xffff0000, v17
    v_and_b32 v109, 0xffff0000, v33
    v_fma_f32 v94, -v47, v100, v94
    v_fmac_f32 v96, v47, v98
    v_fma_f32 v95, -v47, v101, v95
    v_fmac_f32 v97, v47, v99
    v_add_f32 v106, v106, v94
    v_sub_f32 v108, v108, v96
    v_add_f32 v107, v107, v95
    v_sub_f32 v109, v109, v97
    v_cvt_pk_bf16_f32 v9, v102, v106
    v_cvt_pk_bf16_f32 v25, v104, v108
    v_cvt_pk_bf16_f32 v17, v103, v107
    v_cvt_pk_bf16_f32 v33, v105, v109
    s_waitcnt lgkmcnt(0)
    v_readfirstlane_b32 s9, v92
    ds_read_b32 v92, v91 offset:24
    s_cmp_lt_u32 s9, 8
    s_cbranch_scc1 Lbo_43
    s_setprio 3
Lbo_43:
    v_mul_f32 v98, v46, v94
    v_mul_f32 v100, v46, v96
    v_mul_f32 v99, v46, v95
    v_mul_f32 v101, v46, v97
    v_lshlrev_b32 v102, 16, v10
    v_lshlrev_b32 v104, 16, v26
    v_lshlrev_b32 v103, 16, v18
    v_lshlrev_b32 v105, 16, v34
    v_fma_f32 v98, -v47, v96, v98
    v_fmac_f32 v100, v47, v94
    v_fma_f32 v99, -v47, v97, v99
    v_fmac_f32 v101, v47, v95
    v_add_f32 v102, v102, v98
    v_sub_f32 v104, v104, v100
    v_add_f32 v103, v103, v99
    v_sub_f32 v105, v105, v101
    s_waitcnt lgkmcnt(0)
    v_readfirstlane_b32 s9, v92
    ds_read_b32 v92, v91 offset:24
    s_cmp_lt_u32 s9, 8
    s_cbranch_scc1 Lbo_44
    s_setprio 3
Lbo_44:
    v_mul_f32 v94, v46, v98
    v_mul_f32 v96, v46, v100
    v_mul_f32 v95, v46, v99
    v_mul_f32 v97, v46, v101
    v_and_b32 v106, 0xffff0000, v10
    v_and_b32 v108, 0xffff0000, v26
    v_and_b32 v107, 0xffff0000, v18
    v_and_b32 v109, 0xffff0000, v34
    v_fma_f32 v94, -v47, v100, v94
    v_fmac_f32 v96, v47, v98
    v_fma_f32 v95, -v47, v101, v95
    v_fmac_f32 v97, v47, v99
    v_add_f32 v106, v106, v94
    v_sub_f32 v108, v108, v96
    v_add_f32 v107, v107, v95
    v_sub_f32 v109, v109, v97
    v_cvt_pk_bf16_f32 v10, v102, v106
    v_cvt_pk_bf16_f32 v26, v104, v108
    v_cvt_pk_bf16_f32 v18, v103, v107
    v_cvt_pk_bf16_f32 v34, v105, v109
    s_waitcnt lgkmcnt(0)
    v_readfirstlane_b32 s9, v92
    ds_read_b32 v92, v91 offset:24
    s_cmp_lt_u32 s9, 8
    s_cbranch_scc1 Lbo_45
    s_setprio 3
Lbo_45:
    v_mul_f32 v98, v46, v94
    v_mul_f32 v100, v46, v96
    v_mul_f32 v99, v46, v95
    v_mul_f32 v101, v46, v97
    v_lshlrev_b32 v102, 16, v11
    v_lshlrev_b32 v104, 16, v27
    v_lshlrev_b32 v103, 16, v19
    v_lshlrev_b32 v105, 16, v35
    v_fma_f32 v98, -v47, v96, v98
    v_fmac_f32 v100, v47, v94
    v_fma_f32 v99, -v47, v97, v99
    v_fmac_f32 v101, v47, v95
    v_add_f32 v102, v102, v98
    v_sub_f32 v104, v104, v100
    v_add_f32 v103, v103, v99
    v_sub_f32 v105, v105, v101
    s_waitcnt lgkmcnt(0)
    v_readfirstlane_b32 s9, v92
    ds_read_b32 v92, v91 offset:24
    s_cmp_lt_u32 s9, 8
    s_cbranch_scc1 Lbo_46
    s_setprio 3
Lbo_46:
    v_mul_f32 v94, v46, v98
    v_mul_f32 v96, v46, v100
    v_mul_f32 v95, v46, v99
    v_mul_f32 v97, v46, v101
    v_and_b32 v106, 0xffff0000, v11
    v_and_b32 v108, 0xffff0000, v27
    v_and_b32 v107, 0xffff0000, v19
    v_and_b32 v109, 0xffff0000, v35
    v_fma_f32 v94, -v47, v100, v94
    v_fmac_f32 v96, v47, v98
    v_fma_f32 v95, -v47, v101, v95
    v_fmac_f32 v97, v47, v99
    v_add_f32 v106, v106, v94
    v_sub_f32 v108, v108, v96
    v_add_f32 v107, v107, v95
    v_sub_f32 v109, v109, v97
    v_cvt_pk_bf16_f32 v11, v102, v106
    v_cvt_pk_bf16_f32 v27, v104, v108
    v_cvt_pk_bf16_f32 v19, v103, v107
    v_cvt_pk_bf16_f32 v35, v105, v109
    s_waitcnt lgkmcnt(0)
    v_readfirstlane_b32 s9, v92
    ds_read_b32 v92, v91 offset:24
    s_cmp_lt_u32 s9, 8
    s_cbranch_scc1 Lbo_47
    s_setprio 3
Lbo_47:
    v_mul_f32 v98, v46, v94
    v_mul_f32 v100, v46, v96
    v_mul_f32 v99, v46, v95
    v_mul_f32 v101, v46, v97
    v_lshlrev_b32 v102, 16, v12
    v_lshlrev_b32 v104, 16, v28
    v_lshlrev_b32 v103, 16, v20
    v_lshlrev_b32 v105, 16, v36
    v_fma_f32 v98, -v47, v96, v98
    v_fmac_f32 v100, v47, v94
    v_fma_f32 v99, -v47, v97, v99
    v_fmac_f32 v101, v47, v95
    v_add_f32 v102, v102, v98
    v_sub_f32 v104, v104, v100
    v_add_f32 v103, v103, v99
    v_sub_f32 v105, v105, v101
    s_waitcnt lgkmcnt(0)
    v_readfirstlane_b32 s9, v92
    ds_read_b32 v92, v91 offset:24
    s_cmp_lt_u32 s9, 8
    s_cbranch_scc1 Lbo_48
    s_setprio 3
Lbo_48:
    v_mul_f32 v94, v46, v98
    v_mul_f32 v96, v46, v100
    v_mul_f32 v95, v46, v99
    v_mul_f32 v97, v46, v101
    v_and_b32 v106, 0xffff0000, v12
    v_and_b32 v108, 0xffff0000, v28
    v_and_b32 v107, 0xffff0000, v20
    v_and_b32 v109, 0xffff0000, v36
    v_fma_f32 v94, -v47, v100, v94
    v_fmac_f32 v96, v47, v98
    v_fma_f32 v95, -v47, v101, v95
    v_fmac_f32 v97, v47, v99
    v_add_f32 v106, v106, v94
    v_sub_f32 v108, v108, v96
    v_add_f32 v107, v107, v95
    v_sub_f32 v109, v109, v97
    v_cvt_pk_bf16_f32 v12, v102, v106
    v_cvt_pk_bf16_f32 v28, v104, v108
    v_cvt_pk_bf16_f32 v20, v103, v107
    v_cvt_pk_bf16_f32 v36, v105, v109
    s_waitcnt lgkmcnt(0)
    v_readfirstlane_b32 s9, v92
    ds_read_b32 v92, v91 offset:24
    s_cmp_lt_u32 s9, 8
    s_cbranch_scc1 Lbo_49
    s_setprio 3
Lbo_49:
    v_mul_f32 v98, v46, v94
    v_mul_f32 v100, v46, v96
    v_mul_f32 v99, v46, v95
    v_mul_f32 v101, v46, v97
    v_lshlrev_b32 v102, 16, v13
    v_lshlrev_b32 v104, 16, v29
    v_lshlrev_b32 v103, 16, v21
    v_lshlrev_b32 v105, 16, v37
    v_fma_f32 v98, -v47, v96, v98
    v_fmac_f32 v100, v47, v94
    v_fma_f32 v99, -v47, v97, v99
    v_fmac_f32 v101, v47, v95
    v_add_f32 v102, v102, v98
    v_sub_f32 v104, v104, v100
    v_add_f32 v103, v103, v99
    v_sub_f32 v105, v105, v101
    s_waitcnt lgkmcnt(0)
    v_readfirstlane_b32 s9, v92
    ds_read_b32 v92, v91 offset:24
    s_cmp_lt_u32 s9, 8
    s_cbranch_scc1 Lbo_50
    s_setprio 3
Lbo_50:
    v_mul_f32 v94, v46, v98
    v_mul_f32 v96, v46, v100
    v_mul_f32 v95, v46, v99
    v_mul_f32 v97, v46, v101
    v_and_b32 v106, 0xffff0000, v13
    v_and_b32 v108, 0xffff0000, v29
    v_and_b32 v107, 0xffff0000, v21
    v_and_b32 v109, 0xffff0000, v37
    v_fma_f32 v94, -v47, v100, v94
    v_fmac_f32 v96, v47, v98
    v_fma_f32 v95, -v47, v101, v95
    v_fmac_f32 v97, v47, v99
    v_add_f32 v106, v106, v94
    v_sub_f32 v108, v108, v96
    v_add_f32 v107, v107, v95
    v_sub_f32 v109, v109, v97
    v_cvt_pk_bf16_f32 v13, v102, v106
    v_cvt_pk_bf16_f32 v29, v104, v108
    v_cvt_pk_bf16_f32 v21, v103, v107
    v_cvt_pk_bf16_f32 v37, v105, v109
    s_waitcnt lgkmcnt(0)
    v_readfirstlane_b32 s9, v92
    ds_read_b32 v92, v91 offset:24
    s_cmp_lt_u32 s9, 8
    s_cbranch_scc1 Lbo_51
    s_setprio 3
Lbo_51:
    v_mul_f32 v98, v46, v94
    v_mul_f32 v100, v46, v96
    v_mul_f32 v99, v46, v95
    v_mul_f32 v101, v46, v97
    v_lshlrev_b32 v102, 16, v14
    v_lshlrev_b32 v104, 16, v30
    v_lshlrev_b32 v103, 16, v22
    v_lshlrev_b32 v105, 16, v38
    v_fma_f32 v98, -v47, v96, v98
    v_fmac_f32 v100, v47, v94
    v_fma_f32 v99, -v47, v97, v99
    v_fmac_f32 v101, v47, v95
    v_add_f32 v102, v102, v98
    v_sub_f32 v104, v104, v100
    v_add_f32 v103, v103, v99
    v_sub_f32 v105, v105, v101
    s_waitcnt lgkmcnt(0)
    v_readfirstlane_b32 s9, v92
    ds_read_b32 v92, v91 offset:24
    s_cmp_lt_u32 s9, 8
    s_cbranch_scc1 Lbo_52
    s_setprio 3
Lbo_52:
    v_mul_f32 v94, v46, v98
    v_mul_f32 v96, v46, v100
    v_mul_f32 v95, v46, v99
    v_mul_f32 v97, v46, v101
    v_and_b32 v106, 0xffff0000, v14
    v_and_b32 v108, 0xffff0000, v30
    v_and_b32 v107, 0xffff0000, v22
    v_and_b32 v109, 0xffff0000, v38
    v_fma_f32 v94, -v47, v100, v94
    v_fmac_f32 v96, v47, v98
    v_fma_f32 v95, -v47, v101, v95
    v_fmac_f32 v97, v47, v99
    v_add_f32 v106, v106, v94
    v_sub_f32 v108, v108, v96
    v_add_f32 v107, v107, v95
    v_sub_f32 v109, v109, v97
    v_cvt_pk_bf16_f32 v14, v102, v106
    v_cvt_pk_bf16_f32 v30, v104, v108
    v_cvt_pk_bf16_f32 v22, v103, v107
    v_cvt_pk_bf16_f32 v38, v105, v109
    s_waitcnt lgkmcnt(0)
    v_readfirstlane_b32 s9, v92
    ds_read_b32 v92, v91 offset:24
    s_cmp_lt_u32 s9, 8
    s_cbranch_scc1 Lbo_53
    s_setprio 3
Lbo_53:
    v_mul_f32 v98, v46, v94
    v_mul_f32 v100, v46, v96
    v_mul_f32 v99, v46, v95
    v_mul_f32 v101, v46, v97
    v_lshlrev_b32 v102, 16, v15
    v_lshlrev_b32 v104, 16, v31
    v_lshlrev_b32 v103, 16, v23
    v_lshlrev_b32 v105, 16, v39
    v_fma_f32 v98, -v47, v96, v98
    v_fmac_f32 v100, v47, v94
    v_fma_f32 v99, -v47, v97, v99
    v_fmac_f32 v101, v47, v95
    v_add_f32 v102, v102, v98
    v_sub_f32 v104, v104, v100
    v_add_f32 v103, v103, v99
    v_sub_f32 v105, v105, v101
    s_waitcnt lgkmcnt(0)
    v_readfirstlane_b32 s9, v92
    ds_read_b32 v92, v91 offset:24
    s_cmp_lt_u32 s9, 8
    s_cbranch_scc1 Lbo_54
    s_setprio 3
Lbo_54:
    v_mul_f32 v94, v46, v98
    v_mul_f32 v96, v46, v100
    v_mul_f32 v95, v46, v99
    v_mul_f32 v97, v46, v101
    v_and_b32 v106, 0xffff0000, v15
    v_and_b32 v108, 0xffff0000, v31
    v_and_b32 v107, 0xffff0000, v23
    v_and_b32 v109, 0xffff0000, v39
    v_fma_f32 v94, -v47, v100, v94
    v_fmac_f32 v96, v47, v98
    v_fma_f32 v95, -v47, v101, v95
    v_fmac_f32 v97, v47, v99
    v_add_f32 v106, v106, v94
    v_sub_f32 v108, v108, v96
    v_add_f32 v107, v107, v95
    v_sub_f32 v109, v109, v97
    v_cvt_pk_bf16_f32 v15, v102, v106
    v_cvt_pk_bf16_f32 v31, v104, v108
    v_cvt_pk_bf16_f32 v23, v103, v107
    v_cvt_pk_bf16_f32 v39, v105, v109
    ds_write_b128 v86, v[8:11] offset:0
    ds_write_b128 v88, v[12:15] offset:0
    ds_write_b128 v89, v[16:19] offset:0
    ds_write_b128 v90, v[20:23] offset:0
    ds_write_b128 v86, v[24:27] offset:4096
    ds_write_b128 v88, v[28:31] offset:4096
    ds_write_b128 v89, v[32:35] offset:4096
    ds_write_b128 v90, v[36:39] offset:4096
    s_waitcnt lgkmcnt(0)
    ds_read_b128 v[8:11], v87 offset:0
    ds_read_b128 v[12:15], v87 offset:1024
    ds_read_b128 v[16:19], v87 offset:2048
    ds_read_b128 v[20:23], v87 offset:3072
    ds_read_b128 v[24:27], v87 offset:4096
    ds_read_b128 v[28:31], v87 offset:5120
    ds_read_b128 v[32:35], v87 offset:6144
    ds_read_b128 v[36:39], v87 offset:7168
    s_waitcnt lgkmcnt(7)
    buffer_store_dwordx4 v[8:11], v6, s[60:63], s6 offen sc0 sc1
    s_add_u32 s6, s6, 2048
    s_waitcnt lgkmcnt(6)
    buffer_store_dwordx4 v[12:15], v6, s[60:63], s6 offen sc0 sc1
    s_add_u32 s6, s6, 2048
    s_waitcnt lgkmcnt(5)
    buffer_store_dwordx4 v[16:19], v6, s[60:63], s6 offen sc0 sc1
    s_add_u32 s6, s6, 2048
    s_waitcnt lgkmcnt(4)
    buffer_store_dwordx4 v[20:23], v6, s[60:63], s6 offen sc0 sc1
    s_waitcnt lgkmcnt(3)
    buffer_store_dwordx4 v[24:27], v6, s[60:63], s7 offen sc0 sc1
    s_add_u32 s7, s7, 2048
    s_waitcnt lgkmcnt(2)
    buffer_store_dwordx4 v[28:31], v6, s[60:63], s7 offen sc0 sc1
    s_add_u32 s7, s7, 2048
    s_waitcnt lgkmcnt(1)
    buffer_store_dwordx4 v[32:35], v6, s[60:63], s7 offen sc0 sc1
    s_add_u32 s7, s7, 2048
    s_waitcnt lgkmcnt(0)
    buffer_store_dwordx4 v[36:39], v6, s[60:63], s7 offen sc0 sc1
    s_endpgm
L_att_pf:
    s_sub_u32 s7, s7, 18
    s_lshl_b32 s7, s7, 2
    s_add_u32 s7, s7, s5
    s_sub_u32 s7, s7, 8
    s_mul_i32 s7, s7, 12288
    v_lshlrev_b32 v2, 4, v1
    s_sleep 60
    s_mov_b32 s52, s26
    s_mov_b32 s53, s27
    s_mov_b32 s54, 0xa2000
    s_mov_b32 s55, 0x00020000
    s_mov_b32 s8, s7
    buffer_load_dwordx4 v[4:7], v2, s[52:55], s8 offen offset:0
    buffer_load_dwordx4 v[8:11], v2, s[52:55], s8 offen offset:1024
    buffer_load_dwordx4 v[12:15], v2, s[52:55], s8 offen offset:2048
    buffer_load_dwordx4 v[16:19], v2, s[52:55], s8 offen offset:3072
    s_add_u32 s8, s8, 4096
    buffer_load_dwordx4 v[20:23], v2, s[52:55], s8 offen offset:0
    buffer_load_dwordx4 v[24:27], v2, s[52:55], s8 offen offset:1024
    buffer_load_dwordx4 v[28:31], v2, s[52:55], s8 offen offset:2048
    buffer_load_dwordx4 v[32:35], v2, s[52:55], s8 offen offset:3072
    s_add_u32 s8, s8, 4096
    buffer_load_dwordx4 v[36:39], v2, s[52:55], s8 offen offset:0
    buffer_load_dwordx4 v[40:43], v2, s[52:55], s8 offen offset:1024
    buffer_load_dwordx4 v[44:47], v2, s[52:55], s8 offen offset:2048
    buffer_load_dwordx4 v[48:51], v2, s[52:55], s8 offen offset:3072
    s_add_u32 s8, s8, 4096
    s_waitcnt vmcnt(0)
    s_sleep 20
    s_mov_b32 s52, s28
    s_mov_b32 s53, s29
    s_mov_b32 s54, 0xa2000
    s_mov_b32 s55, 0x00020000
    s_mov_b32 s8, s7
    buffer_load_dwordx4 v[4:7], v2, s[52:55], s8 offen offset:0
    buffer_load_dwordx4 v[8:11], v2, s[52:55], s8 offen offset:1024
    buffer_load_dwordx4 v[12:15], v2, s[52:55], s8 offen offset:2048
    buffer_load_dwordx4 v[16:19], v2, s[52:55], s8 offen offset:3072
    s_add_u32 s8, s8, 4096
    buffer_load_dwordx4 v[20:23], v2, s[52:55], s8 offen offset:0
    buffer_load_dwordx4 v[24:27], v2, s[52:55], s8 offen offset:1024
    buffer_load_dwordx4 v[28:31], v2, s[52:55], s8 offen offset:2048
    buffer_load_dwordx4 v[32:35], v2, s[52:55], s8 offen offset:3072
    s_add_u32 s8, s8, 4096
    buffer_load_dwordx4 v[36:39], v2, s[52:55], s8 offen offset:0
    buffer_load_dwordx4 v[40:43], v2, s[52:55], s8 offen offset:1024
    buffer_load_dwordx4 v[44:47], v2, s[52:55], s8 offen offset:2048
    buffer_load_dwordx4 v[48:51], v2, s[52:55], s8 offen offset:3072
    s_add_u32 s8, s8, 4096
    s_waitcnt vmcnt(0)
    s_sleep 20
    s_mov_b32 s52, s42
    s_mov_b32 s53, s43
    s_mov_b32 s54, 0xa2000
    s_mov_b32 s55, 0x00020000
    s_mov_b32 s8, s7
    buffer_load_dwordx4 v[4:7], v2, s[52:55], s8 offen offset:0
    buffer_load_dwordx4 v[8:11], v2, s[52:55], s8 offen offset:1024
    buffer_load_dwordx4 v[12:15], v2, s[52:55], s8 offen offset:2048
    buffer_load_dwordx4 v[16:19], v2, s[52:55], s8 offen offset:3072
    s_add_u32 s8, s8, 4096
    buffer_load_dwordx4 v[20:23], v2, s[52:55], s8 offen offset:0
    buffer_load_dwordx4 v[24:27], v2, s[52:55], s8 offen offset:1024
    buffer_load_dwordx4 v[28:31], v2, s[52:55], s8 offen offset:2048
    buffer_load_dwordx4 v[32:35], v2, s[52:55], s8 offen offset:3072
    s_add_u32 s8, s8, 4096
    buffer_load_dwordx4 v[36:39], v2, s[52:55], s8 offen offset:0
    buffer_load_dwordx4 v[40:43], v2, s[52:55], s8 offen offset:1024
    buffer_load_dwordx4 v[44:47], v2, s[52:55], s8 offen offset:2048
    buffer_load_dwordx4 v[48:51], v2, s[52:55], s8 offen offset:3072
    s_add_u32 s8, s8, 4096
    s_waitcnt vmcnt(0)
    s_sleep 20
    s_mov_b32 s52, s16
    s_mov_b32 s53, s17
    s_mov_b32 s54, 0x240000
    s_mov_b32 s55, 0x00020000
    s_mul_i32 s8, s7, 7
    s_lshr_b32 s8, s8, 4
    s_mul_i32 s9, s6, 294912
    s_add_u32 s8, s8, s9
    buffer_load_dwordx4 v[4:7], v2, s[52:55], s8 offen offset:0
    buffer_load_dwordx4 v[8:11], v2, s[52:55], s8 offen offset:1024
    buffer_load_dwordx4 v[12:15], v2, s[52:55], s8 offen offset:2048
    buffer_load_dwordx4 v[16:19], v2, s[52:55], s8 offen offset:3072
    s_add_u32 s8, s8, 4096
    buffer_load_dwordx4 v[20:23], v2, s[52:55], s8 offen offset:0
    buffer_load_dwordx4 v[24:27], v2, s[52:55], s8 offen offset:1024
    s_waitcnt vmcnt(0)
    s_lshr_b32 s7, s2, 3
    s_sub_u32 s7, s7, 18
    v_subrev_u32 v3, 512, v0
    s_getpc_b64 s[12:13]
Lpc_55:
    s_add_u32 s12, s12, k3_kernel-Lpc_55
    s_addc_u32 s13, s13, 0
    s_mul_i32 s14, s7, 1024
    v_lshlrev_b32 v2, 2, v3
    v_add_u32 v2, s14, v2
    v_min_u32 v2, L_code_end-k3_kernel-4, v2
    global_load_dword v4, v2, s[12:13]
    s_waitcnt vmcnt(0)
    s_endpgm
.globl k3_kernel
.p2align 8
.type k3_kernel,@function
k3_kernel:
    s_cmp_ge_u32 s2, 256
    s_cbranch_scc1 L_k3_end
    s_load_dwordx16 s[16:31], s[0:1], 0
    s_load_dwordx16 s[32:47], s[0:1], 64
    s_load_dwordx2 s[48:49], s[0:1], 128
    v_and_b32 v1, 63, v0
    v_lshrrev_b32 v2, 6, v0
    s_and_b32 s6, s2, 7
    v_readfirstlane_b32 s5, v2
    s_lshr_b32 s7, s2, 3
    s_and_b32 s8, s7, 1
    s_lshl_b32 s3, s6, 1
    s_add_u32 s3, s3, s8
    s_lshr_b32 s4, s7, 1
    s_and_b32 s51, s3, 1
    s_lshl_b32 s51, s51, 2
    s_add_u32 s51, s51, s4
    s_sub_u32 s9, s51, 9
    s_min_u32 s51, s51, s9
    s_sub_u32 s9, s51, 9
    s_min_u32 s51, s51, s9
    s_lshl_b32 s51, s51, 7
    s_cmp_lt_u32 s4, 9
    s_cbranch_scc1 L_k3_y
    s_sub_u32 s4, s4, 9
    s_cmp_ge_u32 s4, 6
    s_cbranch_scc1 L_k3_end
    s_lshl_b32 s6, s3, 7
    s_lshl_b32 s7, s5, 5
    s_add_u32 s6, s6, s7
    v_lshrrev_b32 v3, 4, v1
    v_and_b32 v2, 7, v1
    v_xor_b32 v2, v2, v3
    v_lshlrev_b32 v2, 4, v2
    v_lshrrev_b32 v5, 4, v1
    v_xor_b32 v5, 4, v5
    v_and_b32 v4, 7, v1
    v_xor_b32 v4, v4, v5
    v_lshlrev_b32 v4, 4, v4
    v_lshrrev_b32 v6, 3, v1
    v_add_u32 v6, s6, v6
    v_mul_u32_u24 v6, 1152, v6
    v_add_u32 v7, v6, v2
    v_add_u32 v8, v6, v4
    v_add_u32 v8, 8192, v8
    v_add_u32 v9, v6, v2
    v_add_u32 v9, 16384, v9
    v_add_u32 v10, v6, v4
    v_add_u32 v10, 24576, v10
    s_mul_i32 s7, s4, 192
    s_mul_i32 s8, s5, 192
    v_add_u32 v11, s8, v1
    v_mul_u32_u24 v12, 43691, v11
    v_lshrrev_b32 v12, 19, v12
    v_mul_u32_u24 v13, 12, v12
    v_sub_u32 v13, v11, v13
    v_mul_u32_u24 v14, 1152, v12
    v_lshl_add_u32 v14, v13, 4, v14
    v_add_u32 v14, s7, v14
    v_add_u32 v11, s8, v1
    v_add_u32 v11, 64, v11
    v_mul_u32_u24 v12, 43691, v11
    v_lshrrev_b32 v12, 19, v12
    v_mul_u32_u24 v13, 12, v12
    v_sub_u32 v13, v11, v13
    v_mul_u32_u24 v15, 1152, v12
    v_lshl_add_u32 v15, v13, 4, v15
    v_add_u32 v15, s7, v15
    v_subrev_u32 v15, 1024, v15
    v_add_u32 v11, s8, v1
    v_add_u32 v11, 128, v11
    v_mul_u32_u24 v12, 43691, v11
    v_lshrrev_b32 v12, 19, v12
    v_mul_u32_u24 v13, 12, v12
    v_sub_u32 v13, v11, v13
    v_mul_u32_u24 v16, 1152, v12
    v_lshl_add_u32 v16, v13, 4, v16
    v_add_u32 v16, s7, v16
    v_subrev_u32 v16, 2048, v16
    s_lshl_b32 s10, s5, 12
    s_mul_i32 s11, s5, 3072
    s_add_u32 s11, s11, 16384
    s_waitcnt lgkmcnt(0)
    s_add_u32 s52, s48, 0x800000
    s_addc_u32 s53, s49, 0
    s_mov_b32 s54, 0x240000
    s_mov_b32 s55, 0x00020000
    s_mov_b32 s56, s42
    s_mov_b32 s57, s43
    s_mov_b32 s58, 0xa2000
    s_mov_b32 s59, 0x00020000
    s_mov_b32 s60, s44
    s_mov_b32 s61, s45
    s_mov_b32 s62, 0x900000
    s_mov_b32 s63, 0x00020000
    s_add_u32 m0, s10, 0
    s_add_u32 s51, s51, 128
    s_sub_u32 s9, s51, 1152
    s_min_u32 s51, s51, s9
    buffer_load_dwordx4 v7, s[52:55], s51 offen lds
    buffer_load_dwordx4 v8, s[52:55], s51 offen offset:1024 lds
    buffer_load_dwordx4 v9, s[52:55], s51 offen offset:2048 lds
    buffer_load_dwordx4 v10, s[52:55], s51 offen offset:3072 lds
    s_add_u32 m0, s11, 0
    s_mul_i32 s9, s51, 576
    buffer_load_dwordx4 v14, s[56:59], s9 offen lds
    buffer_load_dwordx4 v15, s[56:59], s9 offen offset:1024 lds
    buffer_load_dwordx4 v16, s[56:59], s9 offen offset:2048 lds
    s_add_u32 m0, s10, 28672
    s_add_u32 s51, s51, 128
    s_sub_u32 s9, s51, 1152
    s_min_u32 s51, s51, s9
    buffer_load_dwordx4 v7, s[52:55], s51 offen lds
    buffer_load_dwordx4 v8, s[52:55], s51 offen offset:1024 lds
    buffer_load_dwordx4 v9, s[52:55], s51 offen offset:2048 lds
    buffer_load_dwordx4 v10, s[52:55], s51 offen offset:3072 lds
    s_add_u32 m0, s11, 28672
    s_mul_i32 s9, s51, 576
    buffer_load_dwordx4 v14, s[56:59], s9 offen lds
    buffer_load_dwordx4 v15, s[56:59], s9 offen offset:1024 lds
    buffer_load_dwordx4 v16, s[56:59], s9 offen offset:2048 lds
    v_and_b32 v17, 31, v1
    v_bfe_u32 v18, v1, 1, 3
    v_lshrrev_b32 v19, 5, v1
    v_xor_b32 v18, v18, v19
    v_lshlrev_b32 v18, 4, v18
    v_lshl_add_u32 v19, v17, 7, v18
    v_add_u32 v19, s10, v19
    v_add_u32 v20, 0x10000, v19
    v_add_u32 v21, 0x20000, v19
    v_xor_b32 v22, 32, v19
    v_add_u32 v23, 0x10000, v22
    v_add_u32 v24, 0x20000, v22
    v_xor_b32 v25, 64, v19
    v_add_u32 v26, 0x10000, v25
    v_add_u32 v27, 0x20000, v25
    v_xor_b32 v28, 96, v19
    v_add_u32 v29, 0x10000, v28
    v_add_u32 v30, 0x20000, v28
    v_bfe_u32 v31, v1, 2, 2
    v_lshrrev_b32 v33, 5, v1
    v_lshl_add_u32 v33, v33, 3, v31
    v_mul_u32_u24 v34, 192, v33
    v_and_b32 v32, 1, v1
    v_lshl_add_u32 v34, v32, 5, v34
    v_bfe_u32 v32, v1, 4, 1
    v_lshl_add_u32 v34, v32, 4, v34
    v_bfe_u32 v32, v1, 1, 1
    v_lshl_add_u32 v34, v32, 3, v34
    v_add_u32 v35, 0x10000, v34
    v_add_u32 v36, 0x20000, v34
    s_lshl_b32 s7, s7, 1
    s_add_u32 s7, s7, 2304
    s_mul_i32 s8, s5, 12288
    s_waitcnt vmcnt(7)
    s_barrier
    ds_read_b128 v[40:43], v19 offset:0
    ds_read_b64_tr_b16 v[44:45], v34 offset:16384
    ds_read_b64_tr_b16 v[46:47], v34 offset:17152
    ds_read_b64_tr_b16 v[48:49], v34 offset:16448
    ds_read_b64_tr_b16 v[50:51], v34 offset:17216
    ds_read_b64_tr_b16 v[52:53], v34 offset:16512
    ds_read_b64_tr_b16 v[54:55], v34 offset:17280
    ds_read_b128 v[56:59], v22 offset:0
    ds_read_b64_tr_b16 v[60:61], v34 offset:19456
    ds_read_b64_tr_b16 v[62:63], v34 offset:20224
    ds_read_b64_tr_b16 v[64:65], v34 offset:19520
    ds_read_b64_tr_b16 v[66:67], v34 offset:20288
    ds_read_b64_tr_b16 v[68:69], v34 offset:19584
    ds_read_b64_tr_b16 v[70:71], v34 offset:20352
    ds_read_b128 v[72:75], v25 offset:0
    ds_read_b64_tr_b16 v[76:77], v34 offset:22528
    ds_read_b64_tr_b16 v[78:79], v34 offset:23296
    ds_read_b64_tr_b16 v[80:81], v34 offset:22592
    ds_read_b64_tr_b16 v[82:83], v34 offset:23360
    ds_read_b64_tr_b16 v[84:85], v34 offset:22656
    ds_read_b64_tr_b16 v[86:87], v34 offset:23424
    s_waitcnt lgkmcnt(14)
    v_mfma_f32_32x32x16_bf16 v[88:103], v[44:47], v[40:43], 0
    s_add_u32 m0, s10, 57344
    s_add_u32 s51, s51, 128
    s_sub_u32 s9, s51, 1152
    s_min_u32 s51, s51, s9
    buffer_load_dwordx4 v7, s[52:55], s51 offen lds
    v_mfma_f32_32x32x16_bf16 v[104:119], v[48:51], v[40:43], 0
    buffer_load_dwordx4 v8, s[52:55], s51 offen offset:1024 lds
    v_mfma_f32_32x32x16_bf16 v[120:135], v[52:55], v[40:43], 0
    buffer_load_dwordx4 v9, s[52:55], s51 offen offset:2048 lds
    ds_read_b128 v[40:43], v28 offset:0
    ds_read_b64_tr_b16 v[44:45], v34 offset:25600
    ds_read_b64_tr_b16 v[46:47], v34 offset:26368
    ds_read_b64_tr_b16 v[48:49], v34 offset:25664
    ds_read_b64_tr_b16 v[50:51], v34 offset:26432
    ds_read_b64_tr_b16 v[52:53], v34 offset:25728
    ds_read_b64_tr_b16 v[54:55], v34 offset:26496
    s_waitcnt lgkmcnt(14)
    v_mfma_f32_32x32x16_bf16 v[88:103], v[60:63], v[56:59], v[88:103]
    buffer_load_dwordx4 v10, s[52:55], s51 offen offset:3072 lds
    v_mfma_f32_32x32x16_bf16 v[104:119], v[64:67], v[56:59], v[104:119]
    s_add_u32 m0, s11, 57344
    s_mul_i32 s9, s51, 576
    buffer_load_dwordx4 v14, s[56:59], s9 offen lds
    v_mfma_f32_32x32x16_bf16 v[120:135], v[68:71], v[56:59], v[120:135]
    buffer_load_dwordx4 v15, s[56:59], s9 offen offset:1024 lds
    s_waitcnt vmcnt(6) lgkmcnt(0)
    s_barrier
    ds_read_b128 v[56:59], v19 offset:28672
    ds_read_b64_tr_b16 v[60:61], v34 offset:45056
    ds_read_b64_tr_b16 v[62:63], v34 offset:45824
    ds_read_b64_tr_b16 v[64:65], v34 offset:45120
    ds_read_b64_tr_b16 v[66:67], v34 offset:45888
    ds_read_b64_tr_b16 v[68:69], v34 offset:45184
    ds_read_b64_tr_b16 v[70:71], v34 offset:45952
    v_mfma_f32_32x32x16_bf16 v[88:103], v[76:79], v[72:75], v[88:103]
    buffer_load_dwordx4 v16, s[56:59], s9 offen offset:2048 lds
    v_mfma_f32_32x32x16_bf16 v[104:119], v[80:83], v[72:75], v[104:119]
    s_add_u32 m0, s10, 86016
    s_add_u32 s51, s51, 128
    s_sub_u32 s9, s51, 1152
    s_min_u32 s51, s51, s9
    buffer_load_dwordx4 v7, s[52:55], s51 offen lds
    v_mfma_f32_32x32x16_bf16 v[120:135], v[84:87], v[72:75], v[120:135]
    buffer_load_dwordx4 v8, s[52:55], s51 offen offset:1024 lds
    ds_read_b128 v[72:75], v22 offset:28672
    ds_read_b64_tr_b16 v[76:77], v34 offset:48128
    ds_read_b64_tr_b16 v[78:79], v34 offset:48896
    ds_read_b64_tr_b16 v[80:81], v34 offset:48192
    ds_read_b64_tr_b16 v[82:83], v34 offset:48960
    ds_read_b64_tr_b16 v[84:85], v34 offset:48256
    ds_read_b64_tr_b16 v[86:87], v34 offset:49024
    v_mfma_f32_32x32x16_bf16 v[88:103], v[44:47], v[40:43], v[88:103]
    buffer_load_dwordx4 v9, s[52:55], s51 offen offset:2048 lds
    v_mfma_f32_32x32x16_bf16 v[104:119], v[48:51], v[40:43], v[104:119]
    buffer_load_dwordx4 v10, s[52:55], s51 offen offset:3072 lds
    v_mfma_f32_32x32x16_bf16 v[120:135], v[52:55], v[40:43], v[120:135]
    s_add_u32 m0, s11, 86016
    s_mul_i32 s9, s51, 576
    buffer_load_dwordx4 v14, s[56:59], s9 offen lds
    ds_read_b128 v[40:43], v25 offset:28672
    ds_read_b64_tr_b16 v[44:45], v34 offset:51200
    ds_read_b64_tr_b16 v[46:47], v34 offset:51968
    ds_read_b64_tr_b16 v[48:49], v34 offset:51264
    ds_read_b64_tr_b16 v[50:51], v34 offset:52032
    ds_read_b64_tr_b16 v[52:53], v34 offset:51328
    ds_read_b64_tr_b16 v[54:55], v34 offset:52096
    s_waitcnt lgkmcnt(14)
    v_mfma_f32_32x32x16_bf16 v[88:103], v[60:63], v[56:59], v[88:103]
    buffer_load_dwordx4 v15, s[56:59], s9 offen offset:1024 lds
    v_and_b32 v136, 7, v1
    v_mfma_f32_32x32x16_bf16 v[104:119], v[64:67], v[56:59], v[104:119]
    buffer_load_dwordx4 v16, s[56:59], s9 offen offset:2048 lds
    v_lshrrev_b32 v137, 5, v1
    v_mfma_f32_32x32x16_bf16 v[120:135], v[68:71], v[56:59], v[120:135]
    s_add_u32 m0, s10, 114688
    s_add_u32 s51, s51, 128
    s_sub_u32 s9, s51, 1152
    s_min_u32 s51, s51, s9
    buffer_load_dwordx4 v7, s[52:55], s51 offen lds
    v_lshlrev_b32 v137, 2, v137
    ds_read_b128 v[56:59], v28 offset:28672
    ds_read_b64_tr_b16 v[60:61], v34 offset:54272
    ds_read_b64_tr_b16 v[62:63], v34 offset:55040
    ds_read_b64_tr_b16 v[64:65], v34 offset:54336
    ds_read_b64_tr_b16 v[66:67], v34 offset:55104
    ds_read_b64_tr_b16 v[68:69], v34 offset:54400
    ds_read_b64_tr_b16 v[70:71], v34 offset:55168
    s_waitcnt lgkmcnt(14)
    v_mfma_f32_32x32x16_bf16 v[88:103], v[76:79], v[72:75], v[88:103]
    buffer_load_dwordx4 v8, s[52:55], s51 offen offset:1024 lds
    v_xor_b32 v137, v137, v136
    v_mfma_f32_32x32x16_bf16 v[104:119], v[80:83], v[72:75], v[104:119]
    buffer_load_dwordx4 v9, s[52:55], s51 offen offset:2048 lds
    v_lshlrev_b32 v137, 4, v137
    v_mfma_f32_32x32x16_bf16 v[120:135], v[84:87], v[72:75], v[120:135]
    buffer_load_dwordx4 v10, s[52:55], s51 offen offset:3072 lds
    v_and_b32 v140, 31, v1
    s_waitcnt vmcnt(11) lgkmcnt(0)
    s_barrier
    ds_read_b128 v[72:75], v19 offset:57344
    ds_read_b64_tr_b16 v[76:77], v35 offset:8192
    ds_read_b64_tr_b16 v[78:79], v35 offset:8960
    ds_read_b64_tr_b16 v[80:81], v35 offset:8256
    ds_read_b64_tr_b16 v[82:83], v35 offset:9024
    ds_read_b64_tr_b16 v[84:85], v35 offset:8320
    ds_read_b64_tr_b16 v[86:87], v35 offset:9088
    v_mfma_f32_32x32x16_bf16 v[88:103], v[44:47], v[40:43], v[88:103]
    s_add_u32 m0, s11, 114688
    s_mul_i32 s9, s51, 576
    buffer_load_dwordx4 v14, s[56:59], s9 offen lds
    v_lshl_add_u32 v137, v140, 7, v137
    v_mfma_f32_32x32x16_bf16 v[104:119], v[48:51], v[40:43], v[104:119]
    buffer_load_dwordx4 v15, s[56:59], s9 offen offset:1024 lds
    v_add_u32 v137, s8, v137
    v_mfma_f32_32x32x16_bf16 v[120:135], v[52:55], v[40:43], v[120:135]
    buffer_load_dwordx4 v16, s[56:59], s9 offen offset:2048 lds
    v_lshrrev_b32 v140, 3, v1
    ds_read_b128 v[40:43], v22 offset:57344
    ds_read_b64_tr_b16 v[44:45], v35 offset:11264
    ds_read_b64_tr_b16 v[46:47], v35 offset:12032
    ds_read_b64_tr_b16 v[48:49], v35 offset:11328
    ds_read_b64_tr_b16 v[50:51], v35 offset:12096
    ds_read_b64_tr_b16 v[52:53], v35 offset:11392
    ds_read_b64_tr_b16 v[54:55], v35 offset:12160
    v_mfma_f32_32x32x16_bf16 v[88:103], v[60:63], v[56:59], v[88:103]
    s_add_u32 m0, s10, 0
    s_add_u32 s51, s51, 128
    s_sub_u32 s9, s51, 1152
    s_min_u32 s51, s51, s9
    buffer_load_dwordx4 v7, s[52:55], s51 offen lds
    v_xor_b32 v138, v140, v136
    v_mfma_f32_32x32x16_bf16 v[104:119], v[64:67], v[56:59], v[104:119]
    buffer_load_dwordx4 v8, s[52:55], s51 offen offset:1024 lds
    v_lshlrev_b32 v138, 4, v138
    v_mfma_f32_32x32x16_bf16 v[120:135], v[68:71], v[56:59], v[120:135]
    buffer_load_dwordx4 v9, s[52:55], s51 offen offset:2048 lds
    v_lshl_add_u32 v138, v140, 7, v138
    ds_read_b128 v[56:59], v25 offset:57344
    ds_read_b64_tr_b16 v[60:61], v35 offset:14336
    ds_read_b64_tr_b16 v[62:63], v35 offset:15104
    ds_read_b64_tr_b16 v[64:65], v35 offset:14400
    ds_read_b64_tr_b16 v[66:67], v35 offset:15168
    ds_read_b64_tr_b16 v[68:69], v35 offset:14464
    ds_read_b64_tr_b16 v[70:71], v35 offset:15232
    s_waitcnt lgkmcnt(14)
    v_mfma_f32_32x32x16_bf16 v[88:103], v[76:79], v[72:75], v[88:103]
    buffer_load_dwordx4 v10, s[52:55], s51 offen offset:3072 lds
    v_add_u32 v138, s8, v138
    v_mfma_f32_32x32x16_bf16 v[104:119], v[80:83], v[72:75], v[104:119]
    s_add_u32 m0, s11, 0
    s_mul_i32 s9, s51, 576
    buffer_load_dwordx4 v14, s[56:59], s9 offen lds
    v_add_u32 v139, s6, v140
    v_mfma_f32_32x32x16_bf16 v[120:135], v[84:87], v[72:75], v[120:135]
    buffer_load_dwordx4 v15, s[56:59], s9 offen offset:1024 lds
    v_mul_u32_u24 v139, 4608, v139
    ds_read_b128 v[72:75], v28 offset:57344
    ds_read_b64_tr_b16 v[76:77], v35 offset:17408
    ds_read_b64_tr_b16 v[78:79], v35 offset:18176
    ds_read_b64_tr_b16 v[80:81], v35 offset:17472
    ds_read_b64_tr_b16 v[82:83], v35 offset:18240
    ds_read_b64_tr_b16 v[84:85], v35 offset:17536
    ds_read_b64_tr_b16 v[86:87], v35 offset:18304
    s_waitcnt lgkmcnt(14)
    v_mfma_f32_32x32x16_bf16 v[88:103], v[44:47], v[40:43], v[88:103]
    buffer_load_dwordx4 v16, s[56:59], s9 offen offset:2048 lds
    v_lshl_add_u32 v139, v136, 4, v139
    v_mfma_f32_32x32x16_bf16 v[104:119], v[48:51], v[40:43], v[104:119]
    s_add_u32 m0, s10, 28672
    s_add_u32 s51, s51, 128
    s_sub_u32 s9, s51, 1152
    s_min_u32 s51, s51, s9
    buffer_load_dwordx4 v7, s[52:55], s51 offen lds
    v_add_u32 v139, s7, v139
    v_mfma_f32_32x32x16_bf16 v[120:135], v[52:55], v[40:43], v[120:135]
    buffer_load_dwordx4 v8, s[52:55], s51 offen offset:1024 lds
    v_xor_b32 v141, 16, v137
    s_waitcnt vmcnt(16) lgkmcnt(0)
    s_barrier
    ds_read_b128 v[40:43], v20 offset:20480
    ds_read_b64_tr_b16 v[44:45], v35 offset:36864
    ds_read_b64_tr_b16 v[46:47], v35 offset:37632
    ds_read_b64_tr_b16 v[48:49], v35 offset:36928
    ds_read_b64_tr_b16 v[50:51], v35 offset:37696
    ds_read_b64_tr_b16 v[52:53], v35 offset:36992
    ds_read_b64_tr_b16 v[54:55], v35 offset:37760
    v_mfma_f32_32x32x16_bf16 v[88:103], v[60:63], v[56:59], v[88:103]
    buffer_load_dwordx4 v9, s[52:55], s51 offen offset:2048 lds
    v_xor_b32 v142, 32, v137
    v_mfma_f32_32x32x16_bf16 v[104:119], v[64:67], v[56:59], v[104:119]
    buffer_load_dwordx4 v10, s[52:55], s51 offen offset:3072 lds
    v_xor_b32 v143, 48, v137
    v_mfma_f32_32x32x16_bf16 v[120:135], v[68:71], v[56:59], v[120:135]
    s_add_u32 m0, s11, 28672
    s_mul_i32 s9, s51, 576
    buffer_load_dwordx4 v14, s[56:59], s9 offen lds
    ds_read_b128 v[56:59], v23 offset:20480
    ds_read_b64_tr_b16 v[60:61], v35 offset:39936
    ds_read_b64_tr_b16 v[62:63], v35 offset:40704
    ds_read_b64_tr_b16 v[64:65], v35 offset:40000
    ds_read_b64_tr_b16 v[66:67], v35 offset:40768
    ds_read_b64_tr_b16 v[68:69], v35 offset:40064
    ds_read_b64_tr_b16 v[70:71], v35 offset:40832
    v_mfma_f32_32x32x16_bf16 v[88:103], v[76:79], v[72:75], v[88:103]
    buffer_load_dwordx4 v15, s[56:59], s9 offen offset:1024 lds
    v_mfma_f32_32x32x16_bf16 v[104:119], v[80:83], v[72:75], v[104:119]
    buffer_load_dwordx4 v16, s[56:59], s9 offen offset:2048 lds
    v_mfma_f32_32x32x16_bf16 v[120:135], v[84:87], v[72:75], v[120:135]
    s_add_u32 m0, s10, 57344
    s_add_u32 s51, s51, 128
    s_sub_u32 s9, s51, 1152
    s_min_u32 s51, s51, s9
    buffer_load_dwordx4 v7, s[52:55], s51 offen lds
    ds_read_b128 v[72:75], v26 offset:20480
    ds_read_b64_tr_b16 v[76:77], v35 offset:43008
    ds_read_b64_tr_b16 v[78:79], v35 offset:43776
    ds_read_b64_tr_b16 v[80:81], v35 offset:43072
    ds_read_b64_tr_b16 v[82:83], v35 offset:43840
    ds_read_b64_tr_b16 v[84:85], v35 offset:43136
    ds_read_b64_tr_b16 v[86:87], v35 offset:43904
    s_waitcnt lgkmcnt(14)
    v_mfma_f32_32x32x16_bf16 v[88:103], v[44:47], v[40:43], v[88:103]
    buffer_load_dwordx4 v8, s[52:55], s51 offen offset:1024 lds
    v_mfma_f32_32x32x16_bf16 v[104:119], v[48:51], v[40:43], v[104:119]
    buffer_load_dwordx4 v9, s[52:55], s51 offen offset:2048 lds
    v_mfma_f32_32x32x16_bf16 v[120:135], v[52:55], v[40:43], v[120:135]
    buffer_load_dwordx4 v10, s[52:55], s51 offen offset:3072 lds
    ds_read_b128 v[40:43], v29 offset:20480
    ds_read_b64_tr_b16 v[44:45], v35 offset:46080
    ds_read_b64_tr_b16 v[46:47], v35 offset:46848
    ds_read_b64_tr_b16 v[48:49], v35 offset:46144
    ds_read_b64_tr_b16 v[50:51], v35 offset:46912
    ds_read_b64_tr_b16 v[52:53], v35 offset:46208
    ds_read_b64_tr_b16 v[54:55], v35 offset:46976
    s_waitcnt lgkmcnt(14)
    v_mfma_f32_32x32x16_bf16 v[88:103], v[60:63], v[56:59], v[88:103]
    s_add_u32 m0, s11, 57344
    s_mul_i32 s9, s51, 576
    buffer_load_dwordx4 v14, s[56:59], s9 offen lds
    v_mfma_f32_32x32x16_bf16 v[104:119], v[64:67], v[56:59], v[104:119]
    buffer_load_dwordx4 v15, s[56:59], s9 offen offset:1024 lds
    v_mfma_f32_32x32x16_bf16 v[120:135], v[68:71], v[56:59], v[120:135]
    buffer_load_dwordx4 v16, s[56:59], s9 offen offset:2048 lds
    s_waitcnt vmcnt(21) lgkmcnt(0)
    s_barrier
    ds_read_b128 v[56:59], v20 offset:49152
    ds_read_b64_tr_b16 v[60:61], v36 offset:0
    ds_read_b64_tr_b16 v[62:63], v36 offset:768
    ds_read_b64_tr_b16 v[64:65], v36 offset:64
    ds_read_b64_tr_b16 v[66:67], v36 offset:832
    ds_read_b64_tr_b16 v[68:69], v36 offset:128
    ds_read_b64_tr_b16 v[70:71], v36 offset:896
    v_mfma_f32_32x32x16_bf16 v[88:103], v[76:79], v[72:75], v[88:103]
    s_add_u32 m0, s10, 86016
    s_add_u32 s51, s51, 128
    s_sub_u32 s9, s51, 1152
    s_min_u32 s51, s51, s9
    buffer_load_dwordx4 v7, s[52:55], s51 offen lds
    v_mfma_f32_32x32x16_bf16 v[104:119], v[80:83], v[72:75], v[104:119]
    buffer_load_dwordx4 v8, s[52:55], s51 offen offset:1024 lds
    v_mfma_f32_32x32x16_bf16 v[120:135], v[84:87], v[72:75], v[120:135]
    buffer_load_dwordx4 v9, s[52:55], s51 offen offset:2048 lds
    ds_read_b128 v[72:75], v23 offset:49152
    ds_read_b64_tr_b16 v[76:77], v36 offset:3072
    ds_read_b64_tr_b16 v[78:79], v36 offset:3840
    ds_read_b64_tr_b16 v[80:81], v36 offset:3136
    ds_read_b64_tr_b16 v[82:83], v36 offset:3904
    ds_read_b64_tr_b16 v[84:85], v36 offset:3200
    ds_read_b64_tr_b16 v[86:87], v36 offset:3968
    v_mfma_f32_32x32x16_bf16 v[88:103], v[44:47], v[40:43], v[88:103]
    buffer_load_dwordx4 v10, s[52:55], s51 offen offset:3072 lds
    v_mfma_f32_32x32x16_bf16 v[104:119], v[48:51], v[40:43], v[104:119]
    s_add_u32 m0, s11, 86016
    s_mul_i32 s9, s51, 576
    buffer_load_dwordx4 v14, s[56:59], s9 offen lds
    v_mfma_f32_32x32x16_bf16 v[120:135], v[52:55], v[40:43], v[120:135]
    buffer_load_dwordx4 v15, s[56:59], s9 offen offset:1024 lds
    ds_read_b128 v[40:43], v26 offset:49152
    ds_read_b64_tr_b16 v[44:45], v36 offset:6144
    ds_read_b64_tr_b16 v[46:47], v36 offset:6912
    ds_read_b64_tr_b16 v[48:49], v36 offset:6208
    ds_read_b64_tr_b16 v[50:51], v36 offset:6976
    ds_read_b64_tr_b16 v[52:53], v36 offset:6272
    ds_read_b64_tr_b16 v[54:55], v36 offset:7040
    s_waitcnt lgkmcnt(14)
    v_mfma_f32_32x32x16_bf16 v[88:103], v[60:63], v[56:59], v[88:103]
    buffer_load_dwordx4 v16, s[56:59], s9 offen offset:2048 lds
    v_mfma_f32_32x32x16_bf16 v[104:119], v[64:67], v[56:59], v[104:119]
    v_mfma_f32_32x32x16_bf16 v[120:135], v[68:71], v[56:59], v[120:135]
    ds_read_b128 v[56:59], v29 offset:49152
    ds_read_b64_tr_b16 v[60:61], v36 offset:9216
    ds_read_b64_tr_b16 v[62:63], v36 offset:9984
    ds_read_b64_tr_b16 v[64:65], v36 offset:9280
    ds_read_b64_tr_b16 v[66:67], v36 offset:10048
    ds_read_b64_tr_b16 v[68:69], v36 offset:9344
    ds_read_b64_tr_b16 v[70:71], v36 offset:10112
    s_waitcnt lgkmcnt(14)
    v_mfma_f32_32x32x16_bf16 v[88:103], v[76:79], v[72:75], v[88:103]
    v_mfma_f32_32x32x16_bf16 v[104:119], v[80:83], v[72:75], v[104:119]
    v_mfma_f32_32x32x16_bf16 v[120:135], v[84:87], v[72:75], v[120:135]
    s_waitcnt vmcnt(21) lgkmcnt(0)
    s_barrier
    ds_read_b128 v[72:75], v19 offset:0
    ds_read_b64_tr_b16 v[76:77], v34 offset:16384
    ds_read_b64_tr_b16 v[78:79], v34 offset:17152
    ds_read_b64_tr_b16 v[80:81], v34 offset:16448
    ds_read_b64_tr_b16 v[82:83], v34 offset:17216
    ds_read_b64_tr_b16 v[84:85], v34 offset:16512
    ds_read_b64_tr_b16 v[86:87], v34 offset:17280
    v_mfma_f32_32x32x16_bf16 v[88:103], v[44:47], v[40:43], v[88:103]
    v_mfma_f32_32x32x16_bf16 v[104:119], v[48:51], v[40:43], v[104:119]
    v_mfma_f32_32x32x16_bf16 v[120:135], v[52:55], v[40:43], v[120:135]
    ds_read_b128 v[40:43], v22 offset:0
    ds_read_b64_tr_b16 v[44:45], v34 offset:19456
    ds_read_b64_tr_b16 v[46:47], v34 offset:20224
    ds_read_b64_tr_b16 v[48:49], v34 offset:19520
    ds_read_b64_tr_b16 v[50:51], v34 offset:20288
    ds_read_b64_tr_b16 v[52:53], v34 offset:19584
    ds_read_b64_tr_b16 v[54:55], v34 offset:20352
    v_mfma_f32_32x32x16_bf16 v[88:103], v[60:63], v[56:59], v[88:103]
    v_mfma_f32_32x32x16_bf16 v[104:119], v[64:67], v[56:59], v[104:119]
    v_mfma_f32_32x32x16_bf16 v[120:135], v[68:71], v[56:59], v[120:135]
    ds_read_b128 v[56:59], v25 offset:0
    ds_read_b64_tr_b16 v[60:61], v34 offset:22528
    ds_read_b64_tr_b16 v[62:63], v34 offset:23296
    ds_read_b64_tr_b16 v[64:65], v34 offset:22592
    ds_read_b64_tr_b16 v[66:67], v34 offset:23360
    ds_read_b64_tr_b16 v[68:69], v34 offset:22656
    ds_read_b64_tr_b16 v[70:71], v34 offset:23424
    s_waitcnt lgkmcnt(14)
    v_mfma_f32_32x32x16_bf16 v[88:103], v[76:79], v[72:75], v[88:103]
    v_mfma_f32_32x32x16_bf16 v[104:119], v[80:83], v[72:75], v[104:119]
    v_mfma_f32_32x32x16_bf16 v[120:135], v[84:87], v[72:75], v[120:135]
    ds_read_b128 v[72:75], v28 offset:0
    ds_read_b64_tr_b16 v[76:77], v34 offset:25600
    ds_read_b64_tr_b16 v[78:79], v34 offset:26368
    ds_read_b64_tr_b16 v[80:81], v34 offset:25664
    ds_read_b64_tr_b16 v[82:83], v34 offset:26432
    ds_read_b64_tr_b16 v[84:85], v34 offset:25728
    ds_read_b64_tr_b16 v[86:87], v34 offset:26496
    s_waitcnt lgkmcnt(14)
    v_mfma_f32_32x32x16_bf16 v[88:103], v[44:47], v[40:43], v[88:103]
    v_mfma_f32_32x32x16_bf16 v[104:119], v[48:51], v[40:43], v[104:119]
    v_mfma_f32_32x32x16_bf16 v[120:135], v[52:55], v[40:43], v[120:135]
    s_waitcnt vmcnt(14) lgkmcnt(0)
    s_barrier
    ds_read_b128 v[40:43], v19 offset:28672
    ds_read_b64_tr_b16 v[44:45], v34 offset:45056
    ds_read_b64_tr_b16 v[46:47], v34 offset:45824
    ds_read_b64_tr_b16 v[48:49], v34 offset:45120
    ds_read_b64_tr_b16 v[50:51], v34 offset:45888
    ds_read_b64_tr_b16 v[52:53], v34 offset:45184
    ds_read_b64_tr_b16 v[54:55], v34 offset:45952
    v_mfma_f32_32x32x16_bf16 v[88:103], v[60:63], v[56:59], v[88:103]
    v_mfma_f32_32x32x16_bf16 v[104:119], v[64:67], v[56:59], v[104:119]
    v_mfma_f32_32x32x16_bf16 v[120:135], v[68:71], v[56:59], v[120:135]
    ds_read_b128 v[56:59], v22 offset:28672
    ds_read_b64_tr_b16 v[60:61], v34 offset:48128
    ds_read_b64_tr_b16 v[62:63], v34 offset:48896
    ds_read_b64_tr_b16 v[64:65], v34 offset:48192
    ds_read_b64_tr_b16 v[66:67], v34 offset:48960
    ds_read_b64_tr_b16 v[68:69], v34 offset:48256
    ds_read_b64_tr_b16 v[70:71], v34 offset:49024
    v_mfma_f32_32x32x16_bf16 v[88:103], v[76:79], v[72:75], v[88:103]
    v_mfma_f32_32x32x16_bf16 v[104:119], v[80:83], v[72:75], v[104:119]
    v_mfma_f32_32x32x16_bf16 v[120:135], v[84:87], v[72:75], v[120:135]
    ds_read_b128 v[72:75], v25 offset:28672
    ds_read_b64_tr_b16 v[76:77], v34 offset:51200
    ds_read_b64_tr_b16 v[78:79], v34 offset:51968
    ds_read_b64_tr_b16 v[80:81], v34 offset:51264
    ds_read_b64_tr_b16 v[82:83], v34 offset:52032
    ds_read_b64_tr_b16 v[84:85], v34 offset:51328
    ds_read_b64_tr_b16 v[86:87], v34 offset:52096
    s_waitcnt lgkmcnt(14)
    v_mfma_f32_32x32x16_bf16 v[88:103], v[44:47], v[40:43], v[88:103]
    v_mfma_f32_32x32x16_bf16 v[104:119], v[48:51], v[40:43], v[104:119]
    v_mfma_f32_32x32x16_bf16 v[120:135], v[52:55], v[40:43], v[120:135]
    ds_read_b128 v[40:43], v28 offset:28672
    ds_read_b64_tr_b16 v[44:45], v34 offset:54272
    ds_read_b64_tr_b16 v[46:47], v34 offset:55040
    ds_read_b64_tr_b16 v[48:49], v34 offset:54336
    ds_read_b64_tr_b16 v[50:51], v34 offset:55104
    ds_read_b64_tr_b16 v[52:53], v34 offset:54400
    ds_read_b64_tr_b16 v[54:55], v34 offset:55168
    s_waitcnt lgkmcnt(14)
    v_mfma_f32_32x32x16_bf16 v[88:103], v[60:63], v[56:59], v[88:103]
    v_mfma_f32_32x32x16_bf16 v[104:119], v[64:67], v[56:59], v[104:119]
    v_mfma_f32_32x32x16_bf16 v[120:135], v[68:71], v[56:59], v[120:135]
    s_waitcnt vmcnt(7) lgkmcnt(0)
    s_barrier
    ds_read_b128 v[56:59], v19 offset:57344
    ds_read_b64_tr_b16 v[60:61], v35 offset:8192
    ds_read_b64_tr_b16 v[62:63], v35 offset:8960
    ds_read_b64_tr_b16 v[64:65], v35 offset:8256
    ds_read_b64_tr_b16 v[66:67], v35 offset:9024
    ds_read_b64_tr_b16 v[68:69], v35 offset:8320
    ds_read_b64_tr_b16 v[70:71], v35 offset:9088
    v_mfma_f32_32x32x16_bf16 v[88:103], v[76:79], v[72:75], v[88:103]
    v_mfma_f32_32x32x16_bf16 v[104:119], v[80:83], v[72:75], v[104:119]
    v_mfma_f32_32x32x16_bf16 v[120:135], v[84:87], v[72:75], v[120:135]
    ds_read_b128 v[72:75], v22 offset:57344
    ds_read_b64_tr_b16 v[76:77], v35 offset:11264
    ds_read_b64_tr_b16 v[78:79], v35 offset:12032
    ds_read_b64_tr_b16 v[80:81], v35 offset:11328
    ds_read_b64_tr_b16 v[82:83], v35 offset:12096
    ds_read_b64_tr_b16 v[84:85], v35 offset:11392
    ds_read_b64_tr_b16 v[86:87], v35 offset:12160
    v_mfma_f32_32x32x16_bf16 v[88:103], v[44:47], v[40:43], v[88:103]
    v_mfma_f32_32x32x16_bf16 v[104:119], v[48:51], v[40:43], v[104:119]
    v_mfma_f32_32x32x16_bf16 v[120:135], v[52:55], v[40:43], v[120:135]
    ds_read_b128 v[40:43], v25 offset:57344
    ds_read_b64_tr_b16 v[44:45], v35 offset:14336
    ds_read_b64_tr_b16 v[46:47], v35 offset:15104
    ds_read_b64_tr_b16 v[48:49], v35 offset:14400
    ds_read_b64_tr_b16 v[50:51], v35 offset:15168
    ds_read_b64_tr_b16 v[52:53], v35 offset:14464
    ds_read_b64_tr_b16 v[54:55], v35 offset:15232
    s_waitcnt lgkmcnt(14)
    v_mfma_f32_32x32x16_bf16 v[88:103], v[60:63], v[56:59], v[88:103]
    v_mfma_f32_32x32x16_bf16 v[104:119], v[64:67], v[56:59], v[104:119]
    v_mfma_f32_32x32x16_bf16 v[120:135], v[68:71], v[56:59], v[120:135]
    ds_read_b128 v[56:59], v28 offset:57344
    ds_read_b64_tr_b16 v[60:61], v35 offset:17408
    ds_read_b64_tr_b16 v[62:63], v35 offset:18176
    ds_read_b64_tr_b16 v[64:65], v35 offset:17472
    ds_read_b64_tr_b16 v[66:67], v35 offset:18240
    ds_read_b64_tr_b16 v[68:69], v35 offset:17536
    ds_read_b64_tr_b16 v[70:71], v35 offset:18304
    s_waitcnt lgkmcnt(14)
    v_mfma_f32_32x32x16_bf16 v[88:103], v[76:79], v[72:75], v[88:103]
    v_mfma_f32_32x32x16_bf16 v[104:119], v[80:83], v[72:75], v[104:119]
    v_mfma_f32_32x32x16_bf16 v[120:135], v[84:87], v[72:75], v[120:135]
    s_waitcnt vmcnt(0) lgkmcnt(0)
    s_barrier
    ds_read_b128 v[72:75], v20 offset:20480
    ds_read_b64_tr_b16 v[76:77], v35 offset:36864
    ds_read_b64_tr_b16 v[78:79], v35 offset:37632
    ds_read_b64_tr_b16 v[80:81], v35 offset:36928
    ds_read_b64_tr_b16 v[82:83], v35 offset:37696
    ds_read_b64_tr_b16 v[84:85], v35 offset:36992
    ds_read_b64_tr_b16 v[86:87], v35 offset:37760
    v_mfma_f32_32x32x16_bf16 v[88:103], v[44:47], v[40:43], v[88:103]
    v_mfma_f32_32x32x16_bf16 v[104:119], v[48:51], v[40:43], v[104:119]
    v_mfma_f32_32x32x16_bf16 v[120:135], v[52:55], v[40:43], v[120:135]
    ds_read_b128 v[40:43], v23 offset:20480
    ds_read_b64_tr_b16 v[44:45], v35 offset:39936
    ds_read_b64_tr_b16 v[46:47], v35 offset:40704
    ds_read_b64_tr_b16 v[48:49], v35 offset:40000
    ds_read_b64_tr_b16 v[50:51], v35 offset:40768
    ds_read_b64_tr_b16 v[52:53], v35 offset:40064
    ds_read_b64_tr_b16 v[54:55], v35 offset:40832
    v_mfma_f32_32x32x16_bf16 v[88:103], v[60:63], v[56:59], v[88:103]
    v_mfma_f32_32x32x16_bf16 v[104:119], v[64:67], v[56:59], v[104:119]
    v_mfma_f32_32x32x16_bf16 v[120:135], v[68:71], v[56:59], v[120:135]
    ds_read_b128 v[56:59], v26 offset:20480
    ds_read_b64_tr_b16 v[60:61], v35 offset:43008
    ds_read_b64_tr_b16 v[62:63], v35 offset:43776
    ds_read_b64_tr_b16 v[64:65], v35 offset:43072
    ds_read_b64_tr_b16 v[66:67], v35 offset:43840
    ds_read_b64_tr_b16 v[68:69], v35 offset:43136
    ds_read_b64_tr_b16 v[70:71], v35 offset:43904
    s_waitcnt lgkmcnt(14)
    v_mfma_f32_32x32x16_bf16 v[88:103], v[76:79], v[72:75], v[88:103]
    v_mfma_f32_32x32x16_bf16 v[104:119], v[80:83], v[72:75], v[104:119]
    v_mfma_f32_32x32x16_bf16 v[120:135], v[84:87], v[72:75], v[120:135]
    ds_read_b128 v[72:75], v29 offset:20480
    ds_read_b64_tr_b16 v[76:77], v35 offset:46080
    ds_read_b64_tr_b16 v[78:79], v35 offset:46848
    ds_read_b64_tr_b16 v[80:81], v35 offset:46144
    ds_read_b64_tr_b16 v[82:83], v35 offset:46912
    ds_read_b64_tr_b16 v[84:85], v35 offset:46208
    ds_read_b64_tr_b16 v[86:87], v35 offset:46976
    s_waitcnt lgkmcnt(14)
    v_mfma_f32_32x32x16_bf16 v[88:103], v[44:47], v[40:43], v[88:103]
    v_mfma_f32_32x32x16_bf16 v[104:119], v[48:51], v[40:43], v[104:119]
    v_mfma_f32_32x32x16_bf16 v[120:135], v[52:55], v[40:43], v[120:135]
    s_waitcnt lgkmcnt(7)
    v_mfma_f32_32x32x16_bf16 v[88:103], v[60:63], v[56:59], v[88:103]
    v_mfma_f32_32x32x16_bf16 v[104:119], v[64:67], v[56:59], v[104:119]
    v_mfma_f32_32x32x16_bf16 v[120:135], v[68:71], v[56:59], v[120:135]
    s_waitcnt lgkmcnt(0)
    v_mfma_f32_32x32x16_bf16 v[88:103], v[76:79], v[72:75], v[88:103]
    v_mfma_f32_32x32x16_bf16 v[104:119], v[80:83], v[72:75], v[104:119]
    v_mfma_f32_32x32x16_bf16 v[120:135], v[84:87], v[72:75], v[120:135]
    s_nop 7
    s_nop 7
    ds_write_b128 v137, v[88:91] offset:0
    ds_write_b128 v141, v[92:95] offset:0
    ds_write_b128 v142, v[96:99] offset:0
    ds_write_b128 v143, v[100:103] offset:0
    ds_write_b128 v137, v[104:107] offset:4096
    ds_write_b128 v141, v[108:111] offset:4096
    ds_write_b128 v142, v[112:115] offset:4096
    ds_write_b128 v143, v[116:119] offset:4096
    ds_write_b128 v137, v[120:123] offset:8192
    ds_write_b128 v141, v[124:127] offset:8192
    ds_write_b128 v142, v[128:131] offset:8192
    ds_write_b128 v143, v[132:135] offset:8192
    s_waitcnt lgkmcnt(8)
    ds_read_b128 v[88:91], v138 offset:0
    ds_read_b128 v[92:95], v138 offset:1024
    ds_read_b128 v[96:99], v138 offset:2048
    ds_read_b128 v[100:103], v138 offset:3072
    s_waitcnt lgkmcnt(8)
    ds_read_b128 v[104:107], v138 offset:4096
    ds_read_b128 v[108:111], v138 offset:5120
    ds_read_b128 v[112:115], v138 offset:6144
    ds_read_b128 v[116:119], v138 offset:7168
    s_waitcnt lgkmcnt(8)
    ds_read_b128 v[120:123], v138 offset:8192
    ds_read_b128 v[124:127], v138 offset:9216
    ds_read_b128 v[128:131], v138 offset:10240
    ds_read_b128 v[132:135], v138 offset:11264
    s_waitcnt lgkmcnt(11)
    s_mov_b32 s9, 0
    buffer_store_dwordx4 v[88:91], v139, s[60:63], s9 offen offset:0 sc0 sc1
    s_waitcnt lgkmcnt(10)
    s_mov_b32 s9, 36864
    buffer_store_dwordx4 v[92:95], v139, s[60:63], s9 offen offset:0 sc0 sc1
    s_waitcnt lgkmcnt(9)
    s_mov_b32 s9, 73728
    buffer_store_dwordx4 v[96:99], v139, s[60:63], s9 offen offset:0 sc0 sc1
    s_waitcnt lgkmcnt(8)
    s_mov_b32 s9, 110592
    buffer_store_dwordx4 v[100:103], v139, s[60:63], s9 offen offset:0 sc0 sc1
    s_waitcnt lgkmcnt(7)
    s_mov_b32 s9, 0
    buffer_store_dwordx4 v[104:107], v139, s[60:63], s9 offen offset:128 sc0 sc1
    s_waitcnt lgkmcnt(6)
    s_mov_b32 s9, 36864
    buffer_store_dwordx4 v[108:111], v139, s[60:63], s9 offen offset:128 sc0 sc1
    s_waitcnt lgkmcnt(5)
    s_mov_b32 s9, 73728
    buffer_store_dwordx4 v[112:115], v139, s[60:63], s9 offen offset:128 sc0 sc1
    s_waitcnt lgkmcnt(4)
    s_mov_b32 s9, 110592
    buffer_store_dwordx4 v[116:119], v139, s[60:63], s9 offen offset:128 sc0 sc1
    s_waitcnt lgkmcnt(3)
    s_mov_b32 s9, 0
    buffer_store_dwordx4 v[120:123], v139, s[60:63], s9 offen offset:256 sc0 sc1
    s_waitcnt lgkmcnt(2)
    s_mov_b32 s9, 36864
    buffer_store_dwordx4 v[124:127], v139, s[60:63], s9 offen offset:256 sc0 sc1
    s_waitcnt lgkmcnt(1)
    s_mov_b32 s9, 73728
    buffer_store_dwordx4 v[128:131], v139, s[60:63], s9 offen offset:256 sc0 sc1
    s_waitcnt lgkmcnt(0)
    s_mov_b32 s9, 110592
    buffer_store_dwordx4 v[132:135], v139, s[60:63], s9 offen offset:256 sc0 sc1
    s_endpgm
L_k3_y:
    v_lshrrev_b32 v2, 4, v1
    v_bfe_u32 v3, v1, 2, 2
    v_xor_b32 v3, v3, v2
    v_and_b32 v4, 3, v1
    v_lshl_add_u32 v3, v3, 2, v4
    s_lshl_b32 s6, s5, 4
    v_add_u32 v2, s6, v2
    v_lshlrev_b32 v2, 8, v2
    v_lshl_add_u32 v2, v3, 4, v2
    s_mul_i32 s6, s3, 294912
    v_add_u32 v2, s6, v2
    v_lshrrev_b32 v6, 4, v1
    v_and_b32 v5, 7, v1
    v_xor_b32 v5, v5, v6
    v_lshlrev_b32 v5, 4, v5
    v_lshrrev_b32 v3, 5, v1
    v_bfe_u32 v4, v1, 3, 2
    v_lshl_add_u32 v3, v3, 4, v4
    v_mul_u32_u24 v3, 1152, v3
    s_mul_i32 s6, s5, 2
    s_lshr_b32 s7, s6, 2
    s_lshl_b32 s7, s7, 3
    s_and_b32 s8, s6, 3
    s_add_u32 s7, s7, s8
    s_mul_i32 s8, s4, 16
    s_add_u32 s7, s7, s8
    s_mul_i32 s7, s7, 4608
    s_and_b32 s6, s6, 1
    s_lshl_b32 s6, s6, 6
    v_xor_b32 v7, s6, v5
    v_add3_u32 v7, v7, v3, s7
    s_mul_i32 s6, s5, 2
    s_add_u32 s6, s6, 1
    s_lshr_b32 s7, s6, 2
    s_lshl_b32 s7, s7, 3
    s_and_b32 s8, s6, 3
    s_add_u32 s7, s7, s8
    s_mul_i32 s8, s4, 16
    s_add_u32 s7, s7, s8
    s_mul_i32 s7, s7, 4608
    s_sub_u32 s7, s7, 1024
    s_and_b32 s6, s6, 1
    s_lshl_b32 s6, s6, 6
    v_xor_b32 v8, s6, v5
    v_add3_u32 v8, v8, v3, s7
    s_lshl_b32 s7, s3, 7
    s_lshl_b32 s8, s5, 5
    s_add_u32 s7, s7, s8
    v_and_b32 v9, 31, v1
    v_add_u32 v9, s7, v9
    v_lshrrev_b32 v4, 5, v1
    s_mul_i32 s7, s4, 128
    v_lshlrev_b32 v10, 5, v4
    v_add_u32 v10, s7, v10
    v_mul_u32_u24 v9, 1152, v9
    v_add_u32 v9, v9, v10
    s_lshl_b32 s10, s5, 12
    s_mul_i32 s11, s5, 2048
    s_waitcnt lgkmcnt(0)
    s_add_u32 s52, s48, 0x300000
    s_addc_u32 s53, s49, 0
    s_mov_b32 s54, 0x480000
    s_mov_b32 s55, 0x00020000
    s_mov_b32 s56, s26
    s_mov_b32 s57, s27
    s_mov_b32 s58, 0xa2000
    s_mov_b32 s59, 0x00020000
    s_mov_b32 s60, s28
    s_mov_b32 s61, s29
    s_mov_b32 s62, 0xa2000
    s_mov_b32 s63, 0x00020000
    s_mov_b32 s64, s16
    s_mov_b32 s65, s17
    s_mov_b32 s66, 0x240000
    s_mov_b32 s67, 0x00020000
    s_mov_b32 s68, s32
    s_mov_b32 s69, s33
    s_mov_b32 s70, 0x480
    s_mov_b32 s71, 0x00020000
    s_mov_b32 s72, s44
    s_mov_b32 s73, s45
    s_mov_b32 s74, 0x900000
    s_mov_b32 s75, 0x00020000
    s_add_u32 m0, s10, 0
    s_add_u32 s51, s51, 128
    s_sub_u32 s9, s51, 1152
    s_min_u32 s51, s51, s9
    s_lshl_b32 s9, s51, 7
    buffer_load_dwordx4 v2, s[52:55], s9 offen lds
    buffer_load_dwordx4 v2, s[52:55], s9 offen offset:1024 lds
    buffer_load_dwordx4 v2, s[52:55], s9 offen offset:2048 lds
    buffer_load_dwordx4 v2, s[52:55], s9 offen offset:3072 lds
    s_add_u32 m0, s11, 16384
    s_nop 0
    buffer_load_dwordx4 v7, s[56:59], s51 offen lds
    buffer_load_dwordx4 v8, s[56:59], s51 offen offset:1024 lds
    s_add_u32 m0, s10, 24576
    s_add_u32 s51, s51, 128
    s_sub_u32 s9, s51, 1152
    s_min_u32 s51, s51, s9
    s_lshl_b32 s9, s51, 7
    buffer_load_dwordx4 v2, s[52:55], s9 offen lds
    buffer_load_dwordx4 v2, s[52:55], s9 offen offset:1024 lds
    buffer_load_dwordx4 v2, s[52:55], s9 offen offset:2048 lds
    buffer_load_dwordx4 v2, s[52:55], s9 offen offset:3072 lds
    s_add_u32 m0, s11, 40960
    s_nop 0
    buffer_load_dwordx4 v7, s[56:59], s51 offen lds
    buffer_load_dwordx4 v8, s[56:59], s51 offen offset:1024 lds
    buffer_load_dwordx4 v[12:15], v9, s[64:67], 0 offen offset:0
    buffer_load_dwordx4 v[28:31], v10, s[68:71], 0 offen offset:0
    buffer_load_dwordx4 v[16:19], v9, s[64:67], 0 offen offset:16
    buffer_load_dwordx4 v[32:35], v10, s[68:71], 0 offen offset:16
    buffer_load_dwordx4 v[20:23], v9, s[64:67], 0 offen offset:64
    buffer_load_dwordx4 v[36:39], v10, s[68:71], 0 offen offset:64
    buffer_load_dwordx4 v[24:27], v9, s[64:67], 0 offen offset:80
    buffer_load_dwordx4 v[40:43], v10, s[68:71], 0 offen offset:80
    v_and_b32 v44, 31, v1
    v_bfe_u32 v45, v1, 1, 3
    v_lshrrev_b32 v46, 5, v1
    v_xor_b32 v45, v45, v46
    v_lshlrev_b32 v45, 4, v45
    v_lshl_add_u32 v46, v44, 7, v45
    v_add_u32 v47, 0x10000, v46
    v_add_u32 v48, 0x20000, v46
    v_xor_b32 v49, 32, v46
    v_add_u32 v50, 0x10000, v49
    v_add_u32 v51, 0x20000, v49
    v_xor_b32 v52, 64, v46
    v_add_u32 v53, 0x10000, v52
    v_add_u32 v54, 0x20000, v52
    v_xor_b32 v55, 96, v46
    v_add_u32 v56, 0x10000, v55
    v_add_u32 v57, 0x20000, v55
    v_bfe_u32 v58, v1, 2, 2
    v_lshrrev_b32 v60, 5, v1
    v_lshl_add_u32 v60, v60, 3, v58
    v_mul_u32_u24 v61, 256, v60
    v_bfe_u32 v59, v1, 4, 1
    v_lshl_add_u32 v61, v59, 5, v61
    v_and_b32 v59, 3, v1
    v_lshl_add_u32 v61, v59, 3, v61
    v_xor_b32 v58, s5, v58
    v_lshl_add_u32 v61, v58, 6, v61
    v_add_u32 v62, 0x10000, v61
    v_add_u32 v63, 0x20000, v61
    s_lshl_b32 s6, s3, 7
    s_lshl_b32 s8, s5, 5
    s_add_u32 s6, s6, s8
    s_mul_i32 s7, s4, 256
    s_mul_i32 s8, s5, 8192
    s_waitcnt vmcnt(14)
    s_barrier
    ds_read_b64_tr_b16 v[64:65], v61 offset:0
    ds_read_b64_tr_b16 v[66:67], v61 offset:1024
    ds_read_b128 v[68:71], v46 offset:16384
    ds_read_b128 v[72:75], v46 offset:20480
    ds_read_b64_tr_b16 v[76:77], v61 offset:4096
    ds_read_b64_tr_b16 v[78:79], v61 offset:5120
    ds_read_b128 v[80:83], v49 offset:16384
    ds_read_b128 v[84:87], v49 offset:20480
    ds_read_b64_tr_b16 v[88:89], v61 offset:8192
    ds_read_b64_tr_b16 v[90:91], v61 offset:9216
    ds_read_b128 v[92:95], v52 offset:16384
    ds_read_b128 v[96:99], v52 offset:20480
    s_waitcnt lgkmcnt(8)
    v_mfma_f32_32x32x16_bf16 v[100:115], v[68:71], v[64:67], 0
    s_add_u32 m0, s10, 49152
    s_add_u32 s51, s51, 128
    s_sub_u32 s9, s51, 1152
    s_min_u32 s51, s51, s9
    s_lshl_b32 s9, s51, 7
    buffer_load_dwordx4 v2, s[52:55], s9 offen lds
    v_mfma_f32_32x32x16_bf16 v[116:131], v[72:75], v[64:67], 0
    buffer_load_dwordx4 v2, s[52:55], s9 offen offset:1024 lds
    ds_read_b64_tr_b16 v[64:65], v61 offset:12288
    ds_read_b64_tr_b16 v[66:67], v61 offset:13312
    ds_read_b128 v[68:71], v55 offset:16384
    ds_read_b128 v[72:75], v55 offset:20480
    s_waitcnt lgkmcnt(8)
    v_mfma_f32_32x32x16_bf16 v[100:115], v[80:83], v[76:79], v[100:115]
    buffer_load_dwordx4 v2, s[52:55], s9 offen offset:2048 lds
    v_mfma_f32_32x32x16_bf16 v[116:131], v[84:87], v[76:79], v[116:131]
    buffer_load_dwordx4 v2, s[52:55], s9 offen offset:3072 lds
    s_waitcnt vmcnt(12) lgkmcnt(0)
    s_barrier
    ds_read_b64_tr_b16 v[76:77], v61 offset:24576
    ds_read_b64_tr_b16 v[78:79], v61 offset:25600
    ds_read_b128 v[80:83], v46 offset:40960
    ds_read_b128 v[84:87], v46 offset:45056
    v_mfma_f32_32x32x16_bf16 v[100:115], v[92:95], v[88:91], v[100:115]
    s_add_u32 m0, s11, 65536
    s_nop 0
    buffer_load_dwordx4 v7, s[56:59], s51 offen lds
    v_mfma_f32_32x32x16_bf16 v[116:131], v[96:99], v[88:91], v[116:131]
    buffer_load_dwordx4 v8, s[56:59], s51 offen offset:1024 lds
    ds_read_b64_tr_b16 v[88:89], v61 offset:28672
    ds_read_b64_tr_b16 v[90:91], v61 offset:29696
    ds_read_b128 v[92:95], v49 offset:40960
    ds_read_b128 v[96:99], v49 offset:45056
    v_mfma_f32_32x32x16_bf16 v[100:115], v[68:71], v[64:67], v[100:115]
    s_add_u32 m0, s10, 73728
    s_add_u32 s51, s51, 128
    s_sub_u32 s9, s51, 1152
    s_min_u32 s51, s51, s9
    s_lshl_b32 s9, s51, 7
    buffer_load_dwordx4 v2, s[52:55], s9 offen lds
    v_mfma_f32_32x32x16_bf16 v[116:131], v[72:75], v[64:67], v[116:131]
    buffer_load_dwordx4 v2, s[52:55], s9 offen offset:1024 lds
    ds_read_b64_tr_b16 v[64:65], v61 offset:32768
    ds_read_b64_tr_b16 v[66:67], v61 offset:33792
    ds_read_b128 v[68:71], v52 offset:40960
    ds_read_b128 v[72:75], v52 offset:45056
    s_waitcnt lgkmcnt(8)
    v_mfma_f32_32x32x16_bf16 v[100:115], v[80:83], v[76:79], v[100:115]
    buffer_load_dwordx4 v2, s[52:55], s9 offen offset:2048 lds
    v_mfma_f32_32x32x16_bf16 v[116:131], v[84:87], v[76:79], v[116:131]
    buffer_load_dwordx4 v2, s[52:55], s9 offen offset:3072 lds
    ds_read_b64_tr_b16 v[76:77], v61 offset:36864
    ds_read_b64_tr_b16 v[78:79], v61 offset:37888
    ds_read_b128 v[80:83], v55 offset:40960
    ds_read_b128 v[84:87], v55 offset:45056
    s_waitcnt lgkmcnt(8)
    v_mfma_f32_32x32x16_bf16 v[100:115], v[92:95], v[88:91], v[100:115]
    s_add_u32 m0, s11, 90112
    s_nop 0
    buffer_load_dwordx4 v7, s[56:59], s51 offen lds
    v_mfma_f32_32x32x16_bf16 v[116:131], v[96:99], v[88:91], v[116:131]
    buffer_load_dwordx4 v8, s[56:59], s51 offen offset:1024 lds
    s_waitcnt vmcnt(6) lgkmcnt(0)
    s_barrier
    ds_read_b64_tr_b16 v[88:89], v61 offset:49152
    ds_read_b64_tr_b16 v[90:91], v61 offset:50176
    ds_read_b128 v[92:95], v47 offset:0
    ds_read_b128 v[96:99], v47 offset:4096
    v_mfma_f32_32x32x16_bf16 v[100:115], v[68:71], v[64:67], v[100:115]
    s_add_u32 m0, s10, 98304
    s_add_u32 s51, s51, 128
    s_sub_u32 s9, s51, 1152
    s_min_u32 s51, s51, s9
    s_lshl_b32 s9, s51, 7
    buffer_load_dwordx4 v2, s[52:55], s9 offen lds
    v_mfma_f32_32x32x16_bf16 v[116:131], v[72:75], v[64:67], v[116:131]
    buffer_load_dwordx4 v2, s[52:55], s9 offen offset:1024 lds
    ds_read_b64_tr_b16 v[64:65], v61 offset:53248
    ds_read_b64_tr_b16 v[66:67], v61 offset:54272
    ds_read_b128 v[68:71], v50 offset:0
    ds_read_b128 v[72:75], v50 offset:4096
    v_mfma_f32_32x32x16_bf16 v[100:115], v[80:83], v[76:79], v[100:115]
    buffer_load_dwordx4 v2, s[52:55], s9 offen offset:2048 lds
    v_mfma_f32_32x32x16_bf16 v[116:131], v[84:87], v[76:79], v[116:131]
    buffer_load_dwordx4 v2, s[52:55], s9 offen offset:3072 lds
    ds_read_b64_tr_b16 v[76:77], v61 offset:57344
    ds_read_b64_tr_b16 v[78:79], v61 offset:58368
    ds_read_b128 v[80:83], v53 offset:0
    ds_read_b128 v[84:87], v53 offset:4096
    s_waitcnt lgkmcnt(8)
    v_mfma_f32_32x32x16_bf16 v[100:115], v[92:95], v[88:91], v[100:115]
    s_add_u32 m0, s11, 114688
    s_nop 0
    buffer_load_dwordx4 v7, s[56:59], s51 offen lds
    v_mfma_f32_32x32x16_bf16 v[116:131], v[96:99], v[88:91], v[116:131]
    buffer_load_dwordx4 v8, s[56:59], s51 offen offset:1024 lds
    ds_read_b64_tr_b16 v[88:89], v61 offset:61440
    ds_read_b64_tr_b16 v[90:91], v61 offset:62464
    ds_read_b128 v[92:95], v56 offset:0
    ds_read_b128 v[96:99], v56 offset:4096
    s_waitcnt lgkmcnt(8)
    v_mfma_f32_32x32x16_bf16 v[100:115], v[68:71], v[64:67], v[100:115]
    s_add_u32 m0, s10, 122880
    s_add_u32 s51, s51, 128
    s_sub_u32 s9, s51, 1152
    s_min_u32 s51, s51, s9
    s_lshl_b32 s9, s51, 7
    buffer_load_dwordx4 v2, s[52:55], s9 offen lds
    v_mfma_f32_32x32x16_bf16 v[116:131], v[72:75], v[64:67], v[116:131]
    buffer_load_dwordx4 v2, s[52:55], s9 offen offset:1024 lds
    s_waitcnt vmcnt(8) lgkmcnt(0)
    s_barrier
    ds_read_b64_tr_b16 v[64:65], v62 offset:8192
    ds_read_b64_tr_b16 v[66:67], v62 offset:9216
    ds_read_b128 v[68:71], v47 offset:24576
    ds_read_b128 v[72:75], v47 offset:28672
    v_mfma_f32_32x32x16_bf16 v[100:115], v[80:83], v[76:79], v[100:115]
    buffer_load_dwordx4 v2, s[52:55], s9 offen offset:2048 lds
    v_mfma_f32_32x32x16_bf16 v[116:131], v[84:87], v[76:79], v[116:131]
    buffer_load_dwordx4 v2, s[52:55], s9 offen offset:3072 lds
    ds_read_b64_tr_b16 v[76:77], v62 offset:12288
    ds_read_b64_tr_b16 v[78:79], v62 offset:13312
    ds_read_b128 v[80:83], v50 offset:24576
    ds_read_b128 v[84:87], v50 offset:28672
    v_mfma_f32_32x32x16_bf16 v[100:115], v[92:95], v[88:91], v[100:115]
    s_add_u32 m0, s11, 139264
    s_nop 0
    buffer_load_dwordx4 v7, s[56:59], s51 offen lds
    v_mfma_f32_32x32x16_bf16 v[116:131], v[96:99], v[88:91], v[116:131]
    buffer_load_dwordx4 v8, s[56:59], s51 offen offset:1024 lds
    ds_read_b64_tr_b16 v[88:89], v62 offset:16384
    ds_read_b64_tr_b16 v[90:91], v62 offset:17408
    ds_read_b128 v[92:95], v53 offset:24576
    ds_read_b128 v[96:99], v53 offset:28672
    s_waitcnt lgkmcnt(8)
    v_mfma_f32_32x32x16_bf16 v[100:115], v[68:71], v[64:67], v[100:115]
    s_add_u32 m0, s10, 0
    s_add_u32 s51, s51, 128
    s_sub_u32 s9, s51, 1152
    s_min_u32 s51, s51, s9
    s_lshl_b32 s9, s51, 7
    buffer_load_dwordx4 v2, s[52:55], s9 offen lds
    v_and_b32 v132, 7, v1
    v_lshrrev_b32 v133, 5, v1
    v_mfma_f32_32x32x16_bf16 v[116:131], v[72:75], v[64:67], v[116:131]
    buffer_load_dwordx4 v2, s[52:55], s9 offen offset:1024 lds
    v_lshlrev_b32 v133, 2, v133
    v_xor_b32 v133, v133, v132
    ds_read_b64_tr_b16 v[64:65], v62 offset:20480
    ds_read_b64_tr_b16 v[66:67], v62 offset:21504
    ds_read_b128 v[68:71], v56 offset:24576
    ds_read_b128 v[72:75], v56 offset:28672
    s_waitcnt lgkmcnt(8)
    v_mfma_f32_32x32x16_bf16 v[100:115], v[80:83], v[76:79], v[100:115]
    buffer_load_dwordx4 v2, s[52:55], s9 offen offset:2048 lds
    v_lshlrev_b32 v133, 4, v133
    v_and_b32 v136, 31, v1
    v_mfma_f32_32x32x16_bf16 v[116:131], v[84:87], v[76:79], v[116:131]
    buffer_load_dwordx4 v2, s[52:55], s9 offen offset:3072 lds
    v_lshl_add_u32 v133, v136, 7, v133
    v_add_u32 v133, s8, v133
    s_waitcnt vmcnt(10) lgkmcnt(0)
    s_barrier
    ds_read_b64_tr_b16 v[76:77], v62 offset:32768
    ds_read_b64_tr_b16 v[78:79], v62 offset:33792
    ds_read_b128 v[80:83], v47 offset:49152
    ds_read_b128 v[84:87], v47 offset:53248
    v_mfma_f32_32x32x16_bf16 v[100:115], v[92:95], v[88:91], v[100:115]
    s_add_u32 m0, s11, 16384
    s_nop 0
    buffer_load_dwordx4 v7, s[56:59], s51 offen lds
    v_lshrrev_b32 v136, 3, v1
    v_xor_b32 v134, v136, v132
    v_mfma_f32_32x32x16_bf16 v[116:131], v[96:99], v[88:91], v[116:131]
    buffer_load_dwordx4 v8, s[56:59], s51 offen offset:1024 lds
    v_lshlrev_b32 v134, 4, v134
    v_lshl_add_u32 v134, v136, 7, v134
    ds_read_b64_tr_b16 v[88:89], v62 offset:36864
    ds_read_b64_tr_b16 v[90:91], v62 offset:37888
    ds_read_b128 v[92:95], v50 offset:49152
    ds_read_b128 v[96:99], v50 offset:53248
    v_mfma_f32_32x32x16_bf16 v[100:115], v[68:71], v[64:67], v[100:115]
    s_add_u32 m0, s10, 24576
    s_add_u32 s51, s51, 128
    s_sub_u32 s9, s51, 1152
    s_min_u32 s51, s51, s9
    s_lshl_b32 s9, s51, 7
    buffer_load_dwordx4 v2, s[52:55], s9 offen lds
    v_add_u32 v134, s8, v134
    v_add_u32 v135, s6, v136
    v_mfma_f32_32x32x16_bf16 v[116:131], v[72:75], v[64:67], v[116:131]
    buffer_load_dwordx4 v2, s[52:55], s9 offen offset:1024 lds
    v_mul_u32_u24 v135, 4608, v135
    v_lshl_add_u32 v135, v132, 4, v135
    ds_read_b64_tr_b16 v[64:65], v62 offset:40960
    ds_read_b64_tr_b16 v[66:67], v62 offset:41984
    ds_read_b128 v[68:71], v53 offset:49152
    ds_read_b128 v[72:75], v53 offset:53248
    s_waitcnt lgkmcnt(8)
    v_mfma_f32_32x32x16_bf16 v[100:115], v[80:83], v[76:79], v[100:115]
    buffer_load_dwordx4 v2, s[52:55], s9 offen offset:2048 lds
    v_add_u32 v135, s7, v135
    v_xor_b32 v137, 16, v133
    v_mfma_f32_32x32x16_bf16 v[116:131], v[84:87], v[76:79], v[116:131]
    buffer_load_dwordx4 v2, s[52:55], s9 offen offset:3072 lds
    v_xor_b32 v138, 32, v133
    v_xor_b32 v139, 48, v133
    ds_read_b64_tr_b16 v[76:77], v62 offset:45056
    ds_read_b64_tr_b16 v[78:79], v62 offset:46080
    ds_read_b128 v[80:83], v56 offset:49152
    ds_read_b128 v[84:87], v56 offset:53248
    s_waitcnt lgkmcnt(8)
    v_mfma_f32_32x32x16_bf16 v[100:115], v[92:95], v[88:91], v[100:115]
    s_add_u32 m0, s11, 40960
    s_nop 0
    buffer_load_dwordx4 v7, s[56:59], s51 offen lds
    v_lshlrev_b32 v140, 16, v12
    v_lshlrev_b32 v141, 16, v28
    v_mfma_f32_32x32x16_bf16 v[116:131], v[96:99], v[88:91], v[116:131]
    buffer_load_dwordx4 v8, s[56:59], s51 offen offset:1024 lds
    v_and_b32 v142, 0xffff0000, v12
    v_and_b32 v143, 0xffff0000, v28
    s_waitcnt vmcnt(12) lgkmcnt(0)
    s_barrier
    ds_read_b64_tr_b16 v[88:89], v62 offset:57344
    ds_read_b64_tr_b16 v[90:91], v62 offset:58368
    ds_read_b128 v[92:95], v48 offset:8192
    ds_read_b128 v[96:99], v48 offset:12288
    v_mfma_f32_32x32x16_bf16 v[100:115], v[68:71], v[64:67], v[100:115]
    s_add_u32 m0, s10, 49152
    s_add_u32 s51, s51, 128
    s_sub_u32 s9, s51, 1152
    s_min_u32 s51, s51, s9
    s_lshl_b32 s9, s51, 7
    buffer_load_dwordx4 v2, s[52:55], s9 offen lds
    v_mul_f32 v140, v140, v141
    v_mul_f32 v142, v142, v143
    v_mfma_f32_32x32x16_bf16 v[116:131], v[72:75], v[64:67], v[116:131]
    buffer_load_dwordx4 v2, s[52:55], s9 offen offset:1024 lds
    v_cvt_pk_bf16_f32 v140, v140, v142
    v_lshlrev_b32 v12, 16, v140
    ds_read_b64_tr_b16 v[64:65], v62 offset:61440
    ds_read_b64_tr_b16 v[66:67], v62 offset:62464
    ds_read_b128 v[68:71], v51 offset:8192
    ds_read_b128 v[72:75], v51 offset:12288
    v_mfma_f32_32x32x16_bf16 v[100:115], v[80:83], v[76:79], v[100:115]
    buffer_load_dwordx4 v2, s[52:55], s9 offen offset:2048 lds
    v_and_b32 v28, 0xffff0000, v140
    v_lshlrev_b32 v140, 16, v13
    v_mfma_f32_32x32x16_bf16 v[116:131], v[84:87], v[76:79], v[116:131]
    buffer_load_dwordx4 v2, s[52:55], s9 offen offset:3072 lds
    v_lshlrev_b32 v141, 16, v29
    v_and_b32 v142, 0xffff0000, v13
    ds_read_b64_tr_b16 v[76:77], v63 offset:0
    ds_read_b64_tr_b16 v[78:79], v63 offset:1024
    ds_read_b128 v[80:83], v54 offset:8192
    ds_read_b128 v[84:87], v54 offset:12288
    s_waitcnt lgkmcnt(8)
    v_mfma_f32_32x32x16_bf16 v[100:115], v[92:95], v[88:91], v[100:115]
    s_add_u32 m0, s11, 65536
    s_nop 0
    buffer_load_dwordx4 v7, s[56:59], s51 offen lds
    v_and_b32 v143, 0xffff0000, v29
    v_mul_f32 v140, v140, v141
    v_mfma_f32_32x32x16_bf16 v[116:131], v[96:99], v[88:91], v[116:131]
    buffer_load_dwordx4 v8, s[56:59], s51 offen offset:1024 lds
    v_mul_f32 v142, v142, v143
    v_cvt_pk_bf16_f32 v140, v140, v142
    ds_read_b64_tr_b16 v[88:89], v63 offset:4096
    ds_read_b64_tr_b16 v[90:91], v63 offset:5120
    ds_read_b128 v[92:95], v57 offset:8192
    ds_read_b128 v[96:99], v57 offset:12288
    s_waitcnt lgkmcnt(8)
    v_mfma_f32_32x32x16_bf16 v[100:115], v[68:71], v[64:67], v[100:115]
    s_add_u32 m0, s10, 73728
    s_add_u32 s51, s51, 128
    s_sub_u32 s9, s51, 1152
    s_min_u32 s51, s51, s9
    s_lshl_b32 s9, s51, 7
    s_add_u32 s9, s9, 147456
    buffer_load_dwordx4 v2, s[52:55], s9 offen lds
    v_lshlrev_b32 v13, 16, v140
    v_and_b32 v29, 0xffff0000, v140
    v_mfma_f32_32x32x16_bf16 v[116:131], v[72:75], v[64:67], v[116:131]
    buffer_load_dwordx4 v2, s[52:55], s9 offen offset:1024 lds
    v_lshlrev_b32 v140, 16, v14
    v_lshlrev_b32 v141, 16, v30
    s_waitcnt vmcnt(14) lgkmcnt(0)
    s_barrier
    ds_read_b64_tr_b16 v[64:65], v61 offset:0
    ds_read_b64_tr_b16 v[66:67], v61 offset:1024
    ds_read_b128 v[68:71], v46 offset:16384
    ds_read_b128 v[72:75], v46 offset:20480
    v_mfma_f32_32x32x16_bf16 v[100:115], v[80:83], v[76:79], v[100:115]
    buffer_load_dwordx4 v2, s[52:55], s9 offen offset:2048 lds
    v_and_b32 v142, 0xffff0000, v14
    v_and_b32 v143, 0xffff0000, v30
    v_mfma_f32_32x32x16_bf16 v[116:131], v[84:87], v[76:79], v[116:131]
    buffer_load_dwordx4 v2, s[52:55], s9 offen offset:3072 lds
    v_mul_f32 v140, v140, v141
    v_mul_f32 v142, v142, v143
    ds_read_b64_tr_b16 v[76:77], v61 offset:4096
    ds_read_b64_tr_b16 v[78:79], v61 offset:5120
    ds_read_b128 v[80:83], v49 offset:16384
    ds_read_b128 v[84:87], v49 offset:20480
    v_mfma_f32_32x32x16_bf16 v[100:115], v[92:95], v[88:91], v[100:115]
    s_add_u32 m0, s11, 90112
    s_nop 0
    buffer_load_dwordx4 v7, s[60:63], s51 offen lds
    v_cvt_pk_bf16_f32 v140, v140, v142
    v_lshlrev_b32 v14, 16, v140
    v_mfma_f32_32x32x16_bf16 v[116:131], v[96:99], v[88:91], v[116:131]
    buffer_load_dwordx4 v8, s[60:63], s51 offen offset:1024 lds
    v_and_b32 v30, 0xffff0000, v140
    v_lshlrev_b32 v140, 16, v15
    ds_read_b64_tr_b16 v[88:89], v61 offset:8192
    ds_read_b64_tr_b16 v[90:91], v61 offset:9216
    ds_read_b128 v[92:95], v52 offset:16384
    ds_read_b128 v[96:99], v52 offset:20480
    s_waitcnt lgkmcnt(8)
    v_mfma_f32_32x32x16_bf16 v[100:115], v[68:71], v[64:67], v[100:115]
    s_add_u32 m0, s10, 98304
    s_add_u32 s51, s51, 128
    s_sub_u32 s9, s51, 1152
    s_min_u32 s51, s51, s9
    s_lshl_b32 s9, s51, 7
    s_add_u32 s9, s9, 147456
    buffer_load_dwordx4 v2, s[52:55], s9 offen lds
    v_lshlrev_b32 v141, 16, v31
    v_and_b32 v142, 0xffff0000, v15
    v_mfma_f32_32x32x16_bf16 v[116:131], v[72:75], v[64:67], v[116:131]
    buffer_load_dwordx4 v2, s[52:55], s9 offen offset:1024 lds
    v_and_b32 v143, 0xffff0000, v31
    v_mul_f32 v140, v140, v141
    ds_read_b64_tr_b16 v[64:65], v61 offset:12288
    ds_read_b64_tr_b16 v[66:67], v61 offset:13312
    ds_read_b128 v[68:71], v55 offset:16384
    ds_read_b128 v[72:75], v55 offset:20480
    s_waitcnt lgkmcnt(8)
    v_mfma_f32_32x32x16_bf16 v[100:115], v[80:83], v[76:79], v[100:115]
    buffer_load_dwordx4 v2, s[52:55], s9 offen offset:2048 lds
    v_mul_f32 v142, v142, v143
    v_cvt_pk_bf16_f32 v140, v140, v142
    v_mfma_f32_32x32x16_bf16 v[116:131], v[84:87], v[76:79], v[116:131]
    buffer_load_dwordx4 v2, s[52:55], s9 offen offset:3072 lds
    v_lshlrev_b32 v15, 16, v140
    v_and_b32 v31, 0xffff0000, v140
    s_waitcnt vmcnt(16) lgkmcnt(0)
    s_barrier
    ds_read_b64_tr_b16 v[76:77], v61 offset:24576
    ds_read_b64_tr_b16 v[78:79], v61 offset:25600
    ds_read_b128 v[80:83], v46 offset:40960
    ds_read_b128 v[84:87], v46 offset:45056
    v_mfma_f32_32x32x16_bf16 v[100:115], v[92:95], v[88:91], v[100:115]
    s_add_u32 m0, s11, 114688
    s_nop 0
    buffer_load_dwordx4 v7, s[60:63], s51 offen lds
    v_lshlrev_b32 v140, 16, v16
    v_lshlrev_b32 v141, 16, v32
    v_mfma_f32_32x32x16_bf16 v[116:131], v[96:99], v[88:91], v[116:131]
    buffer_load_dwordx4 v8, s[60:63], s51 offen offset:1024 lds
    v_and_b32 v142, 0xffff0000, v16
    v_and_b32 v143, 0xffff0000, v32
    ds_read_b64_tr_b16 v[88:89], v61 offset:28672
    ds_read_b64_tr_b16 v[90:91], v61 offset:29696
    ds_read_b128 v[92:95], v49 offset:40960
    ds_read_b128 v[96:99], v49 offset:45056
    v_mfma_f32_32x32x16_bf16 v[100:115], v[68:71], v[64:67], v[100:115]
    s_add_u32 m0, s10, 122880
    s_add_u32 s51, s51, 128
    s_sub_u32 s9, s51, 1152
    s_min_u32 s51, s51, s9
    s_lshl_b32 s9, s51, 7
    s_add_u32 s9, s9, 147456
    buffer_load_dwordx4 v2, s[52:55], s9 offen lds
    v_mul_f32 v140, v140, v141
    v_mul_f32 v142, v142, v143
    v_mfma_f32_32x32x16_bf16 v[116:131], v[72:75], v[64:67], v[116:131]
    buffer_load_dwordx4 v2, s[52:55], s9 offen offset:1024 lds
    v_cvt_pk_bf16_f32 v140, v140, v142
    v_lshlrev_b32 v16, 16, v140
    ds_read_b64_tr_b16 v[64:65], v61 offset:32768
    ds_read_b64_tr_b16 v[66:67], v61 offset:33792
    ds_read_b128 v[68:71], v52 offset:40960
    ds_read_b128 v[72:75], v52 offset:45056
    s_waitcnt lgkmcnt(8)
    v_mfma_f32_32x32x16_bf16 v[100:115], v[80:83], v[76:79], v[100:115]
    buffer_load_dwordx4 v2, s[52:55], s9 offen offset:2048 lds
    v_and_b32 v32, 0xffff0000, v140
    v_lshlrev_b32 v140, 16, v17
    v_mfma_f32_32x32x16_bf16 v[116:131], v[84:87], v[76:79], v[116:131]
    buffer_load_dwordx4 v2, s[52:55], s9 offen offset:3072 lds
    v_lshlrev_b32 v141, 16, v33
    v_and_b32 v142, 0xffff0000, v17
    ds_read_b64_tr_b16 v[76:77], v61 offset:36864
    ds_read_b64_tr_b16 v[78:79], v61 offset:37888
    ds_read_b128 v[80:83], v55 offset:40960
    ds_read_b128 v[84:87], v55 offset:45056
    s_waitcnt lgkmcnt(8)
    v_mfma_f32_32x32x16_bf16 v[100:115], v[92:95], v[88:91], v[100:115]
    s_add_u32 m0, s11, 139264
    s_nop 0
    buffer_load_dwordx4 v7, s[60:63], s51 offen lds
    v_and_b32 v143, 0xffff0000, v33
    v_mul_f32 v140, v140, v141
    v_mfma_f32_32x32x16_bf16 v[116:131], v[96:99], v[88:91], v[116:131]
    buffer_load_dwordx4 v8, s[60:63], s51 offen offset:1024 lds
    v_mul_f32 v142, v142, v143
    v_cvt_pk_bf16_f32 v140, v140, v142
    s_waitcnt vmcnt(18) lgkmcnt(0)
    s_barrier
    ds_read_b64_tr_b16 v[88:89], v61 offset:49152
    ds_read_b64_tr_b16 v[90:91], v61 offset:50176
    ds_read_b128 v[92:95], v47 offset:0
    ds_read_b128 v[96:99], v47 offset:4096
    v_mfma_f32_32x32x16_bf16 v[100:115], v[68:71], v[64:67], v[100:115]
    s_add_u32 m0, s10, 0
    s_add_u32 s51, s51, 128
    s_sub_u32 s9, s51, 1152
    s_min_u32 s51, s51, s9
    s_lshl_b32 s9, s51, 7
    s_add_u32 s9, s9, 147456
    buffer_load_dwordx4 v2, s[52:55], s9 offen lds
    v_lshlrev_b32 v17, 16, v140
    v_and_b32 v33, 0xffff0000, v140
    v_mfma_f32_32x32x16_bf16 v[116:131], v[72:75], v[64:67], v[116:131]
    buffer_load_dwordx4 v2, s[52:55], s9 offen offset:1024 lds
    v_lshlrev_b32 v140, 16, v18
    v_lshlrev_b32 v141, 16, v34
    ds_read_b64_tr_b16 v[64:65], v61 offset:53248
    ds_read_b64_tr_b16 v[66:67], v61 offset:54272
    ds_read_b128 v[68:71], v50 offset:0
    ds_read_b128 v[72:75], v50 offset:4096
    v_mfma_f32_32x32x16_bf16 v[100:115], v[80:83], v[76:79], v[100:115]
    buffer_load_dwordx4 v2, s[52:55], s9 offen offset:2048 lds
    v_and_b32 v142, 0xffff0000, v18
    v_and_b32 v143, 0xffff0000, v34
    v_mfma_f32_32x32x16_bf16 v[116:131], v[84:87], v[76:79], v[116:131]
    buffer_load_dwordx4 v2, s[52:55], s9 offen offset:3072 lds
    v_mul_f32 v140, v140, v141
    v_mul_f32 v142, v142, v143
    ds_read_b64_tr_b16 v[76:77], v61 offset:57344
    ds_read_b64_tr_b16 v[78:79], v61 offset:58368
    ds_read_b128 v[80:83], v53 offset:0
    ds_read_b128 v[84:87], v53 offset:4096
    s_waitcnt lgkmcnt(8)
    v_mfma_f32_32x32x16_bf16 v[100:115], v[92:95], v[88:91], v[100:115]
    s_add_u32 m0, s11, 16384
    s_nop 0
    buffer_load_dwordx4 v7, s[60:63], s51 offen lds
    v_cvt_pk_bf16_f32 v140, v140, v142
    v_lshlrev_b32 v18, 16, v140
    v_mfma_f32_32x32x16_bf16 v[116:131], v[96:99], v[88:91], v[116:131]
    buffer_load_dwordx4 v8, s[60:63], s51 offen offset:1024 lds
    v_and_b32 v34, 0xffff0000, v140
    v_lshlrev_b32 v140, 16, v19
    ds_read_b64_tr_b16 v[88:89], v61 offset:61440
    ds_read_b64_tr_b16 v[90:91], v61 offset:62464
    ds_read_b128 v[92:95], v56 offset:0
    ds_read_b128 v[96:99], v56 offset:4096
    s_waitcnt lgkmcnt(8)
    v_mfma_f32_32x32x16_bf16 v[100:115], v[68:71], v[64:67], v[100:115]
    s_add_u32 m0, s10, 24576
    s_add_u32 s51, s51, 128
    s_sub_u32 s9, s51, 1152
    s_min_u32 s51, s51, s9
    s_lshl_b32 s9, s51, 7
    s_add_u32 s9, s9, 147456
    buffer_load_dwordx4 v2, s[52:55], s9 offen lds
    v_lshlrev_b32 v141, 16, v35
    v_and_b32 v142, 0xffff0000, v19
    v_mfma_f32_32x32x16_bf16 v[116:131], v[72:75], v[64:67], v[116:131]
    buffer_load_dwordx4 v2, s[52:55], s9 offen offset:1024 lds
    v_and_b32 v143, 0xffff0000, v35
    v_mul_f32 v140, v140, v141
    s_waitcnt vmcnt(20) lgkmcnt(0)
    s_barrier
    ds_read_b64_tr_b16 v[64:65], v62 offset:8192
    ds_read_b64_tr_b16 v[66:67], v62 offset:9216
    ds_read_b128 v[68:71], v47 offset:24576
    ds_read_b128 v[72:75], v47 offset:28672
    v_mfma_f32_32x32x16_bf16 v[100:115], v[80:83], v[76:79], v[100:115]
    buffer_load_dwordx4 v2, s[52:55], s9 offen offset:2048 lds
    v_mul_f32 v142, v142, v143
    v_cvt_pk_bf16_f32 v140, v140, v142
    v_mfma_f32_32x32x16_bf16 v[116:131], v[84:87], v[76:79], v[116:131]
    buffer_load_dwordx4 v2, s[52:55], s9 offen offset:3072 lds
    v_lshlrev_b32 v19, 16, v140
    v_and_b32 v35, 0xffff0000, v140
    ds_read_b64_tr_b16 v[76:77], v62 offset:12288
    ds_read_b64_tr_b16 v[78:79], v62 offset:13312
    ds_read_b128 v[80:83], v50 offset:24576
    ds_read_b128 v[84:87], v50 offset:28672
    v_mfma_f32_32x32x16_bf16 v[100:115], v[92:95], v[88:91], v[100:115]
    s_add_u32 m0, s11, 40960
    s_nop 0
    buffer_load_dwordx4 v7, s[60:63], s51 offen lds
    v_lshlrev_b32 v140, 16, v20
    v_lshlrev_b32 v141, 16, v36
    v_mfma_f32_32x32x16_bf16 v[116:131], v[96:99], v[88:91], v[116:131]
    buffer_load_dwordx4 v8, s[60:63], s51 offen offset:1024 lds
    v_and_b32 v142, 0xffff0000, v20
    v_and_b32 v143, 0xffff0000, v36
    ds_read_b64_tr_b16 v[88:89], v62 offset:16384
    ds_read_b64_tr_b16 v[90:91], v62 offset:17408
    ds_read_b128 v[92:95], v53 offset:24576
    ds_read_b128 v[96:99], v53 offset:28672
    s_waitcnt lgkmcnt(8)
    v_mfma_f32_32x32x16_bf16 v[100:115], v[68:71], v[64:67], v[100:115]
    s_add_u32 m0, s10, 49152
    s_add_u32 s51, s51, 128
    s_sub_u32 s9, s51, 1152
    s_min_u32 s51, s51, s9
    s_lshl_b32 s9, s51, 7
    s_add_u32 s9, s9, 147456
    buffer_load_dwordx4 v2, s[52:55], s9 offen lds
    v_mul_f32 v140, v140, v141
    v_mul_f32 v142, v142, v143
    v_mfma_f32_32x32x16_bf16 v[116:131], v[72:75], v[64:67], v[116:131]
    buffer_load_dwordx4 v2, s[52:55], s9 offen offset:1024 lds
    v_cvt_pk_bf16_f32 v140, v140, v142
    v_lshlrev_b32 v20, 16, v140
    ds_read_b64_tr_b16 v[64:65], v62 offset:20480
    ds_read_b64_tr_b16 v[66:67], v62 offset:21504
    ds_read_b128 v[68:71], v56 offset:24576
    ds_read_b128 v[72:75], v56 offset:28672
    s_waitcnt lgkmcnt(8)
    v_mfma_f32_32x32x16_bf16 v[100:115], v[80:83], v[76:79], v[100:115]
    buffer_load_dwordx4 v2, s[52:55], s9 offen offset:2048 lds
    v_and_b32 v36, 0xffff0000, v140
    v_lshlrev_b32 v140, 16, v21
    v_mfma_f32_32x32x16_bf16 v[116:131], v[84:87], v[76:79], v[116:131]
    buffer_load_dwordx4 v2, s[52:55], s9 offen offset:3072 lds
    v_lshlrev_b32 v141, 16, v37
    v_and_b32 v142, 0xffff0000, v21
    s_waitcnt vmcnt(22) lgkmcnt(0)
    s_barrier
    ds_read_b64_tr_b16 v[76:77], v62 offset:32768
    ds_read_b64_tr_b16 v[78:79], v62 offset:33792
    ds_read_b128 v[80:83], v47 offset:49152
    ds_read_b128 v[84:87], v47 offset:53248
    v_mfma_f32_32x32x16_bf16 v[100:115], v[92:95], v[88:91], v[100:115]
    s_add_u32 m0, s11, 65536
    s_nop 0
    buffer_load_dwordx4 v7, s[60:63], s51 offen lds
    v_and_b32 v143, 0xffff0000, v37
    v_mul_f32 v140, v140, v141
    v_mfma_f32_32x32x16_bf16 v[116:131], v[96:99], v[88:91], v[116:131]
    buffer_load_dwordx4 v8, s[60:63], s51 offen offset:1024 lds
    v_mul_f32 v142, v142, v143
    v_cvt_pk_bf16_f32 v140, v140, v142
    ds_read_b64_tr_b16 v[88:89], v62 offset:36864
    ds_read_b64_tr_b16 v[90:91], v62 offset:37888
    ds_read_b128 v[92:95], v50 offset:49152
    ds_read_b128 v[96:99], v50 offset:53248
    v_mfma_f32_32x32x16_bf16 v[100:115], v[68:71], v[64:67], v[100:115]
    s_add_u32 m0, s10, 73728
    s_add_u32 s51, s51, 128
    s_sub_u32 s9, s51, 1152
    s_min_u32 s51, s51, s9
    s_lshl_b32 s9, s51, 7
    s_add_u32 s9, s9, 147456
    buffer_load_dwordx4 v2, s[52:55], s9 offen lds
    v_lshlrev_b32 v21, 16, v140
    v_and_b32 v37, 0xffff0000, v140
    v_mfma_f32_32x32x16_bf16 v[116:131], v[72:75], v[64:67], v[116:131]
    buffer_load_dwordx4 v2, s[52:55], s9 offen offset:1024 lds
    v_lshlrev_b32 v140, 16, v22
    v_lshlrev_b32 v141, 16, v38
    ds_read_b64_tr_b16 v[64:65], v62 offset:40960
    ds_read_b64_tr_b16 v[66:67], v62 offset:41984
    ds_read_b128 v[68:71], v53 offset:49152
    ds_read_b128 v[72:75], v53 offset:53248
    s_waitcnt lgkmcnt(8)
    v_mfma_f32_32x32x16_bf16 v[100:115], v[80:83], v[76:79], v[100:115]
    buffer_load_dwordx4 v2, s[52:55], s9 offen offset:2048 lds
    v_and_b32 v142, 0xffff0000, v22
    v_and_b32 v143, 0xffff0000, v38
    v_mfma_f32_32x32x16_bf16 v[116:131], v[84:87], v[76:79], v[116:131]
    buffer_load_dwordx4 v2, s[52:55], s9 offen offset:3072 lds
    v_mul_f32 v140, v140, v141
    v_mul_f32 v142, v142, v143
    ds_read_b64_tr_b16 v[76:77], v62 offset:45056
    ds_read_b64_tr_b16 v[78:79], v62 offset:46080
    ds_read_b128 v[80:83], v56 offset:49152
    ds_read_b128 v[84:87], v56 offset:53248
    s_waitcnt lgkmcnt(8)
    v_mfma_f32_32x32x16_bf16 v[100:115], v[92:95], v[88:91], v[100:115]
    s_add_u32 m0, s11, 90112
    s_nop 0
    buffer_load_dwordx4 v7, s[60:63], s51 offen lds
    v_cvt_pk_bf16_f32 v140, v140, v142
    v_lshlrev_b32 v22, 16, v140
    v_mfma_f32_32x32x16_bf16 v[116:131], v[96:99], v[88:91], v[116:131]
    buffer_load_dwordx4 v8, s[60:63], s51 offen offset:1024 lds
    v_and_b32 v38, 0xffff0000, v140
    v_lshlrev_b32 v140, 16, v23
    s_waitcnt vmcnt(24) lgkmcnt(0)
    s_barrier
    ds_read_b64_tr_b16 v[88:89], v62 offset:57344
    ds_read_b64_tr_b16 v[90:91], v62 offset:58368
    ds_read_b128 v[92:95], v48 offset:8192
    ds_read_b128 v[96:99], v48 offset:12288
    v_mfma_f32_32x32x16_bf16 v[100:115], v[68:71], v[64:67], v[100:115]
    s_add_u32 m0, s10, 98304
    s_add_u32 s51, s51, 128
    s_sub_u32 s9, s51, 1152
    s_min_u32 s51, s51, s9
    s_lshl_b32 s9, s51, 7
    s_add_u32 s9, s9, 147456
    buffer_load_dwordx4 v2, s[52:55], s9 offen lds
    v_lshlrev_b32 v141, 16, v39
    v_and_b32 v142, 0xffff0000, v23
    v_mfma_f32_32x32x16_bf16 v[116:131], v[72:75], v[64:67], v[116:131]
    buffer_load_dwordx4 v2, s[52:55], s9 offen offset:1024 lds
    v_and_b32 v143, 0xffff0000, v39
    v_mul_f32 v140, v140, v141
    ds_read_b64_tr_b16 v[64:65], v62 offset:61440
    ds_read_b64_tr_b16 v[66:67], v62 offset:62464
    ds_read_b128 v[68:71], v51 offset:8192
    ds_read_b128 v[72:75], v51 offset:12288
    v_mfma_f32_32x32x16_bf16 v[100:115], v[80:83], v[76:79], v[100:115]
    buffer_load_dwordx4 v2, s[52:55], s9 offen offset:2048 lds
    v_mul_f32 v142, v142, v143
    v_cvt_pk_bf16_f32 v140, v140, v142
    v_mfma_f32_32x32x16_bf16 v[116:131], v[84:87], v[76:79], v[116:131]
    buffer_load_dwordx4 v2, s[52:55], s9 offen offset:3072 lds
    v_lshlrev_b32 v23, 16, v140
    v_and_b32 v39, 0xffff0000, v140
    ds_read_b64_tr_b16 v[76:77], v63 offset:0
    ds_read_b64_tr_b16 v[78:79], v63 offset:1024
    ds_read_b128 v[80:83], v54 offset:8192
    ds_read_b128 v[84:87], v54 offset:12288
    s_waitcnt lgkmcnt(8)
    v_mfma_f32_32x32x16_bf16 v[100:115], v[92:95], v[88:91], v[100:115]
    s_add_u32 m0, s11, 114688
    s_nop 0
    buffer_load_dwordx4 v7, s[60:63], s51 offen lds
    v_lshlrev_b32 v140, 16, v24
    v_lshlrev_b32 v141, 16, v40
    v_mfma_f32_32x32x16_bf16 v[116:131], v[96:99], v[88:91], v[116:131]
    buffer_load_dwordx4 v8, s[60:63], s51 offen offset:1024 lds
    v_and_b32 v142, 0xffff0000, v24
    v_and_b32 v143, 0xffff0000, v40
    ds_read_b64_tr_b16 v[88:89], v63 offset:4096
    ds_read_b64_tr_b16 v[90:91], v63 offset:5120
    ds_read_b128 v[92:95], v57 offset:8192
    ds_read_b128 v[96:99], v57 offset:12288
    s_waitcnt lgkmcnt(8)
    v_mfma_f32_32x32x16_bf16 v[100:115], v[68:71], v[64:67], v[100:115]
    v_mul_f32 v140, v140, v141
    v_mul_f32 v142, v142, v143
    v_mfma_f32_32x32x16_bf16 v[116:131], v[72:75], v[64:67], v[116:131]
    v_cvt_pk_bf16_f32 v140, v140, v142
    v_lshlrev_b32 v24, 16, v140
    s_waitcnt vmcnt(24) lgkmcnt(0)
    s_barrier
    ds_read_b64_tr_b16 v[64:65], v61 offset:0
    ds_read_b64_tr_b16 v[66:67], v61 offset:1024
    ds_read_b128 v[68:71], v46 offset:16384
    ds_read_b128 v[72:75], v46 offset:20480
    v_mfma_f32_32x32x16_bf16 v[100:115], v[80:83], v[76:79], v[100:115]
    s_add_u32 m0, s10, 122880
    s_add_u32 s51, s51, 128
    s_sub_u32 s9, s51, 1152
    s_min_u32 s51, s51, s9
    s_lshl_b32 s9, s51, 7
    s_add_u32 s9, s9, 147456
    buffer_load_dwordx4 v2, s[52:55], s9 offen lds
    v_and_b32 v40, 0xffff0000, v140
    v_lshlrev_b32 v140, 16, v25
    v_mfma_f32_32x32x16_bf16 v[116:131], v[84:87], v[76:79], v[116:131]
    buffer_load_dwordx4 v2, s[52:55], s9 offen offset:1024 lds
    v_lshlrev_b32 v141, 16, v41
    v_and_b32 v142, 0xffff0000, v25
    ds_read_b64_tr_b16 v[76:77], v61 offset:4096
    ds_read_b64_tr_b16 v[78:79], v61 offset:5120
    ds_read_b128 v[80:83], v49 offset:16384
    ds_read_b128 v[84:87], v49 offset:20480
    v_mfma_f32_32x32x16_bf16 v[100:115], v[92:95], v[88:91], v[100:115]
    buffer_load_dwordx4 v2, s[52:55], s9 offen offset:2048 lds
    v_and_b32 v143, 0xffff0000, v41
    v_mul_f32 v140, v140, v141
    v_mfma_f32_32x32x16_bf16 v[116:131], v[96:99], v[88:91], v[116:131]
    buffer_load_dwordx4 v2, s[52:55], s9 offen offset:3072 lds
    v_mul_f32 v142, v142, v143
    v_cvt_pk_bf16_f32 v140, v140, v142
    ds_read_b64_tr_b16 v[88:89], v61 offset:8192
    ds_read_b64_tr_b16 v[90:91], v61 offset:9216
    ds_read_b128 v[92:95], v52 offset:16384
    ds_read_b128 v[96:99], v52 offset:20480
    s_waitcnt lgkmcnt(8)
    v_mfma_f32_32x32x16_bf16 v[100:115], v[68:71], v[64:67], v[100:115]
    s_add_u32 m0, s11, 139264
    s_nop 0
    buffer_load_dwordx4 v7, s[60:63], s51 offen lds
    v_lshlrev_b32 v25, 16, v140
    v_and_b32 v41, 0xffff0000, v140
    v_mfma_f32_32x32x16_bf16 v[116:131], v[72:75], v[64:67], v[116:131]
    buffer_load_dwordx4 v8, s[60:63], s51 offen offset:1024 lds
    v_lshlrev_b32 v140, 16, v26
    v_lshlrev_b32 v141, 16, v42
    ds_read_b64_tr_b16 v[64:65], v61 offset:12288
    ds_read_b64_tr_b16 v[66:67], v61 offset:13312
    ds_read_b128 v[68:71], v55 offset:16384
    ds_read_b128 v[72:75], v55 offset:20480
    s_waitcnt lgkmcnt(8)
    v_mfma_f32_32x32x16_bf16 v[100:115], v[80:83], v[76:79], v[100:115]
    v_and_b32 v142, 0xffff0000, v26
    v_and_b32 v143, 0xffff0000, v42
    v_mfma_f32_32x32x16_bf16 v[116:131], v[84:87], v[76:79], v[116:131]
    v_mul_f32 v140, v140, v141
    v_mul_f32 v142, v142, v143
    s_waitcnt vmcnt(24) lgkmcnt(0)
    s_barrier
    ds_read_b64_tr_b16 v[76:77], v61 offset:24576
    ds_read_b64_tr_b16 v[78:79], v61 offset:25600
    ds_read_b128 v[80:83], v46 offset:40960
    ds_read_b128 v[84:87], v46 offset:45056
    v_mfma_f32_32x32x16_bf16 v[100:115], v[92:95], v[88:91], v[100:115]
    v_cvt_pk_bf16_f32 v140, v140, v142
    v_lshlrev_b32 v26, 16, v140
    v_mfma_f32_32x32x16_bf16 v[116:131], v[96:99], v[88:91], v[116:131]
    v_and_b32 v42, 0xffff0000, v140
    v_lshlrev_b32 v140, 16, v27
    ds_read_b64_tr_b16 v[88:89], v61 offset:28672
    ds_read_b64_tr_b16 v[90:91], v61 offset:29696
    ds_read_b128 v[92:95], v49 offset:40960
    ds_read_b128 v[96:99], v49 offset:45056
    v_mfma_f32_32x32x16_bf16 v[100:115], v[68:71], v[64:67], v[100:115]
    v_lshlrev_b32 v141, 16, v43
    v_and_b32 v142, 0xffff0000, v27
    v_mfma_f32_32x32x16_bf16 v[116:131], v[72:75], v[64:67], v[116:131]
    v_and_b32 v143, 0xffff0000, v43
    v_mul_f32 v140, v140, v141
    ds_read_b64_tr_b16 v[64:65], v61 offset:32768
    ds_read_b64_tr_b16 v[66:67], v61 offset:33792
    ds_read_b128 v[68:71], v52 offset:40960
    ds_read_b128 v[72:75], v52 offset:45056
    s_waitcnt lgkmcnt(8)
    v_mfma_f32_32x32x16_bf16 v[100:115], v[80:83], v[76:79], v[100:115]
    v_mul_f32 v142, v142, v143
    v_cvt_pk_bf16_f32 v140, v140, v142
    v_mfma_f32_32x32x16_bf16 v[116:131], v[84:87], v[76:79], v[116:131]
    v_lshlrev_b32 v27, 16, v140
    v_and_b32 v43, 0xffff0000, v140
    ds_read_b64_tr_b16 v[76:77], v61 offset:36864
    ds_read_b64_tr_b16 v[78:79], v61 offset:37888
    ds_read_b128 v[80:83], v55 offset:40960
    ds_read_b128 v[84:87], v55 offset:45056
    s_waitcnt lgkmcnt(8)
    v_mfma_f32_32x32x16_bf16 v[100:115], v[92:95], v[88:91], v[100:115]
    v_mfma_f32_32x32x16_bf16 v[116:131], v[96:99], v[88:91], v[116:131]
    s_waitcnt vmcnt(18) lgkmcnt(0)
    s_barrier
    ds_read_b64_tr_b16 v[88:89], v61 offset:49152
    ds_read_b64_tr_b16 v[90:91], v61 offset:50176
    ds_read_b128 v[92:95], v47 offset:0
    ds_read_b128 v[96:99], v47 offset:4096
    v_mfma_f32_32x32x16_bf16 v[100:115], v[68:71], v[64:67], v[100:115]
    v_mfma_f32_32x32x16_bf16 v[116:131], v[72:75], v[64:67], v[116:131]
    ds_read_b64_tr_b16 v[64:65], v61 offset:53248
    ds_read_b64_tr_b16 v[66:67], v61 offset:54272
    ds_read_b128 v[68:71], v50 offset:0
    ds_read_b128 v[72:75], v50 offset:4096
    v_mfma_f32_32x32x16_bf16 v[100:115], v[80:83], v[76:79], v[100:115]
    v_mfma_f32_32x32x16_bf16 v[116:131], v[84:87], v[76:79], v[116:131]
    ds_read_b64_tr_b16 v[76:77], v61 offset:57344
    ds_read_b64_tr_b16 v[78:79], v61 offset:58368
    ds_read_b128 v[80:83], v53 offset:0
    ds_read_b128 v[84:87], v53 offset:4096
    s_waitcnt lgkmcnt(8)
    v_mfma_f32_32x32x16_bf16 v[100:115], v[92:95], v[88:91], v[100:115]
    v_mfma_f32_32x32x16_bf16 v[116:131], v[96:99], v[88:91], v[116:131]
    ds_read_b64_tr_b16 v[88:89], v61 offset:61440
    ds_read_b64_tr_b16 v[90:91], v61 offset:62464
    ds_read_b128 v[92:95], v56 offset:0
    ds_read_b128 v[96:99], v56 offset:4096
    s_waitcnt lgkmcnt(8)
    v_mfma_f32_32x32x16_bf16 v[100:115], v[68:71], v[64:67], v[100:115]
    v_mfma_f32_32x32x16_bf16 v[116:131], v[72:75], v[64:67], v[116:131]
    s_waitcnt vmcnt(12) lgkmcnt(0)
    s_barrier
    ds_read_b64_tr_b16 v[64:65], v62 offset:8192
    ds_read_b64_tr_b16 v[66:67], v62 offset:9216
    ds_read_b128 v[68:71], v47 offset:24576
    ds_read_b128 v[72:75], v47 offset:28672
    v_mfma_f32_32x32x16_bf16 v[100:115], v[80:83], v[76:79], v[100:115]
    v_mfma_f32_32x32x16_bf16 v[116:131], v[84:87], v[76:79], v[116:131]
    ds_read_b64_tr_b16 v[76:77], v62 offset:12288
    ds_read_b64_tr_b16 v[78:79], v62 offset:13312
    ds_read_b128 v[80:83], v50 offset:24576
    ds_read_b128 v[84:87], v50 offset:28672
    v_mfma_f32_32x32x16_bf16 v[100:115], v[92:95], v[88:91], v[100:115]
    v_mfma_f32_32x32x16_bf16 v[116:131], v[96:99], v[88:91], v[116:131]
    ds_read_b64_tr_b16 v[88:89], v62 offset:16384
    ds_read_b64_tr_b16 v[90:91], v62 offset:17408
    ds_read_b128 v[92:95], v53 offset:24576
    ds_read_b128 v[96:99], v53 offset:28672
    s_waitcnt lgkmcnt(8)
    v_mfma_f32_32x32x16_bf16 v[100:115], v[68:71], v[64:67], v[100:115]
    v_mfma_f32_32x32x16_bf16 v[116:131], v[72:75], v[64:67], v[116:131]
    ds_read_b64_tr_b16 v[64:65], v62 offset:20480
    ds_read_b64_tr_b16 v[66:67], v62 offset:21504
    ds_read_b128 v[68:71], v56 offset:24576
    ds_read_b128 v[72:75], v56 offset:28672
    s_waitcnt lgkmcnt(8)
    v_mfma_f32_32x32x16_bf16 v[100:115], v[80:83], v[76:79], v[100:115]
    v_mfma_f32_32x32x16_bf16 v[116:131], v[84:87], v[76:79], v[116:131]
    s_waitcnt vmcnt(6) lgkmcnt(0)
    s_barrier
    ds_read_b64_tr_b16 v[76:77], v62 offset:32768
    ds_read_b64_tr_b16 v[78:79], v62 offset:33792
    ds_read_b128 v[80:83], v47 offset:49152
    ds_read_b128 v[84:87], v47 offset:53248
    v_mfma_f32_32x32x16_bf16 v[100:115], v[92:95], v[88:91], v[100:115]
    v_mfma_f32_32x32x16_bf16 v[116:131], v[96:99], v[88:91], v[116:131]
    ds_read_b64_tr_b16 v[88:89], v62 offset:36864
    ds_read_b64_tr_b16 v[90:91], v62 offset:37888
    ds_read_b128 v[92:95], v50 offset:49152
    ds_read_b128 v[96:99], v50 offset:53248
    v_mfma_f32_32x32x16_bf16 v[100:115], v[68:71], v[64:67], v[100:115]
    v_mfma_f32_32x32x16_bf16 v[116:131], v[72:75], v[64:67], v[116:131]
    ds_read_b64_tr_b16 v[64:65], v62 offset:40960
    ds_read_b64_tr_b16 v[66:67], v62 offset:41984
    ds_read_b128 v[68:71], v53 offset:49152
    ds_read_b128 v[72:75], v53 offset:53248
    s_waitcnt lgkmcnt(8)
    v_mfma_f32_32x32x16_bf16 v[100:115], v[80:83], v[76:79], v[100:115]
    v_mfma_f32_32x32x16_bf16 v[116:131], v[84:87], v[76:79], v[116:131]
    ds_read_b64_tr_b16 v[76:77], v62 offset:45056
    ds_read_b64_tr_b16 v[78:79], v62 offset:46080
    ds_read_b128 v[80:83], v56 offset:49152
    ds_read_b128 v[84:87], v56 offset:53248
    s_waitcnt lgkmcnt(8)
    v_mfma_f32_32x32x16_bf16 v[100:115], v[92:95], v[88:91], v[100:115]
    v_mfma_f32_32x32x16_bf16 v[116:131], v[96:99], v[88:91], v[116:131]
    s_waitcnt vmcnt(0) lgkmcnt(0)
    s_barrier
    ds_read_b64_tr_b16 v[88:89], v62 offset:57344
    ds_read_b64_tr_b16 v[90:91], v62 offset:58368
    ds_read_b128 v[92:95], v48 offset:8192
    ds_read_b128 v[96:99], v48 offset:12288
    v_mfma_f32_32x32x16_bf16 v[100:115], v[68:71], v[64:67], v[100:115]
    v_mfma_f32_32x32x16_bf16 v[116:131], v[72:75], v[64:67], v[116:131]
    ds_read_b64_tr_b16 v[64:65], v62 offset:61440
    ds_read_b64_tr_b16 v[66:67], v62 offset:62464
    ds_read_b128 v[68:71], v51 offset:8192
    ds_read_b128 v[72:75], v51 offset:12288
    v_mfma_f32_32x32x16_bf16 v[100:115], v[80:83], v[76:79], v[100:115]
    v_mfma_f32_32x32x16_bf16 v[116:131], v[84:87], v[76:79], v[116:131]
    ds_read_b64_tr_b16 v[76:77], v63 offset:0
    ds_read_b64_tr_b16 v[78:79], v63 offset:1024
    ds_read_b128 v[80:83], v54 offset:8192
    ds_read_b128 v[84:87], v54 offset:12288
    s_waitcnt lgkmcnt(8)
    v_mfma_f32_32x32x16_bf16 v[100:115], v[92:95], v[88:91], v[100:115]
    v_mfma_f32_32x32x16_bf16 v[116:131], v[96:99], v[88:91], v[116:131]
    ds_read_b64_tr_b16 v[88:89], v63 offset:4096
    ds_read_b64_tr_b16 v[90:91], v63 offset:5120
    ds_read_b128 v[92:95], v57 offset:8192
    ds_read_b128 v[96:99], v57 offset:12288
    s_waitcnt lgkmcnt(8)
    v_mfma_f32_32x32x16_bf16 v[100:115], v[68:71], v[64:67], v[100:115]
    v_mfma_f32_32x32x16_bf16 v[116:131], v[72:75], v[64:67], v[116:131]
    s_waitcnt lgkmcnt(4)
    v_mfma_f32_32x32x16_bf16 v[100:115], v[80:83], v[76:79], v[100:115]
    v_mfma_f32_32x32x16_bf16 v[116:131], v[84:87], v[76:79], v[116:131]
    s_waitcnt lgkmcnt(0)
    v_mfma_f32_32x32x16_bf16 v[100:115], v[92:95], v[88:91], v[100:115]
    v_mfma_f32_32x32x16_bf16 v[116:131], v[96:99], v[88:91], v[116:131]
    s_nop 7
    s_nop 3
    v_add_f32 v100, v100, v12
    v_add_f32 v101, v101, v28
    v_add_f32 v102, v102, v13
    v_add_f32 v103, v103, v29
    v_add_f32 v104, v104, v14
    v_add_f32 v105, v105, v30
    v_add_f32 v106, v106, v15
    v_add_f32 v107, v107, v31
    v_add_f32 v108, v108, v16
    v_add_f32 v109, v109, v32
    v_add_f32 v110, v110, v17
    v_add_f32 v111, v111, v33
    v_add_f32 v112, v112, v18
    v_add_f32 v113, v113, v34
    v_add_f32 v114, v114, v19
    v_add_f32 v115, v115, v35
    v_add_f32 v116, v116, v20
    v_add_f32 v117, v117, v36
    v_add_f32 v118, v118, v21
    v_add_f32 v119, v119, v37
    v_add_f32 v120, v120, v22
    v_add_f32 v121, v121, v38
    v_add_f32 v122, v122, v23
    v_add_f32 v123, v123, v39
    v_add_f32 v124, v124, v24
    v_add_f32 v125, v125, v40
    v_add_f32 v126, v126, v25
    v_add_f32 v127, v127, v41
    v_add_f32 v128, v128, v26
    v_add_f32 v129, v129, v42
    v_add_f32 v130, v130, v27
    v_add_f32 v131, v131, v43
    ds_write_b128 v133, v[100:103] offset:0
    ds_write_b128 v137, v[104:107] offset:0
    ds_write_b128 v138, v[108:111] offset:0
    ds_write_b128 v139, v[112:115] offset:0
    ds_write_b128 v133, v[116:119] offset:4096
    ds_write_b128 v137, v[120:123] offset:4096
    ds_write_b128 v138, v[124:127] offset:4096
    ds_write_b128 v139, v[128:131] offset:4096
    s_waitcnt lgkmcnt(4)
    ds_read_b128 v[100:103], v134 offset:0
    ds_read_b128 v[104:107], v134 offset:1024
    ds_read_b128 v[108:111], v134 offset:2048
    ds_read_b128 v[112:115], v134 offset:3072
    s_waitcnt lgkmcnt(4)
    ds_read_b128 v[116:119], v134 offset:4096
    ds_read_b128 v[120:123], v134 offset:5120
    ds_read_b128 v[124:127], v134 offset:6144
    ds_read_b128 v[128:131], v134 offset:7168
    s_waitcnt lgkmcnt(7)
    s_mov_b32 s9, 0
    buffer_store_dwordx4 v[100:103], v135, s[72:75], s9 offen offset:0 sc0 sc1
    s_waitcnt lgkmcnt(6)
    s_mov_b32 s9, 36864
    buffer_store_dwordx4 v[104:107], v135, s[72:75], s9 offen offset:0 sc0 sc1
    s_waitcnt lgkmcnt(5)
    s_mov_b32 s9, 73728
    buffer_store_dwordx4 v[108:111], v135, s[72:75], s9 offen offset:0 sc0 sc1
    s_waitcnt lgkmcnt(4)
    s_mov_b32 s9, 110592
    buffer_store_dwordx4 v[112:115], v135, s[72:75], s9 offen offset:0 sc0 sc1
    s_waitcnt lgkmcnt(3)
    s_mov_b32 s9, 0
    buffer_store_dwordx4 v[116:119], v135, s[72:75], s9 offen offset:128 sc0 sc1
    s_waitcnt lgkmcnt(2)
    s_mov_b32 s9, 36864
    buffer_store_dwordx4 v[120:123], v135, s[72:75], s9 offen offset:128 sc0 sc1
    s_waitcnt lgkmcnt(1)
    s_mov_b32 s9, 73728
    buffer_store_dwordx4 v[124:127], v135, s[72:75], s9 offen offset:128 sc0 sc1
    s_waitcnt lgkmcnt(0)
    s_mov_b32 s9, 110592
    buffer_store_dwordx4 v[128:131], v135, s[72:75], s9 offen offset:128 sc0 sc1
    s_endpgm
L_k3_end:
    s_endpgm
L_code_end:
.section .rodata,"a"
.p2align 6
.amdhsa_kernel k1_kernel
  .amdhsa_next_free_vgpr 256
  .amdhsa_next_free_sgpr 102
  .amdhsa_accum_offset 256
  .amdhsa_group_segment_fixed_size 0
  .amdhsa_kernarg_size 136
  .amdhsa_user_sgpr_count 2
  .amdhsa_user_sgpr_kernarg_segment_ptr 1
  .amdhsa_system_sgpr_workgroup_id_x 1
.end_amdhsa_kernel

.p2align 6
.amdhsa_kernel k2_kernel
  .amdhsa_next_free_vgpr 110
  .amdhsa_next_free_sgpr 102
  .amdhsa_accum_offset 112
  .amdhsa_group_segment_fixed_size 0
  .amdhsa_kernarg_size 136
  .amdhsa_user_sgpr_count 2
  .amdhsa_user_sgpr_kernarg_segment_ptr 1
  .amdhsa_system_sgpr_workgroup_id_x 1
.end_amdhsa_kernel

.p2align 6
.amdhsa_kernel k3_kernel
  .amdhsa_next_free_vgpr 144
  .amdhsa_next_free_sgpr 102
  .amdhsa_accum_offset 144
  .amdhsa_group_segment_fixed_size 0
  .amdhsa_kernarg_size 136
  .amdhsa_user_sgpr_count 2
  .amdhsa_user_sgpr_kernarg_segment_ptr 1
  .amdhsa_system_sgpr_workgroup_id_x 1
.end_amdhsa_kernel
```
